```python
import torch

def _softmax(x, axis=-1):
    return torch.softmax(x, dim=axis)
def _gelu(x):
    return torch.nn.functional.gelu(x, approximate="tanh")
def _silu(x):
    return torch.nn.functional.silu(x)
def _sigmoid(x):
    return torch.sigmoid(x)
def _layernorm(x, axis=-1, eps=1e-5):
    m = x.mean(dim=axis, keepdim=True)
    v = x.var(dim=axis, keepdim=True, unbiased=False)
    return (x - m) / torch.sqrt(v + eps)
def _scatter_add(tgt, idx, src, axis=0):
    return tgt.clone().index_add_(axis, idx, src)
def _segment_sum(src, seg, n):
    out = torch.zeros((n,) + src.shape[1:], dtype=src.dtype)
    return out.index_add_(0, seg, src)
def _pad(x, pw):
    flat = tuple(v for pair in reversed(pw) for v in pair)
    return torch.nn.functional.pad(x, flat)

kernel_name = 'standalone__mha_softmax__near_ridge'

def setup_inputs():

    _w = (lambda a: (lambda t: t.to(torch.bfloat16) if t.is_floating_point() else t)(torch.as_tensor(a)))
    B, H, Sq, Sk, D = 8, 32, 192, 512, 128
    return {
        "q": _w((lambda *s: torch.randn(*s, dtype=torch.bfloat16) * 0.8)(B, H, Sq, D)),
        "k": _w((lambda *s: torch.randn(*s, dtype=torch.bfloat16) * 0.8)(B, H, Sk, D)),
        "v": _w((lambda *s: torch.randn(*s, dtype=torch.bfloat16) * 0.05)(B, H, Sk, D)),
    }

def reference(q, k, v):
    scale = q.shape[-1] ** -0.5
    scores = torch.einsum("bhqd,bhkd->bhqk", q, k) * scale
    p = _softmax(scores, axis=-1)
    return torch.einsum("bhqk,bhkd->bhqd", p, v)
```

```asm
; @launch grid=(256,1,1) block=(256,1,1) lds=160528
.amdgcn_target "amdgcn-amd-amdhsa--gfx950"
.text
.globl standalone__mha_softmax__near_ridge_kernel
.p2align 12
.p2align 8
.type standalone__mha_softmax__near_ridge_kernel,@function
standalone__mha_softmax__near_ridge_kernel:
s_cmp_ge_u32 s2, 256
s_cbranch_scc1 L_end
s_load_dwordx4 s[4:7], s[0:1], 0
s_load_dwordx4 s[12:15], s[0:1], 16
s_lshr_b32 s3, s2, 3
s_and_b32 s28, s2, 7
s_lshl_b32 s92, s28, 2
s_lshr_b32 s92, 0x10101012, s92
s_lshl_b32 s28, s28, 5
s_or_b32 s3, s3, s28
s_getpc_b64 s[44:45]
v_mul_u32_u24 v138, 72, v0
s_and_b32 s92, s92, 15
s_lshl_b32 s46, s92, 14
v_cmp_le_u32 vcc, 38, v0
v_add_u32 v139, s46, v138
v_cndmask_b32 v138, v138, v139, vcc
global_load_dword v139, v138, s[44:45] offset:588
v_and_b32 v1, 63, v0
v_lshrrev_b32 v20, 6, v0
v_lshlrev_b32 v21, 4, v1
v_readfirstlane_b32 s20, v20
v_lshrrev_b32 v23, 4, v1
s_lshl_b32 s21, s20, 15
v_add_u32 v2, s21, v21
s_mul_i32 s93, s20, 12288
s_add_u32 s99, s93, 4096
s_add_u32 s100, s93, 8192
v_lshlrev_b32 v23, 6, v23
v_xor_b32 v3, v21, v23
s_mul_i32 s23, s20, 2112
s_mul_i32 s26, s20, 12672
s_mul_i32 s28, s3, 49152
s_lshl_b32 s29, s3, 17
s_mov_b32 s27, 0
s_bfe_u32 s25, s2, 0x10003
s_mul_i32 s98, s25, 10240
s_mov_b32 s10, 131072
s_mov_b32 s11, 0x20000
s_mov_b32 s18, 49152
s_mov_b32 s19, 0x20000
v_mov_b32 v26, 0xff800000
v_mov_b32 v27, 0xff800000
v_mov_b32 v28, 0xff800000
v_and_b32 v20, 7, v1
v_bfe_u32 v21, v1, 3, 1
v_lshrrev_b32 v22, 4, v1
v_mul_u32_u24 v20, 1056, v20
v_lshl_add_u32 v20, v21, 8, v20
v_lshl_add_u32 v6, v22, 4, v20
v_add_u32 v7, 59136, v6
v_add_u32 v8, 118272, v6
v_bfe_u32 v20, v1, 2, 3
v_lshrrev_b32 v21, 5, v1
v_and_b32 v23, 3, v1
v_bfe_u32 v24, v1, 4, 1
v_mul_u32_u24 v20, 1032, v20
v_mul_u32_u24 v24, 96, v24
v_lshl_add_u32 v20, v23, 5, v20
v_add_u32 v20, v20, v24
v_lshl_add_u32 v9, v21, 8, v20
v_add_u32 v10, 59136, v9
v_add_u32 v11, 118272, v9
v_lshl_add_u32 v12, v21, 7, v20
v_add_u32 v12, 76032, v12
v_bfe_u32 v20, v1, 3, 1
v_bfe_u32 v24, v1, 4, 1
v_and_b32 v25, 7, v1
v_lshl_add_u32 v20, v20, 8, s21
v_lshl_add_u32 v20, v24, 9, v20
v_lshl_add_u32 v20, v21, 11, v20
v_lshl_add_u32 v4, v25, 4, v20
s_and_b32 s25, s98, 2048
s_andn2_b32 s101, s98, 2048
v_xor_b32 v4, s25, v4
v_bfe_u32 v20, v1, 2, 2
v_mul_u32_u24 v20, 1056, v20
v_lshl_add_u32 v20, v23, 8, v20
v_lshl_add_u32 v20, v22, 4, v20
v_add_u32 v20, s26, v20
v_add_u32 v20, 109824, v20
v_xor_b32 v21, 0, v23
v_lshl_add_u32 v16, v21, 6, v20
v_xor_b32 v21, 1, v23
v_lshl_add_u32 v17, v21, 6, v20
v_xor_b32 v21, 2, v23
v_lshl_add_u32 v18, v21, 6, v20
v_xor_b32 v21, 3, v23
v_lshl_add_u32 v19, v21, 6, v20
v_and_b32 v20, 15, v1
v_cmp_eq_u32 vcc, 0, v23
v_and_b32 v20, 14, v1
v_and_b32 v21, 1, v1
v_lshlrev_b32 v20, 8, v20
v_lshl_add_u32 v20, v22, 5, v20
v_lshl_add_u32 v5, v21, 4, v20
s_mov_b32 s22, 0x53800000
s_mov_b32 s30, 0x3e0293ee
s_mov_b32 s31, 0x3e0293ee
v_mov_b32 v20, 0x3f803f80
v_cndmask_b32 v20, 0, v20, vcc
v_accvgpr_write_b32 a32, v20
v_accvgpr_write_b32 a33, v20
v_accvgpr_write_b32 a34, v20
v_accvgpr_write_b32 a35, v20
v_mov_b32 v15, 160512
s_waitcnt lgkmcnt(0)
s_add_u32 s8, s6, s29
s_addc_u32 s9, s7, 0
s_add_u32 s4, s4, s28
s_addc_u32 s5, s5, 0
s_mov_b32 s6, 49152
s_mov_b32 s7, 0x20000
s_add_u32 s16, s14, s28
s_addc_u32 s17, s15, 0
s_add_u32 s12, s12, s29
s_addc_u32 s13, s13, 0
s_mov_b32 s14, 131072
s_mov_b32 s15, 0x20000
L_restart:
s_add_u32 m0, s26, 109824
s_nop 0
buffer_load_dwordx4 v3, s[4:7], s93 offen offset:0 nt lds
s_add_u32 m0, m0, 32
s_nop 0
buffer_load_dwordx4 v3, s[4:7], s93 offen offset:1024 nt lds
s_add_u32 m0, m0, 32
s_nop 0
buffer_load_dwordx4 v3, s[4:7], s93 offen offset:2048 nt lds
s_add_u32 m0, m0, 32
s_nop 0
buffer_load_dwordx4 v3, s[4:7], s93 offen offset:3072 nt lds
s_xor_b32 s24, s98, 0
s_add_u32 m0, s23, 0
s_nop 0
buffer_load_dwordx4 v2, s[8:11], s24 offen offset:0 nt lds
s_add_u32 m0, m0, 32
s_nop 0
buffer_load_dwordx4 v2, s[8:11], s24 offen offset:1024 nt lds
s_add_u32 m0, s26, 114048
s_nop 0
buffer_load_dwordx4 v3, s[4:7], s99 offen offset:0 nt lds
s_add_u32 m0, m0, 32
s_nop 0
buffer_load_dwordx4 v3, s[4:7], s99 offen offset:1024 nt lds
s_add_u32 m0, m0, 32
s_nop 0
buffer_load_dwordx4 v3, s[4:7], s99 offen offset:2048 nt lds
s_add_u32 m0, m0, 32
s_nop 0
buffer_load_dwordx4 v3, s[4:7], s99 offen offset:3072 nt lds
s_lshr_b32 s25, s20, 1
s_mul_i32 s29, s20, 2064
s_mul_i32 s25, s25, 96
s_add_u32 s29, s29, s25
s_cmp_eq_u32 s92, 1
s_cbranch_scc1 L_touch_a1
s_cmp_eq_u32 s92, 2
s_cbranch_scc1 L_touch_a2
s_cmp_eq_u32 s20, 0
s_cbranch_scc1 L_touch0
s_cmp_eq_u32 s20, 1
s_cbranch_scc1 L_touch1
s_cmp_eq_u32 s20, 2
s_cbranch_scc1 L_touch2
s_cmp_eq_u32 s20, 3
s_cbranch_scc1 L_touch3
L_touch_a1:
s_cmp_eq_u32 s20, 0
s_cbranch_scc1 L_touch0_o1
s_cmp_eq_u32 s20, 1
s_cbranch_scc1 L_touch1_o1
s_cmp_eq_u32 s20, 2
s_cbranch_scc1 L_touch2_o1
s_cmp_eq_u32 s20, 3
s_cbranch_scc1 L_touch3_o1
L_touch_a2:
s_cmp_eq_u32 s20, 0
s_cbranch_scc1 L_touch0_o2
s_cmp_eq_u32 s20, 1
s_cbranch_scc1 L_touch1_o2
s_cmp_eq_u32 s20, 2
s_cbranch_scc1 L_touch2_o2
s_cmp_eq_u32 s20, 3
s_cbranch_scc1 L_touch3_o2
L_touch_ret:
s_cmp_lg_u32 s20, s20
s_add_u32 m0, s26, 118272
s_nop 0
buffer_load_dwordx4 v3, s[4:7], s100 offen offset:0 nt lds
s_add_u32 m0, m0, 32
s_nop 0
buffer_load_dwordx4 v3, s[4:7], s100 offen offset:1024 nt lds
s_add_u32 m0, m0, 32
s_nop 0
buffer_load_dwordx4 v3, s[4:7], s100 offen offset:2048 nt lds
s_add_u32 m0, m0, 32
s_nop 0
buffer_load_dwordx4 v3, s[4:7], s100 offen offset:3072 nt lds
v_mov_b32 v20, 0
ds_write_b32 v15, v20 offset:0
s_waitcnt vmcnt(10)
ds_read_b128 v[44:47], v16 offset:0
ds_read_b128 v[48:51], v17 offset:0
ds_read_b128 v[52:55], v18 offset:0
ds_read_b128 v[56:59], v19 offset:0
s_xor_b32 s24, s98, 2048
s_add_u32 m0, s23, 8448
s_nop 0
buffer_load_dwordx4 v2, s[8:11], s24 offen offset:0 nt lds
s_add_u32 m0, m0, 32
s_nop 0
buffer_load_dwordx4 v2, s[8:11], s24 offen offset:1024 nt lds
s_waitcnt lgkmcnt(3)
v_lshlrev_b32 v20, 16, v44
v_and_b32 v21, 0xffff0000, v44
v_pk_mul_f32 v[20:21], v[20:21], s[30:31]
v_cvt_pk_bf16_f32 v44, v20, v21
v_accvgpr_write_b32 a0, v44
v_lshlrev_b32 v22, 16, v45
v_and_b32 v23, 0xffff0000, v45
v_pk_mul_f32 v[22:23], v[22:23], s[30:31]
v_cvt_pk_bf16_f32 v45, v22, v23
v_accvgpr_write_b32 a1, v45
v_lshlrev_b32 v20, 16, v46
v_and_b32 v21, 0xffff0000, v46
v_pk_mul_f32 v[20:21], v[20:21], s[30:31]
v_cvt_pk_bf16_f32 v46, v20, v21
v_accvgpr_write_b32 a2, v46
v_lshlrev_b32 v22, 16, v47
v_and_b32 v23, 0xffff0000, v47
v_pk_mul_f32 v[22:23], v[22:23], s[30:31]
v_cvt_pk_bf16_f32 v47, v22, v23
v_accvgpr_write_b32 a3, v47
s_waitcnt lgkmcnt(2)
v_lshlrev_b32 v20, 16, v48
v_and_b32 v21, 0xffff0000, v48
v_pk_mul_f32 v[20:21], v[20:21], s[30:31]
v_cvt_pk_bf16_f32 v48, v20, v21
v_accvgpr_write_b32 a4, v48
v_lshlrev_b32 v22, 16, v49
v_and_b32 v23, 0xffff0000, v49
v_pk_mul_f32 v[22:23], v[22:23], s[30:31]
v_cvt_pk_bf16_f32 v49, v22, v23
v_accvgpr_write_b32 a5, v49
v_lshlrev_b32 v20, 16, v50
v_and_b32 v21, 0xffff0000, v50
v_pk_mul_f32 v[20:21], v[20:21], s[30:31]
v_cvt_pk_bf16_f32 v50, v20, v21
v_accvgpr_write_b32 a6, v50
v_lshlrev_b32 v22, 16, v51
v_and_b32 v23, 0xffff0000, v51
v_pk_mul_f32 v[22:23], v[22:23], s[30:31]
v_cvt_pk_bf16_f32 v51, v22, v23
v_accvgpr_write_b32 a7, v51
s_waitcnt lgkmcnt(1)
v_lshlrev_b32 v20, 16, v52
v_and_b32 v21, 0xffff0000, v52
v_pk_mul_f32 v[20:21], v[20:21], s[30:31]
v_cvt_pk_bf16_f32 v52, v20, v21
v_accvgpr_write_b32 a8, v52
v_lshlrev_b32 v22, 16, v53
v_and_b32 v23, 0xffff0000, v53
v_pk_mul_f32 v[22:23], v[22:23], s[30:31]
v_cvt_pk_bf16_f32 v53, v22, v23
v_accvgpr_write_b32 a9, v53
v_lshlrev_b32 v20, 16, v54
v_and_b32 v21, 0xffff0000, v54
v_pk_mul_f32 v[20:21], v[20:21], s[30:31]
v_cvt_pk_bf16_f32 v54, v20, v21
v_accvgpr_write_b32 a10, v54
v_lshlrev_b32 v22, 16, v55
v_and_b32 v23, 0xffff0000, v55
v_pk_mul_f32 v[22:23], v[22:23], s[30:31]
v_cvt_pk_bf16_f32 v55, v22, v23
v_accvgpr_write_b32 a11, v55
s_waitcnt lgkmcnt(0)
v_lshlrev_b32 v20, 16, v56
v_and_b32 v21, 0xffff0000, v56
v_pk_mul_f32 v[20:21], v[20:21], s[30:31]
v_cvt_pk_bf16_f32 v56, v20, v21
v_accvgpr_write_b32 a12, v56
v_lshlrev_b32 v22, 16, v57
v_and_b32 v23, 0xffff0000, v57
v_pk_mul_f32 v[22:23], v[22:23], s[30:31]
v_cvt_pk_bf16_f32 v57, v22, v23
v_accvgpr_write_b32 a13, v57
v_lshlrev_b32 v20, 16, v58
v_and_b32 v21, 0xffff0000, v58
v_pk_mul_f32 v[20:21], v[20:21], s[30:31]
v_cvt_pk_bf16_f32 v58, v20, v21
v_accvgpr_write_b32 a14, v58
v_lshlrev_b32 v22, 16, v59
v_and_b32 v23, 0xffff0000, v59
v_pk_mul_f32 v[22:23], v[22:23], s[30:31]
v_cvt_pk_bf16_f32 v59, v22, v23
v_accvgpr_write_b32 a15, v59
s_waitcnt vmcnt(10)
s_barrier
ds_read_b128 a[36:39], v6 offset:0
ds_read_b128 a[52:55], v6 offset:512
ds_read_b128 a[40:43], v6 offset:64
ds_read_b128 a[56:59], v6 offset:576
ds_read_b128 a[44:47], v6 offset:128
ds_read_b128 a[60:63], v6 offset:640
ds_read_b128 a[48:51], v6 offset:192
ds_read_b128 a[64:67], v6 offset:704
s_waitcnt lgkmcnt(7)
v_mfma_f32_16x16x32_bf16 v[152:155], a[36:39], a[0:3], 0
s_waitcnt lgkmcnt(5)
v_mfma_f32_16x16x32_bf16 v[152:155], a[40:43], a[4:7], v[152:155]
s_waitcnt lgkmcnt(3)
v_mfma_f32_16x16x32_bf16 v[152:155], a[44:47], a[8:11], v[152:155]
s_waitcnt lgkmcnt(1)
v_mfma_f32_16x16x32_bf16 v[152:155], a[48:51], a[12:15], v[152:155]
s_waitcnt lgkmcnt(0)
v_mfma_f32_16x16x32_bf16 v[156:159], a[64:67], a[12:15], 0
v_mfma_f32_16x16x32_bf16 v[156:159], a[60:63], a[8:11], v[156:159]
v_mfma_f32_16x16x32_bf16 v[156:159], a[56:59], a[4:7], v[156:159]
v_mfma_f32_16x16x32_bf16 v[156:159], a[52:55], a[0:3], v[156:159]
v_max3_f32 v24, v152, v153, v154
s_nop 6
v_max3_f32 v25, v155, v156, v157
v_max3_f32 v24, v24, v158, v159
v_max3_f32 v24, v24, v25, v26
v_mov_b32 v25, v24
s_nop 1
v_permlane32_swap_b32 v24, v25
v_max_f32 v24, v24, v25
v_mov_b32 v25, v24
s_nop 1
v_permlane16_swap_b32 v24, v25
v_max_f32 v24, v24, v25
v_sub_f32 v152, v152, v24
v_sub_f32 v153, v153, v24
v_sub_f32 v154, v154, v24
v_sub_f32 v155, v155, v24
v_sub_f32 v156, v156, v24
v_sub_f32 v157, v157, v24
v_sub_f32 v158, v158, v24
v_sub_f32 v159, v159, v24
v_sub_f32 v32, 0, v24
v_sub_f32 v33, 0, v24
v_sub_f32 v34, 0, v24
v_sub_f32 v35, 0, v24
v_exp_f32 v152, v152
v_exp_f32 v153, v153
v_exp_f32 v154, v154
v_exp_f32 v155, v155
v_exp_f32 v156, v156
v_exp_f32 v157, v157
v_exp_f32 v158, v158
v_exp_f32 v159, v159
v_cvt_pk_bf16_f32 v176, v152, v153
v_cvt_pk_bf16_f32 v177, v154, v155
v_cvt_pk_bf16_f32 v178, v156, v157
v_cvt_pk_bf16_f32 v179, v158, v159
s_waitcnt vmcnt(6)
ds_read_b128 v[76:79], v16 offset:4224
ds_read_b128 v[80:83], v17 offset:4224
ds_read_b128 v[84:87], v18 offset:4224
ds_read_b128 v[88:91], v19 offset:4224
s_waitcnt lgkmcnt(3)
v_lshlrev_b32 v20, 16, v76
v_and_b32 v21, 0xffff0000, v76
v_pk_mul_f32 v[20:21], v[20:21], s[30:31]
v_cvt_pk_bf16_f32 v76, v20, v21
v_accvgpr_write_b32 a16, v76
v_lshlrev_b32 v22, 16, v77
v_and_b32 v23, 0xffff0000, v77
v_pk_mul_f32 v[22:23], v[22:23], s[30:31]
v_cvt_pk_bf16_f32 v77, v22, v23
v_accvgpr_write_b32 a17, v77
v_lshlrev_b32 v20, 16, v78
v_and_b32 v21, 0xffff0000, v78
v_pk_mul_f32 v[20:21], v[20:21], s[30:31]
v_cvt_pk_bf16_f32 v78, v20, v21
v_accvgpr_write_b32 a18, v78
v_lshlrev_b32 v22, 16, v79
v_and_b32 v23, 0xffff0000, v79
v_pk_mul_f32 v[22:23], v[22:23], s[30:31]
v_cvt_pk_bf16_f32 v79, v22, v23
v_accvgpr_write_b32 a19, v79
s_waitcnt lgkmcnt(2)
v_lshlrev_b32 v20, 16, v80
v_and_b32 v21, 0xffff0000, v80
v_pk_mul_f32 v[20:21], v[20:21], s[30:31]
v_cvt_pk_bf16_f32 v80, v20, v21
v_accvgpr_write_b32 a20, v80
v_lshlrev_b32 v22, 16, v81
v_and_b32 v23, 0xffff0000, v81
v_pk_mul_f32 v[22:23], v[22:23], s[30:31]
v_cvt_pk_bf16_f32 v81, v22, v23
v_accvgpr_write_b32 a21, v81
v_lshlrev_b32 v20, 16, v82
v_and_b32 v21, 0xffff0000, v82
v_pk_mul_f32 v[20:21], v[20:21], s[30:31]
v_cvt_pk_bf16_f32 v82, v20, v21
v_accvgpr_write_b32 a22, v82
v_lshlrev_b32 v22, 16, v83
v_and_b32 v23, 0xffff0000, v83
v_pk_mul_f32 v[22:23], v[22:23], s[30:31]
v_cvt_pk_bf16_f32 v83, v22, v23
v_accvgpr_write_b32 a23, v83
s_waitcnt lgkmcnt(1)
v_lshlrev_b32 v20, 16, v84
v_and_b32 v21, 0xffff0000, v84
v_pk_mul_f32 v[20:21], v[20:21], s[30:31]
v_cvt_pk_bf16_f32 v84, v20, v21
v_accvgpr_write_b32 a24, v84
v_lshlrev_b32 v22, 16, v85
v_and_b32 v23, 0xffff0000, v85
v_pk_mul_f32 v[22:23], v[22:23], s[30:31]
v_cvt_pk_bf16_f32 v85, v22, v23
v_accvgpr_write_b32 a25, v85
v_lshlrev_b32 v20, 16, v86
v_and_b32 v21, 0xffff0000, v86
v_pk_mul_f32 v[20:21], v[20:21], s[30:31]
v_cvt_pk_bf16_f32 v86, v20, v21
v_accvgpr_write_b32 a26, v86
v_lshlrev_b32 v22, 16, v87
v_and_b32 v23, 0xffff0000, v87
v_pk_mul_f32 v[22:23], v[22:23], s[30:31]
v_cvt_pk_bf16_f32 v87, v22, v23
v_accvgpr_write_b32 a27, v87
s_waitcnt lgkmcnt(0)
v_lshlrev_b32 v20, 16, v88
v_and_b32 v21, 0xffff0000, v88
v_pk_mul_f32 v[20:21], v[20:21], s[30:31]
v_cvt_pk_bf16_f32 v88, v20, v21
v_accvgpr_write_b32 a28, v88
v_lshlrev_b32 v22, 16, v89
v_and_b32 v23, 0xffff0000, v89
v_pk_mul_f32 v[22:23], v[22:23], s[30:31]
v_cvt_pk_bf16_f32 v89, v22, v23
v_accvgpr_write_b32 a29, v89
v_lshlrev_b32 v20, 16, v90
v_and_b32 v21, 0xffff0000, v90
v_pk_mul_f32 v[20:21], v[20:21], s[30:31]
v_cvt_pk_bf16_f32 v90, v20, v21
v_accvgpr_write_b32 a30, v90
v_lshlrev_b32 v22, 16, v91
v_and_b32 v23, 0xffff0000, v91
v_pk_mul_f32 v[22:23], v[22:23], s[30:31]
v_cvt_pk_bf16_f32 v91, v22, v23
v_accvgpr_write_b32 a31, v91
v_mfma_f32_16x16x32_bf16 v[160:163], a[36:39], a[16:19], 0
v_mfma_f32_16x16x32_bf16 v[160:163], a[40:43], a[20:23], v[160:163]
v_mfma_f32_16x16x32_bf16 v[160:163], a[44:47], a[24:27], v[160:163]
v_mfma_f32_16x16x32_bf16 v[160:163], a[48:51], a[28:31], v[160:163]
v_mfma_f32_16x16x32_bf16 v[164:167], a[64:67], a[28:31], 0
v_mfma_f32_16x16x32_bf16 v[164:167], a[60:63], a[24:27], v[164:167]
v_mfma_f32_16x16x32_bf16 v[164:167], a[56:59], a[20:23], v[164:167]
v_mfma_f32_16x16x32_bf16 v[164:167], a[52:55], a[16:19], v[164:167]
v_max3_f32 v24, v160, v161, v162
s_nop 6
v_max3_f32 v25, v163, v164, v165
v_max3_f32 v24, v24, v166, v167
v_max3_f32 v24, v24, v25, v27
v_mov_b32 v25, v24
s_nop 1
v_permlane32_swap_b32 v24, v25
v_max_f32 v24, v24, v25
v_mov_b32 v25, v24
s_nop 1
v_permlane16_swap_b32 v24, v25
v_max_f32 v24, v24, v25
v_sub_f32 v160, v160, v24
v_sub_f32 v161, v161, v24
v_sub_f32 v162, v162, v24
v_sub_f32 v163, v163, v24
v_sub_f32 v164, v164, v24
v_sub_f32 v165, v165, v24
v_sub_f32 v166, v166, v24
v_sub_f32 v167, v167, v24
v_sub_f32 v36, 0, v24
v_sub_f32 v37, 0, v24
v_sub_f32 v38, 0, v24
v_sub_f32 v39, 0, v24
v_exp_f32 v160, v160
v_exp_f32 v161, v161
v_exp_f32 v162, v162
v_exp_f32 v163, v163
v_exp_f32 v164, v164
v_exp_f32 v165, v165
v_exp_f32 v166, v166
v_exp_f32 v167, v167
v_cvt_pk_bf16_f32 v196, v160, v161
v_cvt_pk_bf16_f32 v197, v162, v163
v_cvt_pk_bf16_f32 v198, v164, v165
v_cvt_pk_bf16_f32 v199, v166, v167
v_mfma_f32_16x16x32_bf16 v[140:143], a[32:35], v[176:179], 0
v_mfma_f32_16x16x32_bf16 v[144:147], a[32:35], v[196:199], 0
s_waitcnt vmcnt(2)
ds_read_b128 v[236:239], v16 offset:8448
ds_read_b128 v[240:243], v17 offset:8448
ds_read_b128 v[244:247], v18 offset:8448
ds_read_b128 v[248:251], v19 offset:8448
s_xor_b32 s24, s98, 4096
s_add_u32 m0, s23, 16896
s_nop 0
buffer_load_dwordx4 v2, s[8:11], s24 offen offset:0 nt lds
s_add_u32 m0, m0, 32
s_nop 0
buffer_load_dwordx4 v2, s[8:11], s24 offen offset:1024 nt lds
s_waitcnt lgkmcnt(3)
v_lshlrev_b32 v20, 16, v236
v_and_b32 v21, 0xffff0000, v236
v_pk_mul_f32 v[20:21], v[20:21], s[30:31]
v_cvt_pk_bf16_f32 v236, v20, v21
v_lshlrev_b32 v22, 16, v237
v_and_b32 v23, 0xffff0000, v237
v_pk_mul_f32 v[22:23], v[22:23], s[30:31]
v_cvt_pk_bf16_f32 v237, v22, v23
v_lshlrev_b32 v20, 16, v238
v_and_b32 v21, 0xffff0000, v238
v_pk_mul_f32 v[20:21], v[20:21], s[30:31]
v_cvt_pk_bf16_f32 v238, v20, v21
v_lshlrev_b32 v22, 16, v239
v_and_b32 v23, 0xffff0000, v239
v_pk_mul_f32 v[22:23], v[22:23], s[30:31]
v_cvt_pk_bf16_f32 v239, v22, v23
s_waitcnt lgkmcnt(2)
v_lshlrev_b32 v20, 16, v240
v_and_b32 v21, 0xffff0000, v240
v_pk_mul_f32 v[20:21], v[20:21], s[30:31]
v_cvt_pk_bf16_f32 v240, v20, v21
v_lshlrev_b32 v22, 16, v241
v_and_b32 v23, 0xffff0000, v241
v_pk_mul_f32 v[22:23], v[22:23], s[30:31]
v_cvt_pk_bf16_f32 v241, v22, v23
v_lshlrev_b32 v20, 16, v242
v_and_b32 v21, 0xffff0000, v242
s_cmp_eq_u32 s92, 1
s_cbranch_scc1 L_odd1
s_cmp_eq_u32 s92, 2
s_cbranch_scc1 L_odd2
v_pk_mul_f32 v[20:21], v[20:21], s[30:31]
L_touch0:
s_cbranch_scc1 L_touch_ret
v_cvt_pk_bf16_f32 v242, v20, v21
s_xor_b32 s24, s98, 6144
s_add_u32 m0, s23, 25344
s_nop 0
buffer_load_dwordx4 v2, s[8:11], s24 offen offset:0 nt lds
v_lshlrev_b32 v22, 16, v243
v_and_b32 v23, 0xffff0000, v243
v_pk_mul_f32 v[22:23], v[22:23], s[30:31]
v_cvt_pk_bf16_f32 v243, v22, v23
s_waitcnt lgkmcnt(1)
v_lshlrev_b32 v20, 16, v244
v_and_b32 v21, 0xffff0000, v244
v_pk_mul_f32 v[20:21], v[20:21], s[30:31]
v_cvt_pk_bf16_f32 v244, v20, v21
v_lshlrev_b32 v22, 16, v245
v_and_b32 v23, 0xffff0000, v245
v_pk_mul_f32 v[22:23], v[22:23], s[30:31]
v_cvt_pk_bf16_f32 v245, v22, v23
v_lshlrev_b32 v20, 16, v246
v_and_b32 v21, 0xffff0000, v246
v_pk_mul_f32 v[20:21], v[20:21], s[30:31]
v_cvt_pk_bf16_f32 v246, v20, v21
s_add_u32 m0, m0, 32
s_nop 0
buffer_load_dwordx4 v2, s[8:11], s24 offen offset:1024 nt lds
v_lshlrev_b32 v22, 16, v247
v_and_b32 v23, 0xffff0000, v247
v_pk_mul_f32 v[22:23], v[22:23], s[30:31]
v_cvt_pk_bf16_f32 v247, v22, v23
s_waitcnt lgkmcnt(0)
v_lshlrev_b32 v20, 16, v248
v_and_b32 v21, 0xffff0000, v248
v_pk_mul_f32 v[20:21], v[20:21], s[30:31]
v_cvt_pk_bf16_f32 v248, v20, v21
v_lshlrev_b32 v22, 16, v249
v_and_b32 v23, 0xffff0000, v249
v_pk_mul_f32 v[22:23], v[22:23], s[30:31]
v_cvt_pk_bf16_f32 v249, v22, v23
v_lshlrev_b32 v20, 16, v250
v_and_b32 v21, 0xffff0000, v250
v_pk_mul_f32 v[20:21], v[20:21], s[30:31]
v_cvt_pk_bf16_f32 v250, v20, v21
v_lshlrev_b32 v22, 16, v251
v_and_b32 v23, 0xffff0000, v251
v_pk_mul_f32 v[22:23], v[22:23], s[30:31]
v_cvt_pk_bf16_f32 v251, v22, v23
s_waitcnt vmcnt(4)
s_barrier
ds_read_b128 a[68:71], v6 offset:8448
ds_read_b128 a[72:75], v6 offset:8512
v_mfma_f32_16x16x32_bf16 v[168:171], a[36:39], v[236:239], 0
ds_read_b128 a[76:79], v6 offset:8576
v_mfma_f32_16x16x32_bf16 v[168:171], a[40:43], v[240:243], v[168:171]
ds_read_b128 a[80:83], v6 offset:8640
v_mfma_f32_16x16x32_bf16 v[168:171], a[44:47], v[244:247], v[168:171]
ds_read_b128 a[96:99], v6 offset:9152
v_mfma_f32_16x16x32_bf16 v[168:171], a[48:51], v[248:251], v[168:171]
ds_read_b128 a[92:95], v6 offset:9088
v_mfma_f32_16x16x32_bf16 v[172:175], a[64:67], v[248:251], 0
ds_read_b128 a[88:91], v6 offset:9024
v_mfma_f32_16x16x32_bf16 v[172:175], a[60:63], v[244:247], v[172:175]
ds_read_b128 a[84:87], v6 offset:8960
v_mfma_f32_16x16x32_bf16 v[172:175], a[56:59], v[240:243], v[172:175]
v_mfma_f32_16x16x32_bf16 v[172:175], a[52:55], v[236:239], v[172:175]
v_max3_f32 v24, v168, v169, v170
s_nop 6
v_max3_f32 v25, v171, v172, v173
v_max3_f32 v24, v24, v174, v175
v_max3_f32 v24, v24, v25, v28
v_mov_b32 v25, v24
s_nop 1
v_permlane32_swap_b32 v24, v25
v_max_f32 v24, v24, v25
v_mov_b32 v25, v24
s_nop 1
v_permlane16_swap_b32 v24, v25
v_max_f32 v24, v24, v25
v_sub_f32 v168, v168, v24
v_sub_f32 v169, v169, v24
v_sub_f32 v170, v170, v24
v_sub_f32 v171, v171, v24
v_sub_f32 v172, v172, v24
v_sub_f32 v173, v173, v24
v_sub_f32 v174, v174, v24
v_sub_f32 v175, v175, v24
v_sub_f32 v40, 0, v24
v_sub_f32 v41, 0, v24
v_sub_f32 v42, 0, v24
v_sub_f32 v43, 0, v24
s_waitcnt lgkmcnt(0)
v_mfma_f32_16x16x32_bf16 v[152:155], a[68:71], a[0:3], v[32:35]
s_xor_b32 s24, s98, 8192
v_exp_f32 v168, v168
v_mfma_f32_16x16x32_bf16 v[152:155], a[72:75], a[4:7], v[152:155]
s_add_u32 m0, s23, 33792
v_exp_f32 v169, v169
v_mfma_f32_16x16x32_bf16 v[152:155], a[76:79], a[8:11], v[152:155]
v_exp_f32 v170, v170
v_exp_f32 v171, v171
v_mfma_f32_16x16x32_bf16 v[152:155], a[80:83], a[12:15], v[152:155]
v_exp_f32 v172, v172
v_cvt_pk_bf16_f32 v216, v168, v169
v_mfma_f32_16x16x32_bf16 v[156:159], a[96:99], a[12:15], v[32:35]
v_exp_f32 v173, v173
v_cvt_pk_bf16_f32 v217, v170, v171
v_mfma_f32_16x16x32_bf16 v[156:159], a[92:95], a[8:11], v[156:159]
v_exp_f32 v174, v174
v_cvt_pk_bf16_f32 v218, v172, v173
v_mfma_f32_16x16x32_bf16 v[156:159], a[88:91], a[4:7], v[156:159]
v_exp_f32 v175, v175
v_mfma_f32_16x16x32_bf16 v[156:159], a[84:87], a[0:3], v[156:159]
v_cvt_pk_bf16_f32 v219, v174, v175
v_mfma_f32_16x16x32_bf16 v[164:167], a[84:87], a[16:19], v[36:39]
v_mfma_f32_16x16x32_bf16 v[164:167], a[88:91], a[20:23], v[164:167]
buffer_load_dwordx4 v2, s[8:11], s24 offen offset:0 nt lds
v_mfma_f32_16x16x32_bf16 v[164:167], a[92:95], a[24:27], v[164:167]
s_add_u32 m0, m0, 32
v_exp_f32 v152, v152
v_exp_f32 v153, v153
v_exp_f32 v154, v154
v_mfma_f32_16x16x32_bf16 v[164:167], a[96:99], a[28:31], v[164:167]
buffer_load_dwordx4 v2, s[8:11], s24 offen offset:1024 nt lds
v_exp_f32 v155, v155
v_mfma_f32_16x16x32_bf16 v[160:163], a[80:83], a[28:31], v[36:39]
s_xor_b32 s24, s98, 10240
v_exp_f32 v156, v156
v_cvt_pk_bf16_f32 v180, v152, v153
v_mfma_f32_16x16x32_bf16 v[160:163], a[76:79], a[24:27], v[160:163]
s_add_u32 m0, s23, 42240
v_exp_f32 v157, v157
v_cvt_pk_bf16_f32 v181, v154, v155
v_mfma_f32_16x16x32_bf16 v[160:163], a[72:75], a[20:23], v[160:163]
v_exp_f32 v158, v158
v_cvt_pk_bf16_f32 v182, v156, v157
v_mfma_f32_16x16x32_bf16 v[160:163], a[68:71], a[16:19], v[160:163]
v_exp_f32 v159, v159
v_mfma_f32_16x16x32_bf16 v[168:171], a[68:71], v[236:239], v[40:43]
v_cvt_pk_bf16_f32 v183, v158, v159
v_mfma_f32_16x16x32_bf16 v[168:171], a[72:75], v[240:243], v[168:171]
v_mfma_f32_16x16x32_bf16 v[168:171], a[76:79], v[244:247], v[168:171]
buffer_load_dwordx4 v2, s[8:11], s24 offen offset:0 nt lds
v_exp_f32 v164, v164
v_exp_f32 v165, v165
v_mfma_f32_16x16x32_bf16 v[168:171], a[80:83], v[248:251], v[168:171]
s_add_u32 m0, m0, 32
v_exp_f32 v166, v166
v_cvt_pk_bf16_f32 v202, v164, v165
v_mfma_f32_16x16x32_bf16 v[172:175], a[96:99], v[248:251], v[40:43]
v_exp_f32 v167, v167
v_mfma_f32_16x16x32_bf16 v[172:175], a[92:95], v[244:247], v[172:175]
v_exp_f32 v160, v160
v_exp_f32 v161, v161
v_mfma_f32_16x16x32_bf16 v[172:175], a[88:91], v[240:243], v[172:175]
s_waitcnt vmcnt(5)
s_barrier
v_mfma_f32_16x16x32_bf16 v[172:175], a[84:87], v[236:239], v[172:175]
ds_read_b128 a[36:39], v6 offset:16896
ds_read_b128 a[40:43], v6 offset:16960
ds_read_b128 a[44:47], v6 offset:17024
ds_read_b128 a[48:51], v6 offset:17088
ds_read_b128 a[64:67], v6 offset:17600
buffer_load_dwordx4 v2, s[8:11], s24 offen offset:1024 nt lds
v_exp_f32 v162, v162
v_cvt_pk_bf16_f32 v203, v166, v167
v_cvt_pk_bf16_f32 v200, v160, v161
v_mfma_f32_16x16x32_bf16 v[148:151], a[32:35], v[216:219], 0
s_waitcnt lgkmcnt(4)
v_exp_f32 v163, v163
v_mfma_f32_16x16x32_bf16 v[152:155], a[36:39], a[0:3], v[32:35]
s_waitcnt lgkmcnt(3)
v_cvt_pk_bf16_f32 v201, v162, v163
v_mfma_f32_16x16x32_bf16 v[152:155], a[40:43], a[4:7], v[152:155]
s_waitcnt lgkmcnt(2)
v_exp_f32 v168, v168
v_exp_f32 v169, v169
v_exp_f32 v170, v170
v_exp_f32 v171, v171
v_exp_f32 v172, v172
v_exp_f32 v173, v173
v_exp_f32 v174, v174
v_exp_f32 v175, v175
v_mfma_f32_16x16x32_bf16 v[152:155], a[44:47], a[8:11], v[152:155]
s_waitcnt lgkmcnt(1)
s_xor_b32 s24, s98, 0
s_add_u32 m0, s29, 50688
v_cvt_pk_bf16_f32 v220, v168, v169
v_cvt_pk_bf16_f32 v221, v170, v171
v_cvt_pk_bf16_f32 v222, v172, v173
v_cvt_pk_bf16_f32 v223, v174, v175
v_mfma_f32_16x16x32_bf16 v[152:155], a[48:51], a[12:15], v[152:155]
s_waitcnt lgkmcnt(0)
buffer_load_dwordx4 v2, s[12:15], s24 offen offset:0 nt lds
v_mfma_f32_16x16x32_bf16 v[156:159], a[64:67], a[12:15], v[32:35]
s_add_u32 m0, m0, 8
ds_read_b128 a[60:63], v6 offset:17536
s_waitcnt lgkmcnt(0)
ds_read_b128 a[56:59], v6 offset:17472
ds_read_b128 a[52:55], v6 offset:17408
v_mfma_f32_16x16x32_bf16 v[156:159], a[60:63], a[8:11], v[156:159]
s_waitcnt lgkmcnt(1)
buffer_load_dwordx4 v2, s[12:15], s24 offen offset:1024 nt lds
v_mfma_f32_16x16x32_bf16 v[156:159], a[56:59], a[4:7], v[156:159]
s_waitcnt lgkmcnt(0)
v_mfma_f32_16x16x32_bf16 v[156:159], a[52:55], a[0:3], v[156:159]
s_xor_b32 s24, s98, 12288
v_mfma_f32_16x16x32_bf16 v[164:167], a[52:55], a[16:19], v[36:39]
s_add_u32 m0, s23, 59136
v_mfma_f32_16x16x32_bf16 v[164:167], a[56:59], a[20:23], v[164:167]
v_mfma_f32_16x16x32_bf16 v[164:167], a[60:63], a[24:27], v[164:167]
v_exp_f32 v152, v152
v_exp_f32 v153, v153
v_exp_f32 v154, v154
v_exp_f32 v155, v155
v_exp_f32 v156, v156
v_exp_f32 v157, v157
v_exp_f32 v158, v158
v_exp_f32 v159, v159
v_mfma_f32_16x16x32_bf16 v[164:167], a[64:67], a[28:31], v[164:167]
v_cvt_pk_bf16_f32 v184, v152, v153
v_cvt_pk_bf16_f32 v185, v154, v155
v_cvt_pk_bf16_f32 v186, v156, v157
v_cvt_pk_bf16_f32 v187, v158, v159
v_mfma_f32_16x16x32_bf16 v[160:163], a[48:51], a[28:31], v[36:39]
v_mfma_f32_16x16x32_bf16 v[160:163], a[44:47], a[24:27], v[160:163]
v_mfma_f32_16x16x32_bf16 v[160:163], a[40:43], a[20:23], v[160:163]
v_mfma_f32_16x16x32_bf16 v[160:163], a[36:39], a[16:19], v[160:163]
v_mfma_f32_16x16x32_bf16 v[168:171], a[36:39], v[236:239], v[40:43]
v_mfma_f32_16x16x32_bf16 v[168:171], a[40:43], v[240:243], v[168:171]
v_mfma_f32_16x16x32_bf16 v[168:171], a[44:47], v[244:247], v[168:171]
v_exp_f32 v164, v164
v_exp_f32 v165, v165
v_exp_f32 v166, v166
v_exp_f32 v167, v167
v_exp_f32 v160, v160
v_exp_f32 v161, v161
v_exp_f32 v162, v162
v_exp_f32 v163, v163
v_mfma_f32_16x16x32_bf16 v[168:171], a[48:51], v[248:251], v[168:171]
v_cvt_pk_bf16_f32 v206, v164, v165
v_cvt_pk_bf16_f32 v207, v166, v167
v_cvt_pk_bf16_f32 v204, v160, v161
v_cvt_pk_bf16_f32 v205, v162, v163
v_mfma_f32_16x16x32_bf16 v[172:175], a[64:67], v[248:251], v[40:43]
v_mfma_f32_16x16x32_bf16 v[172:175], a[60:63], v[244:247], v[172:175]
v_mfma_f32_16x16x32_bf16 v[172:175], a[56:59], v[240:243], v[172:175]
v_mfma_f32_16x16x32_bf16 v[172:175], a[52:55], v[236:239], v[172:175]
v_mfma_f32_16x16x32_bf16 v[140:143], a[32:35], v[180:183], v[140:143]
s_waitcnt vmcnt(6)
s_barrier
v_mfma_f32_16x16x32_bf16 v[144:147], a[32:35], v[200:203], v[144:147]
ds_read_b128 a[68:71], v6 offset:25344
ds_read_b128 a[72:75], v6 offset:25408
ds_read_b128 a[76:79], v6 offset:25472
ds_read_b128 a[80:83], v6 offset:25536
ds_read_b128 a[96:99], v6 offset:26048
ds_read_b128 a[92:95], v6 offset:25984
ds_read_b128 a[88:91], v6 offset:25920
ds_read_b128 a[84:87], v6 offset:25856
v_mfma_f32_16x16x32_bf16 v[148:151], a[32:35], v[220:223], v[148:151]
s_waitcnt lgkmcnt(7)
v_exp_f32 v168, v168
v_exp_f32 v169, v169
v_exp_f32 v170, v170
v_exp_f32 v171, v171
v_exp_f32 v172, v172
v_exp_f32 v173, v173
v_exp_f32 v174, v174
v_exp_f32 v175, v175
v_mfma_f32_16x16x32_bf16 v[152:155], a[68:71], a[0:3], v[32:35]
s_waitcnt lgkmcnt(6)
v_cvt_pk_bf16_f32 v224, v168, v169
v_cvt_pk_bf16_f32 v225, v170, v171
v_cvt_pk_bf16_f32 v226, v172, v173
v_cvt_pk_bf16_f32 v227, v174, v175
v_mfma_f32_16x16x32_bf16 v[152:155], a[72:75], a[4:7], v[152:155]
s_waitcnt lgkmcnt(5)
v_mfma_f32_16x16x32_bf16 v[152:155], a[76:79], a[8:11], v[152:155]
s_waitcnt lgkmcnt(4)
v_mfma_f32_16x16x32_bf16 v[152:155], a[80:83], a[12:15], v[152:155]
s_waitcnt lgkmcnt(3)
v_mfma_f32_16x16x32_bf16 v[156:159], a[96:99], a[12:15], v[32:35]
s_waitcnt lgkmcnt(2)
v_mfma_f32_16x16x32_bf16 v[156:159], a[92:95], a[8:11], v[156:159]
s_waitcnt lgkmcnt(1)
v_mfma_f32_16x16x32_bf16 v[156:159], a[88:91], a[4:7], v[156:159]
s_waitcnt lgkmcnt(0)
v_mfma_f32_16x16x32_bf16 v[156:159], a[84:87], a[0:3], v[156:159]
buffer_load_dwordx4 v2, s[8:11], s24 offen offset:0 nt lds
v_mfma_f32_16x16x32_bf16 v[164:167], a[84:87], a[16:19], v[36:39]
s_add_u32 m0, m0, 32
v_mfma_f32_16x16x32_bf16 v[164:167], a[88:91], a[20:23], v[164:167]
buffer_load_dwordx4 v2, s[8:11], s24 offen offset:1024 nt lds
v_mfma_f32_16x16x32_bf16 v[164:167], a[92:95], a[24:27], v[164:167]
s_xor_b32 s24, s98, 2048
v_exp_f32 v152, v152
v_exp_f32 v153, v153
v_exp_f32 v154, v154
v_exp_f32 v155, v155
v_exp_f32 v156, v156
v_exp_f32 v157, v157
v_exp_f32 v158, v158
v_exp_f32 v159, v159
v_mfma_f32_16x16x32_bf16 v[164:167], a[96:99], a[28:31], v[164:167]
s_add_u32 m0, s29, 67584
v_cvt_pk_bf16_f32 v188, v152, v153
v_cvt_pk_bf16_f32 v189, v154, v155
v_cvt_pk_bf16_f32 v190, v156, v157
v_cvt_pk_bf16_f32 v191, v158, v159
v_mfma_f32_16x16x32_bf16 v[160:163], a[80:83], a[28:31], v[36:39]
v_mfma_f32_16x16x32_bf16 v[160:163], a[76:79], a[24:27], v[160:163]
v_mfma_f32_16x16x32_bf16 v[160:163], a[72:75], a[20:23], v[160:163]
v_mfma_f32_16x16x32_bf16 v[160:163], a[68:71], a[16:19], v[160:163]
buffer_load_dwordx4 v2, s[12:15], s24 offen offset:0 nt lds
v_mfma_f32_16x16x32_bf16 v[168:171], a[68:71], v[236:239], v[40:43]
s_add_u32 m0, m0, 8
v_mfma_f32_16x16x32_bf16 v[168:171], a[72:75], v[240:243], v[168:171]
buffer_load_dwordx4 v2, s[12:15], s24 offen offset:1024 nt lds
v_mfma_f32_16x16x32_bf16 v[168:171], a[76:79], v[244:247], v[168:171]
s_xor_b32 s24, s98, 14336
v_exp_f32 v164, v164
v_exp_f32 v165, v165
v_exp_f32 v166, v166
v_exp_f32 v167, v167
v_exp_f32 v160, v160
v_exp_f32 v161, v161
v_exp_f32 v162, v162
v_exp_f32 v163, v163
v_mfma_f32_16x16x32_bf16 v[168:171], a[80:83], v[248:251], v[168:171]
s_add_u32 m0, s23, 76032
v_cvt_pk_bf16_f32 v210, v164, v165
v_cvt_pk_bf16_f32 v211, v166, v167
v_cvt_pk_bf16_f32 v208, v160, v161
v_cvt_pk_bf16_f32 v209, v162, v163
v_mfma_f32_16x16x32_bf16 v[172:175], a[96:99], v[248:251], v[40:43]
v_mfma_f32_16x16x32_bf16 v[172:175], a[92:95], v[244:247], v[172:175]
v_mfma_f32_16x16x32_bf16 v[172:175], a[88:91], v[240:243], v[172:175]
v_mfma_f32_16x16x32_bf16 v[172:175], a[84:87], v[236:239], v[172:175]
v_mfma_f32_16x16x32_bf16 v[140:143], a[32:35], v[184:187], v[140:143]
s_waitcnt vmcnt(8)
s_barrier
v_mfma_f32_16x16x32_bf16 v[144:147], a[32:35], v[204:207], v[144:147]
ds_read_b128 a[36:39], v6 offset:33792
ds_read_b128 a[40:43], v6 offset:33856
ds_read_b128 a[44:47], v6 offset:33920
ds_read_b128 a[48:51], v6 offset:33984
ds_read_b128 a[64:67], v6 offset:34496
ds_read_b128 a[60:63], v6 offset:34432
ds_read_b128 a[56:59], v6 offset:34368
ds_read_b128 a[52:55], v6 offset:34304
v_mfma_f32_16x16x32_bf16 v[148:151], a[32:35], v[224:227], v[148:151]
s_waitcnt lgkmcnt(7)
v_exp_f32 v168, v168
v_exp_f32 v169, v169
v_exp_f32 v170, v170
v_exp_f32 v171, v171
v_exp_f32 v172, v172
v_exp_f32 v173, v173
v_exp_f32 v174, v174
v_exp_f32 v175, v175
v_mfma_f32_16x16x32_bf16 v[152:155], a[36:39], a[0:3], v[32:35]
s_waitcnt lgkmcnt(6)
v_cvt_pk_bf16_f32 v228, v168, v169
v_cvt_pk_bf16_f32 v229, v170, v171
v_cvt_pk_bf16_f32 v230, v172, v173
v_cvt_pk_bf16_f32 v231, v174, v175
v_mfma_f32_16x16x32_bf16 v[152:155], a[40:43], a[4:7], v[152:155]
s_waitcnt lgkmcnt(5)
v_mfma_f32_16x16x32_bf16 v[152:155], a[44:47], a[8:11], v[152:155]
s_waitcnt lgkmcnt(4)
v_mfma_f32_16x16x32_bf16 v[152:155], a[48:51], a[12:15], v[152:155]
s_waitcnt lgkmcnt(3)
v_mfma_f32_16x16x32_bf16 v[156:159], a[64:67], a[12:15], v[32:35]
s_waitcnt lgkmcnt(2)
v_mfma_f32_16x16x32_bf16 v[156:159], a[60:63], a[8:11], v[156:159]
s_waitcnt lgkmcnt(1)
v_mfma_f32_16x16x32_bf16 v[156:159], a[56:59], a[4:7], v[156:159]
s_waitcnt lgkmcnt(0)
v_mfma_f32_16x16x32_bf16 v[156:159], a[52:55], a[0:3], v[156:159]
v_mfma_f32_16x16x32_bf16 v[164:167], a[52:55], a[16:19], v[36:39]
v_mfma_f32_16x16x32_bf16 v[164:167], a[56:59], a[20:23], v[164:167]
v_mfma_f32_16x16x32_bf16 v[164:167], a[60:63], a[24:27], v[164:167]
v_exp_f32 v152, v152
v_exp_f32 v153, v153
v_exp_f32 v154, v154
v_exp_f32 v155, v155
v_exp_f32 v156, v156
v_exp_f32 v157, v157
v_exp_f32 v158, v158
v_exp_f32 v159, v159
v_mfma_f32_16x16x32_bf16 v[164:167], a[64:67], a[28:31], v[164:167]
v_cvt_pk_bf16_f32 v192, v152, v153
v_cvt_pk_bf16_f32 v193, v154, v155
v_cvt_pk_bf16_f32 v194, v156, v157
v_cvt_pk_bf16_f32 v195, v158, v159
v_mfma_f32_16x16x32_bf16 v[160:163], a[48:51], a[28:31], v[36:39]
v_mfma_f32_16x16x32_bf16 v[160:163], a[44:47], a[24:27], v[160:163]
v_mfma_f32_16x16x32_bf16 v[160:163], a[40:43], a[20:23], v[160:163]
v_mfma_f32_16x16x32_bf16 v[160:163], a[36:39], a[16:19], v[160:163]
v_mfma_f32_16x16x32_bf16 v[168:171], a[36:39], v[236:239], v[40:43]
v_mfma_f32_16x16x32_bf16 v[168:171], a[40:43], v[240:243], v[168:171]
buffer_load_dwordx4 v2, s[8:11], s24 offen offset:0 nt lds
v_mfma_f32_16x16x32_bf16 v[168:171], a[44:47], v[244:247], v[168:171]
s_add_u32 m0, m0, 32
v_exp_f32 v164, v164
v_exp_f32 v165, v165
v_exp_f32 v166, v166
v_exp_f32 v167, v167
v_exp_f32 v160, v160
v_exp_f32 v161, v161
v_exp_f32 v162, v162
v_exp_f32 v163, v163
v_mfma_f32_16x16x32_bf16 v[168:171], a[48:51], v[248:251], v[168:171]
buffer_load_dwordx4 v2, s[8:11], s24 offen offset:1024 nt lds
v_cvt_pk_bf16_f32 v214, v164, v165
v_cvt_pk_bf16_f32 v215, v166, v167
v_cvt_pk_bf16_f32 v212, v160, v161
v_cvt_pk_bf16_f32 v213, v162, v163
v_mfma_f32_16x16x32_bf16 v[172:175], a[64:67], v[248:251], v[40:43]
s_xor_b32 s24, s98, 4096
v_mfma_f32_16x16x32_bf16 v[172:175], a[60:63], v[244:247], v[172:175]
s_add_u32 m0, s29, 84480
v_mfma_f32_16x16x32_bf16 v[172:175], a[56:59], v[240:243], v[172:175]
v_mfma_f32_16x16x32_bf16 v[172:175], a[52:55], v[236:239], v[172:175]
v_mfma_f32_16x16x32_bf16 v[140:143], a[32:35], v[188:191], v[140:143]
s_waitcnt vmcnt(6)
s_barrier
v_mfma_f32_16x16x32_bf16 v[144:147], a[32:35], v[208:211], v[144:147]
ds_read_b128 a[68:71], v6 offset:42240
ds_read_b128 a[72:75], v6 offset:42304
ds_read_b128 a[76:79], v6 offset:42368
ds_read_b128 a[80:83], v6 offset:42432
ds_read_b128 a[96:99], v6 offset:42944
ds_read_b128 a[92:95], v6 offset:42880
ds_read_b128 a[88:91], v6 offset:42816
ds_read_b128 a[84:87], v6 offset:42752
ds_read_b64_tr_b16 a[100:101], v9 offset:50688
ds_read_b64_tr_b16 a[102:103], v9 offset:51200
s_waitcnt lgkmcnt(0)
ds_read_b64_tr_b16 a[104:105], v9 offset:50696
ds_read_b64_tr_b16 a[106:107], v9 offset:51208
ds_read_b64_tr_b16 a[108:109], v9 offset:50704
ds_read_b64_tr_b16 a[110:111], v9 offset:51216
ds_read_b64_tr_b16 a[112:113], v9 offset:50712
ds_read_b64_tr_b16 a[114:115], v9 offset:51224
ds_read_b64_tr_b16 a[116:117], v9 offset:50816
ds_read_b64_tr_b16 a[118:119], v9 offset:51328
ds_read_b64_tr_b16 a[120:121], v9 offset:50824
ds_read_b64_tr_b16 a[122:123], v9 offset:51336
ds_read_b64_tr_b16 a[124:125], v9 offset:50832
ds_read_b64_tr_b16 a[126:127], v9 offset:51344
ds_read_b64_tr_b16 a[128:129], v9 offset:50840
ds_read_b64_tr_b16 a[130:131], v9 offset:51352
v_mfma_f32_16x16x32_bf16 v[148:151], a[32:35], v[228:231], v[148:151]
v_exp_f32 v168, v168
v_exp_f32 v169, v169
v_exp_f32 v170, v170
v_exp_f32 v171, v171
v_exp_f32 v172, v172
v_exp_f32 v173, v173
v_mfma_f32_16x16x32_bf16 v[44:47], a[100:103], v[176:179], 0
v_exp_f32 v174, v174
v_cvt_pk_bf16_f32 v232, v168, v169
v_cvt_pk_bf16_f32 v233, v170, v171
v_mfma_f32_16x16x32_bf16 v[76:79], a[100:103], v[196:199], 0
s_waitcnt lgkmcnt(12)
v_exp_f32 v175, v175
v_cvt_pk_bf16_f32 v234, v172, v173
v_mfma_f32_16x16x32_bf16 v[108:111], a[100:103], v[216:219], 0
buffer_load_dwordx4 v2, s[12:15], s24 offen offset:0 nt lds
v_cvt_pk_bf16_f32 v235, v174, v175
v_mfma_f32_16x16x32_bf16 v[112:115], a[104:107], v[216:219], 0
s_add_u32 m0, m0, 8
v_mfma_f32_16x16x32_bf16 v[80:83], a[104:107], v[196:199], 0
s_waitcnt lgkmcnt(8)
buffer_load_dwordx4 v2, s[12:15], s24 offen offset:1024 nt lds
v_mfma_f32_16x16x32_bf16 v[48:51], a[104:107], v[176:179], 0
s_xor_b32 s24, s98, 16384
v_mfma_f32_16x16x32_bf16 v[52:55], a[108:111], v[176:179], 0
s_add_u32 m0, s23, 92928
v_mfma_f32_16x16x32_bf16 v[84:87], a[108:111], v[196:199], 0
v_mfma_f32_16x16x32_bf16 v[116:119], a[108:111], v[216:219], 0
v_mfma_f32_16x16x32_bf16 v[120:123], a[112:115], v[216:219], 0
v_mfma_f32_16x16x32_bf16 v[88:91], a[112:115], v[196:199], 0
s_waitcnt lgkmcnt(0)
v_mfma_f32_16x16x32_bf16 v[56:59], a[112:115], v[176:179], 0
v_mfma_f32_16x16x32_bf16 v[60:63], a[116:119], v[176:179], 0
v_mfma_f32_16x16x32_bf16 v[92:95], a[116:119], v[196:199], 0
v_mfma_f32_16x16x32_bf16 v[124:127], a[116:119], v[216:219], 0
v_mfma_f32_16x16x32_bf16 v[128:131], a[120:123], v[216:219], 0
v_mfma_f32_16x16x32_bf16 v[96:99], a[120:123], v[196:199], 0
v_mfma_f32_16x16x32_bf16 v[64:67], a[120:123], v[176:179], 0
v_mfma_f32_16x16x32_bf16 v[68:71], a[124:127], v[176:179], 0
v_mfma_f32_16x16x32_bf16 v[100:103], a[124:127], v[196:199], 0
v_mfma_f32_16x16x32_bf16 v[132:135], a[124:127], v[216:219], 0
v_mfma_f32_16x16x32_bf16 v[136:139], a[128:131], v[216:219], 0
v_mfma_f32_16x16x32_bf16 v[104:107], a[128:131], v[196:199], 0
v_mfma_f32_16x16x32_bf16 v[72:75], a[128:131], v[176:179], 0
v_mfma_f32_16x16x32_bf16 v[152:155], a[68:71], a[0:3], v[32:35]
v_mfma_f32_16x16x32_bf16 v[152:155], a[72:75], a[4:7], v[152:155]
v_mfma_f32_16x16x32_bf16 v[152:155], a[76:79], a[8:11], v[152:155]
v_mfma_f32_16x16x32_bf16 v[152:155], a[80:83], a[12:15], v[152:155]
v_mfma_f32_16x16x32_bf16 v[156:159], a[96:99], a[12:15], v[32:35]
buffer_load_dwordx4 v2, s[8:11], s24 offen offset:0 nt lds
v_mfma_f32_16x16x32_bf16 v[156:159], a[92:95], a[8:11], v[156:159]
s_add_u32 m0, m0, 32
v_mfma_f32_16x16x32_bf16 v[156:159], a[88:91], a[4:7], v[156:159]
buffer_load_dwordx4 v2, s[8:11], s24 offen offset:1024 nt lds
v_mfma_f32_16x16x32_bf16 v[156:159], a[84:87], a[0:3], v[156:159]
s_xor_b32 s24, s98, 6144
v_mfma_f32_16x16x32_bf16 v[164:167], a[84:87], a[16:19], v[36:39]
s_add_u32 m0, s29, 101376
v_mfma_f32_16x16x32_bf16 v[164:167], a[88:91], a[20:23], v[164:167]
v_mfma_f32_16x16x32_bf16 v[164:167], a[92:95], a[24:27], v[164:167]
v_exp_f32 v152, v152
v_exp_f32 v153, v153
v_exp_f32 v154, v154
v_exp_f32 v155, v155
v_exp_f32 v156, v156
v_exp_f32 v157, v157
v_exp_f32 v158, v158
v_exp_f32 v159, v159
v_mfma_f32_16x16x32_bf16 v[164:167], a[96:99], a[28:31], v[164:167]
v_cvt_pk_bf16_f32 v176, v152, v153
v_cvt_pk_bf16_f32 v177, v154, v155
v_cvt_pk_bf16_f32 v178, v156, v157
v_cvt_pk_bf16_f32 v179, v158, v159
v_mfma_f32_16x16x32_bf16 v[160:163], a[80:83], a[28:31], v[36:39]
v_mfma_f32_16x16x32_bf16 v[160:163], a[76:79], a[24:27], v[160:163]
v_mfma_f32_16x16x32_bf16 v[160:163], a[72:75], a[20:23], v[160:163]
v_mfma_f32_16x16x32_bf16 v[160:163], a[68:71], a[16:19], v[160:163]
v_mfma_f32_16x16x32_bf16 v[168:171], a[68:71], v[236:239], v[40:43]
v_mfma_f32_16x16x32_bf16 v[168:171], a[72:75], v[240:243], v[168:171]
v_mfma_f32_16x16x32_bf16 v[168:171], a[76:79], v[244:247], v[168:171]
v_exp_f32 v164, v164
v_exp_f32 v165, v165
v_exp_f32 v166, v166
v_exp_f32 v167, v167
v_exp_f32 v160, v160
v_exp_f32 v161, v161
v_exp_f32 v162, v162
v_exp_f32 v163, v163
v_mfma_f32_16x16x32_bf16 v[168:171], a[80:83], v[248:251], v[168:171]
v_cvt_pk_bf16_f32 v198, v164, v165
v_cvt_pk_bf16_f32 v199, v166, v167
v_cvt_pk_bf16_f32 v196, v160, v161
v_cvt_pk_bf16_f32 v197, v162, v163
v_mfma_f32_16x16x32_bf16 v[172:175], a[96:99], v[248:251], v[40:43]
buffer_load_dwordx4 v2, s[12:15], s24 offen offset:0 nt lds
v_mfma_f32_16x16x32_bf16 v[172:175], a[92:95], v[244:247], v[172:175]
s_add_u32 m0, m0, 8
v_mfma_f32_16x16x32_bf16 v[172:175], a[88:91], v[240:243], v[172:175]
v_mfma_f32_16x16x32_bf16 v[172:175], a[84:87], v[236:239], v[172:175]
v_mfma_f32_16x16x32_bf16 v[140:143], a[32:35], v[192:195], v[140:143]
s_waitcnt vmcnt(7)
s_barrier
v_mfma_f32_16x16x32_bf16 v[144:147], a[32:35], v[212:215], v[144:147]
ds_read_b128 a[36:39], v7 offset:0
ds_read_b128 a[40:43], v7 offset:64
ds_read_b128 a[44:47], v7 offset:128
ds_read_b128 a[48:51], v7 offset:192
ds_read_b128 a[64:67], v7 offset:704
ds_read_b128 a[60:63], v7 offset:640
ds_read_b128 a[56:59], v7 offset:576
ds_read_b128 a[52:55], v7 offset:512
ds_read_b64_tr_b16 a[132:133], v10 offset:8448
ds_read_b64_tr_b16 a[134:135], v10 offset:8960
s_waitcnt lgkmcnt(0)
ds_read_b64_tr_b16 a[136:137], v10 offset:8456
ds_read_b64_tr_b16 a[138:139], v10 offset:8968
ds_read_b64_tr_b16 a[140:141], v10 offset:8464
ds_read_b64_tr_b16 a[142:143], v10 offset:8976
ds_read_b64_tr_b16 a[144:145], v10 offset:8472
ds_read_b64_tr_b16 a[146:147], v10 offset:8984
ds_read_b64_tr_b16 a[148:149], v10 offset:8576
ds_read_b64_tr_b16 a[150:151], v10 offset:9088
ds_read_b64_tr_b16 a[152:153], v10 offset:8584
ds_read_b64_tr_b16 a[154:155], v10 offset:9096
ds_read_b64_tr_b16 a[156:157], v10 offset:8592
ds_read_b64_tr_b16 a[158:159], v10 offset:9104
ds_read_b64_tr_b16 a[160:161], v10 offset:8600
ds_read_b64_tr_b16 a[162:163], v10 offset:9112
buffer_load_dwordx4 v2, s[12:15], s24 offen offset:1024 nt lds
v_mfma_f32_16x16x32_bf16 v[148:151], a[32:35], v[232:235], v[148:151]
s_xor_b32 s24, s98, 18432
v_exp_f32 v168, v168
v_exp_f32 v169, v169
v_exp_f32 v170, v170
v_exp_f32 v171, v171
v_exp_f32 v172, v172
v_mfma_f32_16x16x32_bf16 v[44:47], a[132:135], v[180:183], v[44:47]
s_add_u32 m0, s23, 109824
v_exp_f32 v173, v173
v_cvt_pk_bf16_f32 v216, v168, v169
v_cvt_pk_bf16_f32 v217, v170, v171
v_mfma_f32_16x16x32_bf16 v[76:79], a[132:135], v[200:203], v[76:79]
s_waitcnt lgkmcnt(12)
v_exp_f32 v174, v174
v_cvt_pk_bf16_f32 v218, v172, v173
v_mfma_f32_16x16x32_bf16 v[108:111], a[132:135], v[220:223], v[108:111]
v_exp_f32 v175, v175
v_mfma_f32_16x16x32_bf16 v[112:115], a[136:139], v[220:223], v[112:115]
v_cvt_pk_bf16_f32 v219, v174, v175
v_mfma_f32_16x16x32_bf16 v[80:83], a[136:139], v[200:203], v[80:83]
s_waitcnt lgkmcnt(8)
v_mfma_f32_16x16x32_bf16 v[48:51], a[136:139], v[180:183], v[48:51]
v_mfma_f32_16x16x32_bf16 v[52:55], a[140:143], v[180:183], v[52:55]
v_mfma_f32_16x16x32_bf16 v[84:87], a[140:143], v[200:203], v[84:87]
v_mfma_f32_16x16x32_bf16 v[116:119], a[140:143], v[220:223], v[116:119]
v_mfma_f32_16x16x32_bf16 v[120:123], a[144:147], v[220:223], v[120:123]
v_mfma_f32_16x16x32_bf16 v[88:91], a[144:147], v[200:203], v[88:91]
s_waitcnt lgkmcnt(0)
v_mfma_f32_16x16x32_bf16 v[56:59], a[144:147], v[180:183], v[56:59]
v_mfma_f32_16x16x32_bf16 v[60:63], a[148:151], v[180:183], v[60:63]
v_mfma_f32_16x16x32_bf16 v[92:95], a[148:151], v[200:203], v[92:95]
v_mfma_f32_16x16x32_bf16 v[124:127], a[148:151], v[220:223], v[124:127]
v_mfma_f32_16x16x32_bf16 v[128:131], a[152:155], v[220:223], v[128:131]
v_mfma_f32_16x16x32_bf16 v[96:99], a[152:155], v[200:203], v[96:99]
v_mfma_f32_16x16x32_bf16 v[64:67], a[152:155], v[180:183], v[64:67]
v_mfma_f32_16x16x32_bf16 v[68:71], a[156:159], v[180:183], v[68:71]
v_mfma_f32_16x16x32_bf16 v[100:103], a[156:159], v[200:203], v[100:103]
L_touch1:
s_cbranch_scc1 L_touch_ret
v_mfma_f32_16x16x32_bf16 v[132:135], a[156:159], v[220:223], v[132:135]
buffer_load_dwordx4 v2, s[8:11], s24 offen offset:0 nt lds
v_mfma_f32_16x16x32_bf16 v[136:139], a[160:163], v[220:223], v[136:139]
s_add_u32 m0, m0, 32
v_mfma_f32_16x16x32_bf16 v[104:107], a[160:163], v[200:203], v[104:107]
buffer_load_dwordx4 v2, s[8:11], s24 offen offset:1024 nt lds
v_mfma_f32_16x16x32_bf16 v[72:75], a[160:163], v[180:183], v[72:75]
s_xor_b32 s24, s98, 8192
v_mfma_f32_16x16x32_bf16 v[152:155], a[36:39], a[0:3], v[32:35]
s_add_u32 m0, s29, 118272
v_mfma_f32_16x16x32_bf16 v[152:155], a[40:43], a[4:7], v[152:155]
v_mfma_f32_16x16x32_bf16 v[152:155], a[44:47], a[8:11], v[152:155]
v_mfma_f32_16x16x32_bf16 v[152:155], a[48:51], a[12:15], v[152:155]
v_mfma_f32_16x16x32_bf16 v[156:159], a[64:67], a[12:15], v[32:35]
v_mfma_f32_16x16x32_bf16 v[156:159], a[60:63], a[8:11], v[156:159]
v_mfma_f32_16x16x32_bf16 v[156:159], a[56:59], a[4:7], v[156:159]
v_mfma_f32_16x16x32_bf16 v[156:159], a[52:55], a[0:3], v[156:159]
v_mfma_f32_16x16x32_bf16 v[164:167], a[52:55], a[16:19], v[36:39]
v_mfma_f32_16x16x32_bf16 v[164:167], a[56:59], a[20:23], v[164:167]
v_mfma_f32_16x16x32_bf16 v[164:167], a[60:63], a[24:27], v[164:167]
v_exp_f32 v152, v152
v_exp_f32 v153, v153
v_exp_f32 v154, v154
v_exp_f32 v155, v155
v_exp_f32 v156, v156
v_exp_f32 v157, v157
v_exp_f32 v158, v158
v_exp_f32 v159, v159
v_mfma_f32_16x16x32_bf16 v[164:167], a[64:67], a[28:31], v[164:167]
v_cvt_pk_bf16_f32 v180, v152, v153
v_cvt_pk_bf16_f32 v181, v154, v155
v_cvt_pk_bf16_f32 v182, v156, v157
v_cvt_pk_bf16_f32 v183, v158, v159
v_mfma_f32_16x16x32_bf16 v[160:163], a[48:51], a[28:31], v[36:39]
v_mfma_f32_16x16x32_bf16 v[160:163], a[44:47], a[24:27], v[160:163]
v_mfma_f32_16x16x32_bf16 v[160:163], a[40:43], a[20:23], v[160:163]
v_mfma_f32_16x16x32_bf16 v[160:163], a[36:39], a[16:19], v[160:163]
v_mfma_f32_16x16x32_bf16 v[168:171], a[36:39], v[236:239], v[40:43]
buffer_load_dwordx4 v2, s[12:15], s24 offen offset:0 nt lds
v_mfma_f32_16x16x32_bf16 v[168:171], a[40:43], v[240:243], v[168:171]
s_add_u32 m0, m0, 8
v_mfma_f32_16x16x32_bf16 v[168:171], a[44:47], v[244:247], v[168:171]
buffer_load_dwordx4 v2, s[12:15], s24 offen offset:1024 nt lds
v_exp_f32 v164, v164
v_exp_f32 v165, v165
v_exp_f32 v166, v166
v_exp_f32 v167, v167
v_exp_f32 v160, v160
v_exp_f32 v161, v161
v_exp_f32 v162, v162
v_exp_f32 v163, v163
v_mfma_f32_16x16x32_bf16 v[168:171], a[48:51], v[248:251], v[168:171]
s_xor_b32 s24, s98, 20480
v_cvt_pk_bf16_f32 v202, v164, v165
v_cvt_pk_bf16_f32 v203, v166, v167
v_cvt_pk_bf16_f32 v200, v160, v161
v_cvt_pk_bf16_f32 v201, v162, v163
v_mfma_f32_16x16x32_bf16 v[172:175], a[64:67], v[248:251], v[40:43]
s_add_u32 m0, s23, 126720
v_mfma_f32_16x16x32_bf16 v[172:175], a[60:63], v[244:247], v[172:175]
v_mfma_f32_16x16x32_bf16 v[172:175], a[56:59], v[240:243], v[172:175]
v_mfma_f32_16x16x32_bf16 v[172:175], a[52:55], v[236:239], v[172:175]
v_mfma_f32_16x16x32_bf16 v[140:143], a[32:35], v[176:179], v[140:143]
s_waitcnt vmcnt(8)
s_barrier
v_mfma_f32_16x16x32_bf16 v[144:147], a[32:35], v[196:199], v[144:147]
ds_read_b128 a[68:71], v7 offset:16896
ds_read_b128 a[72:75], v7 offset:16960
ds_read_b128 a[76:79], v7 offset:17024
ds_read_b128 a[80:83], v7 offset:17088
ds_read_b128 a[96:99], v7 offset:17600
ds_read_b128 a[92:95], v7 offset:17536
ds_read_b128 a[88:91], v7 offset:17472
ds_read_b64_tr_b16 a[164:165], v10 offset:25344
ds_read_b64_tr_b16 a[166:167], v10 offset:25856
s_waitcnt lgkmcnt(0)
ds_read_b64_tr_b16 a[168:169], v10 offset:25352
ds_read_b64_tr_b16 a[170:171], v10 offset:25864
ds_read_b64_tr_b16 a[172:173], v10 offset:25360
ds_read_b64_tr_b16 a[174:175], v10 offset:25872
ds_read_b64_tr_b16 a[176:177], v10 offset:25368
ds_read_b64_tr_b16 a[178:179], v10 offset:25880
ds_read_b64_tr_b16 a[180:181], v10 offset:25472
ds_read_b64_tr_b16 a[182:183], v10 offset:25984
ds_read_b64_tr_b16 a[184:185], v10 offset:25480
ds_read_b64_tr_b16 a[186:187], v10 offset:25992
ds_read_b64_tr_b16 a[188:189], v10 offset:25488
ds_read_b64_tr_b16 a[190:191], v10 offset:26000
ds_read_b64_tr_b16 a[192:193], v10 offset:25496
ds_read_b64_tr_b16 a[194:195], v10 offset:26008
v_mfma_f32_16x16x32_bf16 v[148:151], a[32:35], v[216:219], v[148:151]
ds_read_b128 a[84:87], v7 offset:17408
v_exp_f32 v168, v168
v_mfma_f32_16x16x32_bf16 v[44:47], a[164:167], v[184:187], v[44:47]
v_exp_f32 v169, v169
v_mfma_f32_16x16x32_bf16 v[76:79], a[164:167], v[204:207], v[76:79]
s_waitcnt lgkmcnt(13)
v_exp_f32 v170, v170
v_exp_f32 v171, v171
v_cvt_pk_bf16_f32 v220, v168, v169
v_mfma_f32_16x16x32_bf16 v[108:111], a[164:167], v[224:227], v[108:111]
v_exp_f32 v172, v172
v_cvt_pk_bf16_f32 v221, v170, v171
v_mfma_f32_16x16x32_bf16 v[112:115], a[168:171], v[224:227], v[112:115]
v_exp_f32 v173, v173
v_mfma_f32_16x16x32_bf16 v[80:83], a[168:171], v[204:207], v[80:83]
s_waitcnt lgkmcnt(9)
v_exp_f32 v174, v174
v_exp_f32 v175, v175
v_cvt_pk_bf16_f32 v222, v172, v173
v_mfma_f32_16x16x32_bf16 v[48:51], a[168:171], v[184:187], v[48:51]
v_cvt_pk_bf16_f32 v223, v174, v175
v_mfma_f32_16x16x32_bf16 v[52:55], a[172:175], v[184:187], v[52:55]
v_mfma_f32_16x16x32_bf16 v[84:87], a[172:175], v[204:207], v[84:87]
v_mfma_f32_16x16x32_bf16 v[116:119], a[172:175], v[224:227], v[116:119]
v_mfma_f32_16x16x32_bf16 v[120:123], a[176:179], v[224:227], v[120:123]
v_mfma_f32_16x16x32_bf16 v[88:91], a[176:179], v[204:207], v[88:91]
s_waitcnt lgkmcnt(1)
v_mfma_f32_16x16x32_bf16 v[56:59], a[176:179], v[184:187], v[56:59]
v_mfma_f32_16x16x32_bf16 v[60:63], a[180:183], v[184:187], v[60:63]
v_mfma_f32_16x16x32_bf16 v[92:95], a[180:183], v[204:207], v[92:95]
v_mfma_f32_16x16x32_bf16 v[124:127], a[180:183], v[224:227], v[124:127]
v_mfma_f32_16x16x32_bf16 v[128:131], a[184:187], v[224:227], v[128:131]
v_mfma_f32_16x16x32_bf16 v[96:99], a[184:187], v[204:207], v[96:99]
buffer_load_dwordx4 v2, s[8:11], s24 offen offset:0 nt lds
v_mfma_f32_16x16x32_bf16 v[64:67], a[184:187], v[184:187], v[64:67]
s_add_u32 m0, m0, 32
v_mfma_f32_16x16x32_bf16 v[68:71], a[188:191], v[184:187], v[68:71]
buffer_load_dwordx4 v2, s[8:11], s24 offen offset:1024 nt lds
v_mfma_f32_16x16x32_bf16 v[100:103], a[188:191], v[204:207], v[100:103]
s_xor_b32 s24, s98, 10240
v_mfma_f32_16x16x32_bf16 v[132:135], a[188:191], v[224:227], v[132:135]
s_add_u32 m0, s29, 135168
v_mfma_f32_16x16x32_bf16 v[136:139], a[192:195], v[224:227], v[136:139]
v_mfma_f32_16x16x32_bf16 v[104:107], a[192:195], v[204:207], v[104:107]
v_mfma_f32_16x16x32_bf16 v[72:75], a[192:195], v[184:187], v[72:75]
v_mfma_f32_16x16x32_bf16 v[152:155], a[68:71], a[0:3], v[32:35]
v_mfma_f32_16x16x32_bf16 v[152:155], a[72:75], a[4:7], v[152:155]
v_mfma_f32_16x16x32_bf16 v[152:155], a[76:79], a[8:11], v[152:155]
s_waitcnt lgkmcnt(0)
v_mfma_f32_16x16x32_bf16 v[152:155], a[80:83], a[12:15], v[152:155]
v_mfma_f32_16x16x32_bf16 v[156:159], a[96:99], a[12:15], v[32:35]
v_mfma_f32_16x16x32_bf16 v[156:159], a[92:95], a[8:11], v[156:159]
v_mfma_f32_16x16x32_bf16 v[156:159], a[88:91], a[4:7], v[156:159]
v_mfma_f32_16x16x32_bf16 v[156:159], a[84:87], a[0:3], v[156:159]
v_mfma_f32_16x16x32_bf16 v[164:167], a[84:87], a[16:19], v[36:39]
v_mfma_f32_16x16x32_bf16 v[164:167], a[88:91], a[20:23], v[164:167]
v_mfma_f32_16x16x32_bf16 v[164:167], a[92:95], a[24:27], v[164:167]
v_exp_f32 v152, v152
v_exp_f32 v153, v153
v_exp_f32 v154, v154
v_exp_f32 v155, v155
v_exp_f32 v156, v156
v_exp_f32 v157, v157
v_exp_f32 v158, v158
v_exp_f32 v159, v159
v_mfma_f32_16x16x32_bf16 v[164:167], a[96:99], a[28:31], v[164:167]
v_cvt_pk_bf16_f32 v184, v152, v153
v_cvt_pk_bf16_f32 v185, v154, v155
v_cvt_pk_bf16_f32 v186, v156, v157
v_cvt_pk_bf16_f32 v187, v158, v159
v_mfma_f32_16x16x32_bf16 v[160:163], a[80:83], a[28:31], v[36:39]
v_mfma_f32_16x16x32_bf16 v[160:163], a[76:79], a[24:27], v[160:163]
v_mfma_f32_16x16x32_bf16 v[160:163], a[72:75], a[20:23], v[160:163]
v_mfma_f32_16x16x32_bf16 v[160:163], a[68:71], a[16:19], v[160:163]
v_mfma_f32_16x16x32_bf16 v[168:171], a[68:71], v[236:239], v[40:43]
buffer_load_dwordx4 v2, s[12:15], s24 offen offset:0 nt lds
v_mfma_f32_16x16x32_bf16 v[168:171], a[72:75], v[240:243], v[168:171]
s_add_u32 m0, m0, 8
v_mfma_f32_16x16x32_bf16 v[168:171], a[76:79], v[244:247], v[168:171]
buffer_load_dwordx4 v2, s[12:15], s24 offen offset:1024 nt lds
v_exp_f32 v164, v164
v_exp_f32 v165, v165
v_exp_f32 v166, v166
v_exp_f32 v167, v167
v_exp_f32 v160, v160
v_exp_f32 v161, v161
v_exp_f32 v162, v162
v_exp_f32 v163, v163
v_mfma_f32_16x16x32_bf16 v[168:171], a[80:83], v[248:251], v[168:171]
s_xor_b32 s24, s98, 22528
v_cvt_pk_bf16_f32 v206, v164, v165
v_cvt_pk_bf16_f32 v207, v166, v167
v_cvt_pk_bf16_f32 v204, v160, v161
v_cvt_pk_bf16_f32 v205, v162, v163
v_mfma_f32_16x16x32_bf16 v[172:175], a[96:99], v[248:251], v[40:43]
s_add_u32 m0, s23, 143616
v_mfma_f32_16x16x32_bf16 v[172:175], a[92:95], v[244:247], v[172:175]
s_waitcnt vmcnt(8)
s_barrier
v_mfma_f32_16x16x32_bf16 v[172:175], a[88:91], v[240:243], v[172:175]
ds_read_b64_tr_b16 a[196:197], v10 offset:42240
ds_read_b64_tr_b16 a[198:199], v10 offset:42752
ds_read_b64_tr_b16 a[200:201], v10 offset:42248
ds_read_b64_tr_b16 a[202:203], v10 offset:42760
ds_read_b64_tr_b16 a[204:205], v10 offset:42256
ds_read_b64_tr_b16 a[206:207], v10 offset:42768
ds_read_b64_tr_b16 a[208:209], v10 offset:42264
ds_read_b64_tr_b16 a[210:211], v10 offset:42776
ds_read_b64_tr_b16 a[212:213], v10 offset:42368
ds_read_b64_tr_b16 a[214:215], v10 offset:42880
ds_read_b64_tr_b16 a[216:217], v10 offset:42376
ds_read_b64_tr_b16 a[218:219], v10 offset:42888
v_mfma_f32_16x16x32_bf16 v[172:175], a[84:87], v[236:239], v[172:175]
ds_read_b64_tr_b16 a[220:221], v10 offset:42384
ds_read_b64_tr_b16 a[222:223], v10 offset:42896
ds_read_b64_tr_b16 a[224:225], v10 offset:42392
v_mfma_f32_16x16x32_bf16 v[140:143], a[32:35], v[180:183], v[140:143]
ds_read_b128 a[36:39], v7 offset:33792
ds_read_b64_tr_b16 a[226:227], v10 offset:42904
v_mfma_f32_16x16x32_bf16 v[144:147], a[32:35], v[200:203], v[144:147]
s_waitcnt lgkmcnt(15)
ds_read_b128 a[40:43], v7 offset:33856
v_mfma_f32_16x16x32_bf16 v[148:151], a[32:35], v[220:223], v[148:151]
v_exp_f32 v168, v168
v_exp_f32 v169, v169
v_mfma_f32_16x16x32_bf16 v[44:47], a[196:199], v[188:191], v[44:47]
ds_read_b128 a[44:47], v7 offset:33920
v_exp_f32 v170, v170
v_mfma_f32_16x16x32_bf16 v[76:79], a[196:199], v[208:211], v[76:79]
s_waitcnt lgkmcnt(15)
ds_read_b128 a[48:51], v7 offset:33984
v_cvt_pk_bf16_f32 v224, v168, v169
v_mfma_f32_16x16x32_bf16 v[108:111], a[196:199], v[228:231], v[108:111]
ds_read_b128 a[64:67], v7 offset:34496
v_exp_f32 v171, v171
v_mfma_f32_16x16x32_bf16 v[112:115], a[200:203], v[228:231], v[112:115]
v_exp_f32 v172, v172
v_mfma_f32_16x16x32_bf16 v[80:83], a[200:203], v[208:211], v[80:83]
s_waitcnt lgkmcnt(13)
ds_read_b128 a[60:63], v7 offset:34432
v_exp_f32 v173, v173
v_mfma_f32_16x16x32_bf16 v[48:51], a[200:203], v[188:191], v[48:51]
ds_read_b128 a[56:59], v7 offset:34368
v_exp_f32 v174, v174
v_mfma_f32_16x16x32_bf16 v[52:55], a[204:207], v[188:191], v[52:55]
ds_read_b128 a[52:55], v7 offset:34304
v_cvt_pk_bf16_f32 v225, v170, v171
v_mfma_f32_16x16x32_bf16 v[84:87], a[204:207], v[208:211], v[84:87]
v_exp_f32 v175, v175
v_cvt_pk_bf16_f32 v226, v172, v173
v_mfma_f32_16x16x32_bf16 v[116:119], a[204:207], v[228:231], v[116:119]
v_cvt_pk_bf16_f32 v227, v174, v175
v_mfma_f32_16x16x32_bf16 v[120:123], a[208:211], v[228:231], v[120:123]
v_mfma_f32_16x16x32_bf16 v[88:91], a[208:211], v[208:211], v[88:91]
s_waitcnt lgkmcnt(7)
v_mfma_f32_16x16x32_bf16 v[56:59], a[208:211], v[188:191], v[56:59]
v_mfma_f32_16x16x32_bf16 v[60:63], a[212:215], v[188:191], v[60:63]
buffer_load_dwordx4 v2, s[8:11], s24 offen offset:0 nt lds
v_mfma_f32_16x16x32_bf16 v[92:95], a[212:215], v[208:211], v[92:95]
s_add_u32 m0, m0, 32
v_mfma_f32_16x16x32_bf16 v[124:127], a[212:215], v[228:231], v[124:127]
buffer_load_dwordx4 v2, s[8:11], s24 offen offset:1024 nt lds
v_mfma_f32_16x16x32_bf16 v[128:131], a[216:219], v[228:231], v[128:131]
s_xor_b32 s24, s98, 12288
v_mfma_f32_16x16x32_bf16 v[96:99], a[216:219], v[208:211], v[96:99]
s_add_u32 m0, s29, 152064
v_mfma_f32_16x16x32_bf16 v[64:67], a[216:219], v[188:191], v[64:67]
v_mfma_f32_16x16x32_bf16 v[68:71], a[220:223], v[188:191], v[68:71]
v_mfma_f32_16x16x32_bf16 v[100:103], a[220:223], v[208:211], v[100:103]
v_mfma_f32_16x16x32_bf16 v[132:135], a[220:223], v[228:231], v[132:135]
v_mfma_f32_16x16x32_bf16 v[136:139], a[224:227], v[228:231], v[136:139]
v_mfma_f32_16x16x32_bf16 v[104:107], a[224:227], v[208:211], v[104:107]
s_waitcnt lgkmcnt(4)
v_mfma_f32_16x16x32_bf16 v[72:75], a[224:227], v[188:191], v[72:75]
v_mfma_f32_16x16x32_bf16 v[152:155], a[36:39], a[0:3], v[32:35]
v_mfma_f32_16x16x32_bf16 v[152:155], a[40:43], a[4:7], v[152:155]
v_mfma_f32_16x16x32_bf16 v[152:155], a[44:47], a[8:11], v[152:155]
s_waitcnt lgkmcnt(0)
v_mfma_f32_16x16x32_bf16 v[152:155], a[48:51], a[12:15], v[152:155]
v_mfma_f32_16x16x32_bf16 v[156:159], a[64:67], a[12:15], v[32:35]
v_mfma_f32_16x16x32_bf16 v[156:159], a[60:63], a[8:11], v[156:159]
v_mfma_f32_16x16x32_bf16 v[156:159], a[56:59], a[4:7], v[156:159]
v_mfma_f32_16x16x32_bf16 v[156:159], a[52:55], a[0:3], v[156:159]
v_mfma_f32_16x16x32_bf16 v[164:167], a[52:55], a[16:19], v[36:39]
v_mfma_f32_16x16x32_bf16 v[164:167], a[56:59], a[20:23], v[164:167]
v_mfma_f32_16x16x32_bf16 v[164:167], a[60:63], a[24:27], v[164:167]
v_exp_f32 v152, v152
v_exp_f32 v153, v153
v_exp_f32 v154, v154
v_exp_f32 v155, v155
v_exp_f32 v156, v156
v_exp_f32 v157, v157
v_exp_f32 v158, v158
v_exp_f32 v159, v159
v_mfma_f32_16x16x32_bf16 v[164:167], a[64:67], a[28:31], v[164:167]
v_cvt_pk_bf16_f32 v188, v152, v153
v_cvt_pk_bf16_f32 v189, v154, v155
v_cvt_pk_bf16_f32 v190, v156, v157
v_cvt_pk_bf16_f32 v191, v158, v159
v_mfma_f32_16x16x32_bf16 v[160:163], a[48:51], a[28:31], v[36:39]
v_mfma_f32_16x16x32_bf16 v[160:163], a[44:47], a[24:27], v[160:163]
v_mfma_f32_16x16x32_bf16 v[160:163], a[40:43], a[20:23], v[160:163]
v_mfma_f32_16x16x32_bf16 v[160:163], a[36:39], a[16:19], v[160:163]
v_mfma_f32_16x16x32_bf16 v[168:171], a[36:39], v[236:239], v[40:43]
buffer_load_dwordx4 v2, s[12:15], s24 offen offset:0 nt lds
v_mfma_f32_16x16x32_bf16 v[168:171], a[40:43], v[240:243], v[168:171]
s_add_u32 m0, m0, 8
v_mfma_f32_16x16x32_bf16 v[168:171], a[44:47], v[244:247], v[168:171]
v_exp_f32 v164, v164
v_exp_f32 v165, v165
v_exp_f32 v166, v166
v_exp_f32 v167, v167
v_mfma_f32_16x16x32_bf16 v[168:171], a[48:51], v[248:251], v[168:171]
s_waitcnt vmcnt(7)
s_barrier
v_mfma_f32_16x16x32_bf16 v[172:175], a[64:67], v[248:251], v[40:43]
ds_read_b64_tr_b16 a[100:101], v11 offset:0
ds_read_b64_tr_b16 a[102:103], v11 offset:512
buffer_load_dwordx4 v2, s[12:15], s24 offen offset:1024 nt lds
v_mfma_f32_16x16x32_bf16 v[172:175], a[60:63], v[244:247], v[172:175]
s_xor_b32 s24, s98, 24576
ds_read_b64_tr_b16 a[104:105], v11 offset:8
ds_read_b64_tr_b16 a[106:107], v11 offset:520
ds_read_b64_tr_b16 a[108:109], v11 offset:16
v_mfma_f32_16x16x32_bf16 v[172:175], a[56:59], v[240:243], v[172:175]
s_add_u32 m0, s23, 0
ds_read_b64_tr_b16 a[110:111], v11 offset:528
ds_read_b64_tr_b16 a[112:113], v11 offset:24
v_mfma_f32_16x16x32_bf16 v[172:175], a[52:55], v[236:239], v[172:175]
ds_read_b64_tr_b16 a[114:115], v11 offset:536
ds_read_b64_tr_b16 a[116:117], v11 offset:128
ds_read_b64_tr_b16 a[118:119], v11 offset:640
v_mfma_f32_16x16x32_bf16 v[140:143], a[32:35], v[184:187], v[140:143]
ds_read_b64_tr_b16 a[120:121], v11 offset:136
ds_read_b64_tr_b16 a[122:123], v11 offset:648
ds_read_b64_tr_b16 a[124:125], v11 offset:144
v_mfma_f32_16x16x32_bf16 v[144:147], a[32:35], v[204:207], v[144:147]
s_waitcnt lgkmcnt(11)
ds_read_b64_tr_b16 a[126:127], v11 offset:656
ds_read_b64_tr_b16 a[128:129], v11 offset:152
ds_read_b64_tr_b16 a[130:131], v11 offset:664
v_mfma_f32_16x16x32_bf16 v[148:151], a[32:35], v[224:227], v[148:151]
ds_read_b128 a[68:71], v7 offset:50688
ds_read_b128 a[72:75], v7 offset:50752
v_mfma_f32_16x16x32_bf16 v[44:47], a[100:103], v[192:195], v[44:47]
ds_read_b128 a[76:79], v7 offset:50816
v_exp_f32 v160, v160
v_mfma_f32_16x16x32_bf16 v[76:79], a[100:103], v[212:215], v[76:79]
s_waitcnt lgkmcnt(15)
ds_read_b128 a[80:83], v7 offset:50880
v_exp_f32 v161, v161
v_mfma_f32_16x16x32_bf16 v[108:111], a[100:103], v[232:235], v[108:111]
ds_read_b128 a[96:99], v7 offset:51392
v_cvt_pk_bf16_f32 v210, v164, v165
v_cvt_pk_bf16_f32 v211, v166, v167
v_mfma_f32_16x16x32_bf16 v[112:115], a[104:107], v[232:235], v[112:115]
ds_read_b128 a[92:95], v7 offset:51328
v_exp_f32 v162, v162
v_mfma_f32_16x16x32_bf16 v[80:83], a[104:107], v[212:215], v[80:83]
s_waitcnt lgkmcnt(14)
v_exp_f32 v163, v163
v_mfma_f32_16x16x32_bf16 v[48:51], a[104:107], v[192:195], v[48:51]
ds_read_b128 a[88:91], v7 offset:51264
v_cvt_pk_bf16_f32 v208, v160, v161
v_cvt_pk_bf16_f32 v209, v162, v163
v_mfma_f32_16x16x32_bf16 v[52:55], a[108:111], v[192:195], v[52:55]
ds_read_b128 a[84:87], v7 offset:51200
v_exp_f32 v168, v168
v_mfma_f32_16x16x32_bf16 v[84:87], a[108:111], v[212:215], v[84:87]
v_exp_f32 v169, v169
v_mfma_f32_16x16x32_bf16 v[116:119], a[108:111], v[232:235], v[116:119]
v_exp_f32 v170, v170
v_cvt_pk_bf16_f32 v228, v168, v169
v_mfma_f32_16x16x32_bf16 v[120:123], a[112:115], v[232:235], v[120:123]
v_exp_f32 v171, v171
v_mfma_f32_16x16x32_bf16 v[88:91], a[112:115], v[212:215], v[88:91]
s_waitcnt lgkmcnt(8)
v_exp_f32 v172, v172
v_exp_f32 v173, v173
v_mfma_f32_16x16x32_bf16 v[56:59], a[112:115], v[192:195], v[56:59]
v_exp_f32 v174, v174
v_cvt_pk_bf16_f32 v229, v170, v171
v_mfma_f32_16x16x32_bf16 v[60:63], a[116:119], v[192:195], v[60:63]
buffer_load_dwordx4 v2, s[8:11], s24 offen offset:0 nt lds
v_cvt_pk_bf16_f32 v230, v172, v173
v_mfma_f32_16x16x32_bf16 v[92:95], a[116:119], v[212:215], v[92:95]
s_add_u32 m0, m0, 32
v_exp_f32 v175, v175
v_mfma_f32_16x16x32_bf16 v[124:127], a[116:119], v[232:235], v[124:127]
buffer_load_dwordx4 v2, s[8:11], s24 offen offset:1024 nt lds
v_cvt_pk_bf16_f32 v231, v174, v175
v_mfma_f32_16x16x32_bf16 v[128:131], a[120:123], v[232:235], v[128:131]
s_xor_b32 s24, s98, 14336
v_mfma_f32_16x16x32_bf16 v[96:99], a[120:123], v[212:215], v[96:99]
s_add_u32 m0, s29, 8448
v_mfma_f32_16x16x32_bf16 v[64:67], a[120:123], v[192:195], v[64:67]
v_mfma_f32_16x16x32_bf16 v[68:71], a[124:127], v[192:195], v[68:71]
v_mfma_f32_16x16x32_bf16 v[100:103], a[124:127], v[212:215], v[100:103]
v_mfma_f32_16x16x32_bf16 v[132:135], a[124:127], v[232:235], v[132:135]
v_mfma_f32_16x16x32_bf16 v[136:139], a[128:131], v[232:235], v[136:139]
v_mfma_f32_16x16x32_bf16 v[104:107], a[128:131], v[212:215], v[104:107]
s_waitcnt lgkmcnt(4)
v_mfma_f32_16x16x32_bf16 v[72:75], a[128:131], v[192:195], v[72:75]
v_mfma_f32_16x16x32_bf16 v[152:155], a[68:71], a[0:3], v[32:35]
v_mfma_f32_16x16x32_bf16 v[152:155], a[72:75], a[4:7], v[152:155]
v_mfma_f32_16x16x32_bf16 v[152:155], a[76:79], a[8:11], v[152:155]
s_waitcnt lgkmcnt(0)
v_mfma_f32_16x16x32_bf16 v[152:155], a[80:83], a[12:15], v[152:155]
v_mfma_f32_16x16x32_bf16 v[156:159], a[96:99], a[12:15], v[32:35]
v_mfma_f32_16x16x32_bf16 v[156:159], a[92:95], a[8:11], v[156:159]
v_mfma_f32_16x16x32_bf16 v[156:159], a[88:91], a[4:7], v[156:159]
v_mfma_f32_16x16x32_bf16 v[156:159], a[84:87], a[0:3], v[156:159]
v_mfma_f32_16x16x32_bf16 v[164:167], a[84:87], a[16:19], v[36:39]
v_mfma_f32_16x16x32_bf16 v[164:167], a[88:91], a[20:23], v[164:167]
v_mfma_f32_16x16x32_bf16 v[164:167], a[92:95], a[24:27], v[164:167]
v_exp_f32 v152, v152
v_exp_f32 v153, v153
v_exp_f32 v154, v154
v_exp_f32 v155, v155
v_exp_f32 v156, v156
v_exp_f32 v157, v157
v_exp_f32 v158, v158
v_exp_f32 v159, v159
v_mfma_f32_16x16x32_bf16 v[164:167], a[96:99], a[28:31], v[164:167]
v_cvt_pk_bf16_f32 v192, v152, v153
v_cvt_pk_bf16_f32 v193, v154, v155
v_cvt_pk_bf16_f32 v194, v156, v157
v_cvt_pk_bf16_f32 v195, v158, v159
v_mfma_f32_16x16x32_bf16 v[160:163], a[80:83], a[28:31], v[36:39]
v_mfma_f32_16x16x32_bf16 v[160:163], a[76:79], a[24:27], v[160:163]
v_mfma_f32_16x16x32_bf16 v[160:163], a[72:75], a[20:23], v[160:163]
v_mfma_f32_16x16x32_bf16 v[160:163], a[68:71], a[16:19], v[160:163]
v_mfma_f32_16x16x32_bf16 v[168:171], a[68:71], v[236:239], v[40:43]
buffer_load_dwordx4 v2, s[12:15], s24 offen offset:0 nt lds
v_mfma_f32_16x16x32_bf16 v[168:171], a[72:75], v[240:243], v[168:171]
s_add_u32 m0, m0, 8
v_mfma_f32_16x16x32_bf16 v[168:171], a[76:79], v[244:247], v[168:171]
v_exp_f32 v164, v164
v_exp_f32 v165, v165
v_exp_f32 v166, v166
v_exp_f32 v167, v167
v_mfma_f32_16x16x32_bf16 v[168:171], a[80:83], v[248:251], v[168:171]
s_waitcnt vmcnt(7)
s_barrier
v_mfma_f32_16x16x32_bf16 v[172:175], a[96:99], v[248:251], v[40:43]
ds_read_b64_tr_b16 a[132:133], v11 offset:16896
ds_read_b64_tr_b16 a[134:135], v11 offset:17408
ds_read_b64_tr_b16 a[136:137], v11 offset:16904
v_mfma_f32_16x16x32_bf16 v[172:175], a[92:95], v[244:247], v[172:175]
ds_read_b64_tr_b16 a[138:139], v11 offset:17416
buffer_load_dwordx4 v2, s[12:15], s24 offen offset:1024 nt lds
v_mfma_f32_16x16x32_bf16 v[172:175], a[88:91], v[240:243], v[172:175]
s_xor_b32 s24, s98, 26624
ds_read_b64_tr_b16 a[140:141], v11 offset:16912
ds_read_b64_tr_b16 a[142:143], v11 offset:17424
ds_read_b64_tr_b16 a[144:145], v11 offset:16920
v_mfma_f32_16x16x32_bf16 v[172:175], a[84:87], v[236:239], v[172:175]
s_add_u32 m0, s23, 16896
ds_read_b64_tr_b16 a[146:147], v11 offset:17432
ds_read_b64_tr_b16 a[148:149], v11 offset:17024
ds_read_b64_tr_b16 a[150:151], v11 offset:17536
v_mfma_f32_16x16x32_bf16 v[140:143], a[32:35], v[188:191], v[140:143]
ds_read_b64_tr_b16 a[152:153], v11 offset:17032
ds_read_b64_tr_b16 a[154:155], v11 offset:17544
ds_read_b64_tr_b16 a[156:157], v11 offset:17040
v_mfma_f32_16x16x32_bf16 v[144:147], a[32:35], v[208:211], v[144:147]
s_waitcnt lgkmcnt(11)
ds_read_b64_tr_b16 a[158:159], v11 offset:17552
ds_read_b64_tr_b16 a[160:161], v11 offset:17048
v_mfma_f32_16x16x32_bf16 v[148:151], a[32:35], v[228:231], v[148:151]
ds_read_b128 a[36:39], v8 offset:8448
ds_read_b128 a[40:43], v8 offset:8512
ds_read_b64_tr_b16 a[162:163], v11 offset:17560
v_mfma_f32_16x16x32_bf16 v[44:47], a[132:135], v[176:179], v[44:47]
ds_read_b128 a[44:47], v8 offset:8576
v_exp_f32 v160, v160
v_mfma_f32_16x16x32_bf16 v[76:79], a[132:135], v[196:199], v[76:79]
s_waitcnt lgkmcnt(15)
ds_read_b128 a[48:51], v8 offset:8640
v_exp_f32 v161, v161
v_mfma_f32_16x16x32_bf16 v[108:111], a[132:135], v[216:219], v[108:111]
ds_read_b128 a[64:67], v8 offset:9152
v_cvt_pk_bf16_f32 v214, v164, v165
v_cvt_pk_bf16_f32 v215, v166, v167
v_mfma_f32_16x16x32_bf16 v[112:115], a[136:139], v[216:219], v[112:115]
ds_read_b128 a[60:63], v8 offset:9088
v_cvt_pk_bf16_f32 v212, v160, v161
v_mfma_f32_16x16x32_bf16 v[80:83], a[136:139], v[196:199], v[80:83]
s_waitcnt lgkmcnt(14)
v_exp_f32 v162, v162
v_mfma_f32_16x16x32_bf16 v[48:51], a[136:139], v[176:179], v[48:51]
ds_read_b128 a[56:59], v8 offset:9024
v_exp_f32 v163, v163
v_mfma_f32_16x16x32_bf16 v[52:55], a[140:143], v[176:179], v[52:55]
ds_read_b128 a[52:55], v8 offset:8960
v_cvt_pk_bf16_f32 v213, v162, v163
v_exp_f32 v168, v168
v_mfma_f32_16x16x32_bf16 v[84:87], a[140:143], v[196:199], v[84:87]
v_exp_f32 v169, v169
v_mfma_f32_16x16x32_bf16 v[116:119], a[140:143], v[216:219], v[116:119]
v_exp_f32 v170, v170
v_exp_f32 v171, v171
v_mfma_f32_16x16x32_bf16 v[120:123], a[144:147], v[216:219], v[120:123]
v_exp_f32 v172, v172
v_mfma_f32_16x16x32_bf16 v[88:91], a[144:147], v[196:199], v[88:91]
s_waitcnt lgkmcnt(6)
v_exp_f32 v173, v173
v_cvt_pk_bf16_f32 v232, v168, v169
v_mfma_f32_16x16x32_bf16 v[56:59], a[144:147], v[176:179], v[56:59]
v_exp_f32 v174, v174
v_cvt_pk_bf16_f32 v233, v170, v171
v_mfma_f32_16x16x32_bf16 v[60:63], a[148:151], v[176:179], v[60:63]
buffer_load_dwordx4 v2, s[8:11], s24 offen offset:0 nt lds
v_cvt_pk_bf16_f32 v234, v172, v173
v_mfma_f32_16x16x32_bf16 v[92:95], a[148:151], v[196:199], v[92:95]
s_add_u32 m0, m0, 32
v_exp_f32 v175, v175
v_mfma_f32_16x16x32_bf16 v[124:127], a[148:151], v[216:219], v[124:127]
buffer_load_dwordx4 v2, s[8:11], s24 offen offset:1024 nt lds
v_cvt_pk_bf16_f32 v235, v174, v175
v_mfma_f32_16x16x32_bf16 v[128:131], a[152:155], v[216:219], v[128:131]
s_xor_b32 s24, s98, 16384
v_mfma_f32_16x16x32_bf16 v[96:99], a[152:155], v[196:199], v[96:99]
s_add_u32 m0, s29, 25344
v_mfma_f32_16x16x32_bf16 v[64:67], a[152:155], v[176:179], v[64:67]
v_mfma_f32_16x16x32_bf16 v[68:71], a[156:159], v[176:179], v[68:71]
v_mfma_f32_16x16x32_bf16 v[100:103], a[156:159], v[196:199], v[100:103]
v_mfma_f32_16x16x32_bf16 v[132:135], a[156:159], v[216:219], v[132:135]
v_mfma_f32_16x16x32_bf16 v[136:139], a[160:163], v[216:219], v[136:139]
v_mfma_f32_16x16x32_bf16 v[104:107], a[160:163], v[196:199], v[104:107]
s_waitcnt lgkmcnt(4)
v_mfma_f32_16x16x32_bf16 v[72:75], a[160:163], v[176:179], v[72:75]
v_mfma_f32_16x16x32_bf16 v[152:155], a[36:39], a[0:3], v[32:35]
v_mfma_f32_16x16x32_bf16 v[152:155], a[40:43], a[4:7], v[152:155]
v_mfma_f32_16x16x32_bf16 v[152:155], a[44:47], a[8:11], v[152:155]
s_waitcnt lgkmcnt(0)
v_mfma_f32_16x16x32_bf16 v[152:155], a[48:51], a[12:15], v[152:155]
v_mfma_f32_16x16x32_bf16 v[156:159], a[64:67], a[12:15], v[32:35]
v_mfma_f32_16x16x32_bf16 v[156:159], a[60:63], a[8:11], v[156:159]
v_mfma_f32_16x16x32_bf16 v[156:159], a[56:59], a[4:7], v[156:159]
v_mfma_f32_16x16x32_bf16 v[156:159], a[52:55], a[0:3], v[156:159]
v_mfma_f32_16x16x32_bf16 v[164:167], a[52:55], a[16:19], v[36:39]
v_mfma_f32_16x16x32_bf16 v[164:167], a[56:59], a[20:23], v[164:167]
v_mfma_f32_16x16x32_bf16 v[164:167], a[60:63], a[24:27], v[164:167]
v_exp_f32 v152, v152
v_exp_f32 v153, v153
v_exp_f32 v154, v154
v_exp_f32 v155, v155
v_exp_f32 v156, v156
v_exp_f32 v157, v157
v_exp_f32 v158, v158
v_exp_f32 v159, v159
v_mfma_f32_16x16x32_bf16 v[164:167], a[64:67], a[28:31], v[164:167]
v_cvt_pk_bf16_f32 v176, v152, v153
v_cvt_pk_bf16_f32 v177, v154, v155
v_cvt_pk_bf16_f32 v178, v156, v157
v_cvt_pk_bf16_f32 v179, v158, v159
v_mfma_f32_16x16x32_bf16 v[160:163], a[48:51], a[28:31], v[36:39]
v_mfma_f32_16x16x32_bf16 v[160:163], a[44:47], a[24:27], v[160:163]
v_mfma_f32_16x16x32_bf16 v[160:163], a[40:43], a[20:23], v[160:163]
v_mfma_f32_16x16x32_bf16 v[160:163], a[36:39], a[16:19], v[160:163]
v_mfma_f32_16x16x32_bf16 v[168:171], a[36:39], v[236:239], v[40:43]
buffer_load_dwordx4 v2, s[12:15], s24 offen offset:0 nt lds
v_mfma_f32_16x16x32_bf16 v[168:171], a[40:43], v[240:243], v[168:171]
s_add_u32 m0, m0, 8
v_mfma_f32_16x16x32_bf16 v[168:171], a[44:47], v[244:247], v[168:171]
v_exp_f32 v164, v164
v_exp_f32 v165, v165
v_exp_f32 v166, v166
v_exp_f32 v167, v167
v_mfma_f32_16x16x32_bf16 v[168:171], a[48:51], v[248:251], v[168:171]
s_waitcnt vmcnt(7)
s_barrier
v_mfma_f32_16x16x32_bf16 v[172:175], a[64:67], v[248:251], v[40:43]
ds_read_b64_tr_b16 a[164:165], v11 offset:33792
ds_read_b64_tr_b16 a[166:167], v11 offset:34304
buffer_load_dwordx4 v2, s[12:15], s24 offen offset:1024 nt lds
v_mfma_f32_16x16x32_bf16 v[172:175], a[60:63], v[244:247], v[172:175]
s_xor_b32 s24, s98, 28672
ds_read_b64_tr_b16 a[168:169], v11 offset:33800
ds_read_b64_tr_b16 a[170:171], v11 offset:34312
ds_read_b64_tr_b16 a[172:173], v11 offset:33808
v_mfma_f32_16x16x32_bf16 v[172:175], a[56:59], v[240:243], v[172:175]
s_add_u32 m0, s23, 33792
ds_read_b64_tr_b16 a[174:175], v11 offset:34320
ds_read_b64_tr_b16 a[176:177], v11 offset:33816
ds_read_b64_tr_b16 a[178:179], v11 offset:34328
v_mfma_f32_16x16x32_bf16 v[172:175], a[52:55], v[236:239], v[172:175]
ds_read_b64_tr_b16 a[180:181], v11 offset:33920
ds_read_b64_tr_b16 a[182:183], v11 offset:34432
v_mfma_f32_16x16x32_bf16 v[140:143], a[32:35], v[192:195], v[140:143]
ds_read_b64_tr_b16 a[184:185], v11 offset:33928
ds_read_b64_tr_b16 a[186:187], v11 offset:34440
ds_read_b64_tr_b16 a[188:189], v11 offset:33936
v_mfma_f32_16x16x32_bf16 v[144:147], a[32:35], v[212:215], v[144:147]
s_waitcnt lgkmcnt(11)
ds_read_b64_tr_b16 a[190:191], v11 offset:34448
ds_read_b64_tr_b16 a[192:193], v11 offset:33944
ds_read_b64_tr_b16 a[194:195], v11 offset:34456
v_mfma_f32_16x16x32_bf16 v[148:151], a[32:35], v[232:235], v[148:151]
L_touch2:
s_cbranch_scc1 L_touch_ret
ds_read_b128 a[68:71], v8 offset:25344
ds_read_b128 a[72:75], v8 offset:25408
v_mfma_f32_16x16x32_bf16 v[44:47], a[164:167], v[180:183], v[44:47]
ds_read_b128 a[76:79], v8 offset:25472
v_exp_f32 v160, v160
v_mfma_f32_16x16x32_bf16 v[76:79], a[164:167], v[200:203], v[76:79]
s_waitcnt lgkmcnt(15)
ds_read_b128 a[80:83], v8 offset:25536
v_exp_f32 v161, v161
v_mfma_f32_16x16x32_bf16 v[108:111], a[164:167], v[220:223], v[108:111]
ds_read_b128 a[96:99], v8 offset:26048
v_cvt_pk_bf16_f32 v198, v164, v165
v_mfma_f32_16x16x32_bf16 v[112:115], a[168:171], v[220:223], v[112:115]
ds_read_b128 a[92:95], v8 offset:25984
v_exp_f32 v162, v162
v_mfma_f32_16x16x32_bf16 v[80:83], a[168:171], v[200:203], v[80:83]
s_waitcnt lgkmcnt(14)
v_exp_f32 v163, v163
v_cvt_pk_bf16_f32 v199, v166, v167
v_mfma_f32_16x16x32_bf16 v[48:51], a[168:171], v[180:183], v[48:51]
ds_read_b128 a[88:91], v8 offset:25920
v_cvt_pk_bf16_f32 v196, v160, v161
v_mfma_f32_16x16x32_bf16 v[52:55], a[172:175], v[180:183], v[52:55]
ds_read_b128 a[84:87], v8 offset:25856
v_exp_f32 v168, v168
v_mfma_f32_16x16x32_bf16 v[84:87], a[172:175], v[200:203], v[84:87]
v_cvt_pk_bf16_f32 v197, v162, v163
v_exp_f32 v169, v169
v_mfma_f32_16x16x32_bf16 v[116:119], a[172:175], v[220:223], v[116:119]
v_exp_f32 v170, v170
v_mfma_f32_16x16x32_bf16 v[120:123], a[176:179], v[220:223], v[120:123]
v_exp_f32 v171, v171
v_cvt_pk_bf16_f32 v216, v168, v169
v_mfma_f32_16x16x32_bf16 v[88:91], a[176:179], v[200:203], v[88:91]
s_waitcnt lgkmcnt(8)
v_exp_f32 v172, v172
v_cvt_pk_bf16_f32 v217, v170, v171
v_mfma_f32_16x16x32_bf16 v[56:59], a[176:179], v[180:183], v[56:59]
v_exp_f32 v173, v173
v_mfma_f32_16x16x32_bf16 v[60:63], a[180:183], v[180:183], v[60:63]
buffer_load_dwordx4 v2, s[8:11], s24 offen offset:0 nt lds
v_cvt_pk_bf16_f32 v218, v172, v173
v_mfma_f32_16x16x32_bf16 v[92:95], a[180:183], v[200:203], v[92:95]
s_add_u32 m0, m0, 32
v_exp_f32 v174, v174
v_mfma_f32_16x16x32_bf16 v[124:127], a[180:183], v[220:223], v[124:127]
buffer_load_dwordx4 v2, s[8:11], s24 offen offset:1024 nt lds
v_mfma_f32_16x16x32_bf16 v[128:131], a[184:187], v[220:223], v[128:131]
s_xor_b32 s24, s98, 18432
v_exp_f32 v175, v175
v_mfma_f32_16x16x32_bf16 v[96:99], a[184:187], v[200:203], v[96:99]
s_add_u32 m0, s29, 42240
v_cvt_pk_bf16_f32 v219, v174, v175
v_mfma_f32_16x16x32_bf16 v[64:67], a[184:187], v[180:183], v[64:67]
v_mfma_f32_16x16x32_bf16 v[68:71], a[188:191], v[180:183], v[68:71]
v_mfma_f32_16x16x32_bf16 v[100:103], a[188:191], v[200:203], v[100:103]
v_mfma_f32_16x16x32_bf16 v[132:135], a[188:191], v[220:223], v[132:135]
v_mfma_f32_16x16x32_bf16 v[136:139], a[192:195], v[220:223], v[136:139]
v_mfma_f32_16x16x32_bf16 v[104:107], a[192:195], v[200:203], v[104:107]
s_waitcnt lgkmcnt(4)
v_mfma_f32_16x16x32_bf16 v[72:75], a[192:195], v[180:183], v[72:75]
v_mfma_f32_16x16x32_bf16 v[152:155], a[68:71], a[0:3], v[32:35]
v_mfma_f32_16x16x32_bf16 v[152:155], a[72:75], a[4:7], v[152:155]
v_mfma_f32_16x16x32_bf16 v[152:155], a[76:79], a[8:11], v[152:155]
s_waitcnt lgkmcnt(0)
v_mfma_f32_16x16x32_bf16 v[152:155], a[80:83], a[12:15], v[152:155]
v_mfma_f32_16x16x32_bf16 v[156:159], a[96:99], a[12:15], v[32:35]
v_mfma_f32_16x16x32_bf16 v[156:159], a[92:95], a[8:11], v[156:159]
v_mfma_f32_16x16x32_bf16 v[156:159], a[88:91], a[4:7], v[156:159]
v_mfma_f32_16x16x32_bf16 v[156:159], a[84:87], a[0:3], v[156:159]
v_mfma_f32_16x16x32_bf16 v[164:167], a[84:87], a[16:19], v[36:39]
v_mfma_f32_16x16x32_bf16 v[164:167], a[88:91], a[20:23], v[164:167]
v_mfma_f32_16x16x32_bf16 v[164:167], a[92:95], a[24:27], v[164:167]
v_exp_f32 v152, v152
v_exp_f32 v153, v153
v_exp_f32 v154, v154
v_exp_f32 v155, v155
v_exp_f32 v156, v156
v_exp_f32 v157, v157
v_exp_f32 v158, v158
v_exp_f32 v159, v159
v_mfma_f32_16x16x32_bf16 v[164:167], a[96:99], a[28:31], v[164:167]
v_cvt_pk_bf16_f32 v180, v152, v153
v_cvt_pk_bf16_f32 v181, v154, v155
v_cvt_pk_bf16_f32 v182, v156, v157
v_mfma_f32_16x16x32_bf16 v[160:163], a[80:83], a[28:31], v[36:39]
v_cvt_pk_bf16_f32 v183, v158, v159
v_mfma_f32_16x16x32_bf16 v[160:163], a[76:79], a[24:27], v[160:163]
v_mfma_f32_16x16x32_bf16 v[160:163], a[72:75], a[20:23], v[160:163]
v_mfma_f32_16x16x32_bf16 v[160:163], a[68:71], a[16:19], v[160:163]
v_mfma_f32_16x16x32_bf16 v[168:171], a[68:71], v[236:239], v[40:43]
buffer_load_dwordx4 v2, s[12:15], s24 offen offset:0 nt lds
v_mfma_f32_16x16x32_bf16 v[168:171], a[72:75], v[240:243], v[168:171]
s_add_u32 m0, m0, 8
v_mfma_f32_16x16x32_bf16 v[168:171], a[76:79], v[244:247], v[168:171]
v_exp_f32 v164, v164
v_exp_f32 v165, v165
v_exp_f32 v166, v166
v_mfma_f32_16x16x32_bf16 v[168:171], a[80:83], v[248:251], v[168:171]
s_waitcnt vmcnt(7)
s_barrier
v_mfma_f32_16x16x32_bf16 v[172:175], a[96:99], v[248:251], v[40:43]
ds_read_b64_tr_b16 a[196:197], v9 offset:8448
ds_read_b64_tr_b16 a[198:199], v9 offset:8960
buffer_load_dwordx4 v2, s[12:15], s24 offen offset:1024 nt lds
v_mfma_f32_16x16x32_bf16 v[172:175], a[92:95], v[244:247], v[172:175]
s_xor_b32 s24, s98, 30720
ds_read_b64_tr_b16 a[200:201], v9 offset:8456
ds_read_b64_tr_b16 a[202:203], v9 offset:8968
ds_read_b64_tr_b16 a[204:205], v9 offset:8464
v_mfma_f32_16x16x32_bf16 v[172:175], a[88:91], v[240:243], v[172:175]
s_add_u32 m0, s23, 50688
ds_read_b64_tr_b16 a[206:207], v9 offset:8976
ds_read_b64_tr_b16 a[208:209], v9 offset:8472
v_mfma_f32_16x16x32_bf16 v[172:175], a[84:87], v[236:239], v[172:175]
ds_read_b64_tr_b16 a[210:211], v9 offset:8984
ds_read_b64_tr_b16 a[212:213], v9 offset:8576
ds_read_b64_tr_b16 a[214:215], v9 offset:9088
v_mfma_f32_16x16x32_bf16 v[140:143], a[32:35], v[176:179], v[140:143]
ds_read_b64_tr_b16 a[216:217], v9 offset:8584
ds_read_b64_tr_b16 a[218:219], v9 offset:9096
ds_read_b64_tr_b16 a[220:221], v9 offset:8592
v_mfma_f32_16x16x32_bf16 v[144:147], a[32:35], v[196:199], v[144:147]
s_waitcnt lgkmcnt(11)
ds_read_b64_tr_b16 a[222:223], v9 offset:9104
ds_read_b64_tr_b16 a[224:225], v9 offset:8600
v_mfma_f32_16x16x32_bf16 v[148:151], a[32:35], v[216:219], v[148:151]
ds_read_b128 a[36:39], v6 offset:0
ds_read_b128 a[40:43], v6 offset:64
ds_read_b64_tr_b16 a[226:227], v9 offset:9112
v_mfma_f32_16x16x32_bf16 v[44:47], a[196:199], v[184:187], v[44:47]
ds_read_b128 a[44:47], v6 offset:128
v_cvt_pk_bf16_f32 v202, v164, v165
v_mfma_f32_16x16x32_bf16 v[76:79], a[196:199], v[204:207], v[76:79]
s_waitcnt lgkmcnt(15)
ds_read_b128 a[48:51], v6 offset:192
v_exp_f32 v167, v167
v_mfma_f32_16x16x32_bf16 v[108:111], a[196:199], v[224:227], v[108:111]
ds_read_b128 a[64:67], v6 offset:704
v_exp_f32 v160, v160
v_mfma_f32_16x16x32_bf16 v[112:115], a[200:203], v[224:227], v[112:115]
ds_read_b128 a[60:63], v6 offset:640
v_cvt_pk_bf16_f32 v203, v166, v167
v_mfma_f32_16x16x32_bf16 v[80:83], a[200:203], v[204:207], v[80:83]
s_waitcnt lgkmcnt(14)
v_exp_f32 v161, v161
v_mfma_f32_16x16x32_bf16 v[48:51], a[200:203], v[184:187], v[48:51]
ds_read_b128 a[56:59], v6 offset:576
v_exp_f32 v162, v162
v_cvt_pk_bf16_f32 v200, v160, v161
v_mfma_f32_16x16x32_bf16 v[52:55], a[204:207], v[184:187], v[52:55]
v_exp_f32 v163, v163
v_mfma_f32_16x16x32_bf16 v[84:87], a[204:207], v[204:207], v[84:87]
ds_read_b128 a[52:55], v6 offset:512
v_exp_f32 v168, v168
v_mfma_f32_16x16x32_bf16 v[116:119], a[204:207], v[224:227], v[116:119]
buffer_load_dwordx4 v2, s[8:11], s24 offen offset:0 nt lds
v_cvt_pk_bf16_f32 v201, v162, v163
v_mfma_f32_16x16x32_bf16 v[120:123], a[208:211], v[224:227], v[120:123]
s_add_u32 m0, m0, 32
v_exp_f32 v169, v169
v_mfma_f32_16x16x32_bf16 v[88:91], a[208:211], v[204:207], v[88:91]
s_waitcnt lgkmcnt(6)
buffer_load_dwordx4 v2, s[8:11], s24 offen offset:1024 nt lds
v_cvt_pk_bf16_f32 v220, v168, v169
v_mfma_f32_16x16x32_bf16 v[56:59], a[208:211], v[184:187], v[56:59]
s_xor_b32 s24, s98, 20480
v_exp_f32 v170, v170
v_mfma_f32_16x16x32_bf16 v[60:63], a[212:215], v[184:187], v[60:63]
s_add_u32 m0, s29, 59136
v_exp_f32 v171, v171
v_mfma_f32_16x16x32_bf16 v[92:95], a[212:215], v[204:207], v[92:95]
v_exp_f32 v172, v172
v_exp_f32 v173, v173
v_mfma_f32_16x16x32_bf16 v[124:127], a[212:215], v[224:227], v[124:127]
v_exp_f32 v174, v174
v_mfma_f32_16x16x32_bf16 v[128:131], a[216:219], v[224:227], v[128:131]
v_exp_f32 v175, v175
v_cvt_pk_bf16_f32 v221, v170, v171
v_mfma_f32_16x16x32_bf16 v[96:99], a[216:219], v[204:207], v[96:99]
v_cvt_pk_bf16_f32 v222, v172, v173
v_cvt_pk_bf16_f32 v223, v174, v175
v_mfma_f32_16x16x32_bf16 v[64:67], a[216:219], v[184:187], v[64:67]
v_mfma_f32_16x16x32_bf16 v[68:71], a[220:223], v[184:187], v[68:71]
v_mfma_f32_16x16x32_bf16 v[100:103], a[220:223], v[204:207], v[100:103]
v_mfma_f32_16x16x32_bf16 v[132:135], a[220:223], v[224:227], v[132:135]
v_mfma_f32_16x16x32_bf16 v[136:139], a[224:227], v[224:227], v[136:139]
v_mfma_f32_16x16x32_bf16 v[104:107], a[224:227], v[204:207], v[104:107]
s_waitcnt lgkmcnt(4)
v_mfma_f32_16x16x32_bf16 v[72:75], a[224:227], v[184:187], v[72:75]
v_mfma_f32_16x16x32_bf16 v[152:155], a[36:39], a[0:3], v[32:35]
v_mfma_f32_16x16x32_bf16 v[152:155], a[40:43], a[4:7], v[152:155]
v_mfma_f32_16x16x32_bf16 v[152:155], a[44:47], a[8:11], v[152:155]
s_waitcnt lgkmcnt(0)
v_mfma_f32_16x16x32_bf16 v[152:155], a[48:51], a[12:15], v[152:155]
v_mfma_f32_16x16x32_bf16 v[156:159], a[64:67], a[12:15], v[32:35]
v_mfma_f32_16x16x32_bf16 v[156:159], a[60:63], a[8:11], v[156:159]
v_mfma_f32_16x16x32_bf16 v[156:159], a[56:59], a[4:7], v[156:159]
v_mfma_f32_16x16x32_bf16 v[156:159], a[52:55], a[0:3], v[156:159]
v_mfma_f32_16x16x32_bf16 v[164:167], a[52:55], a[16:19], v[36:39]
v_mfma_f32_16x16x32_bf16 v[164:167], a[56:59], a[20:23], v[164:167]
v_mfma_f32_16x16x32_bf16 v[164:167], a[60:63], a[24:27], v[164:167]
v_exp_f32 v152, v152
v_exp_f32 v153, v153
v_exp_f32 v154, v154
v_exp_f32 v155, v155
v_exp_f32 v156, v156
v_exp_f32 v157, v157
v_exp_f32 v158, v158
v_mfma_f32_16x16x32_bf16 v[164:167], a[64:67], a[28:31], v[164:167]
v_cvt_pk_bf16_f32 v184, v152, v153
v_cvt_pk_bf16_f32 v185, v154, v155
v_cvt_pk_bf16_f32 v186, v156, v157
v_mfma_f32_16x16x32_bf16 v[160:163], a[48:51], a[28:31], v[36:39]
v_exp_f32 v159, v159
v_mfma_f32_16x16x32_bf16 v[160:163], a[44:47], a[24:27], v[160:163]
v_cvt_pk_bf16_f32 v187, v158, v159
v_mfma_f32_16x16x32_bf16 v[160:163], a[40:43], a[20:23], v[160:163]
v_mfma_f32_16x16x32_bf16 v[160:163], a[36:39], a[16:19], v[160:163]
v_mfma_f32_16x16x32_bf16 v[168:171], a[36:39], v[236:239], v[40:43]
buffer_load_dwordx4 v2, s[12:15], s24 offen offset:0 nt lds
v_mfma_f32_16x16x32_bf16 v[168:171], a[40:43], v[240:243], v[168:171]
s_add_u32 m0, m0, 8
v_mfma_f32_16x16x32_bf16 v[168:171], a[44:47], v[244:247], v[168:171]
v_exp_f32 v164, v164
v_exp_f32 v165, v165
v_exp_f32 v166, v166
v_mfma_f32_16x16x32_bf16 v[168:171], a[48:51], v[248:251], v[168:171]
s_waitcnt vmcnt(7)
s_barrier
v_mfma_f32_16x16x32_bf16 v[172:175], a[64:67], v[248:251], v[40:43]
ds_read_b64_tr_b16 a[100:101], v9 offset:25344
ds_read_b64_tr_b16 a[102:103], v9 offset:25856
ds_read_b64_tr_b16 a[104:105], v9 offset:25352
v_mfma_f32_16x16x32_bf16 v[172:175], a[60:63], v[244:247], v[172:175]
ds_read_b64_tr_b16 a[106:107], v9 offset:25864
buffer_load_dwordx4 v2, s[12:15], s24 offen offset:1024 nt lds
v_mfma_f32_16x16x32_bf16 v[172:175], a[56:59], v[240:243], v[172:175]
s_xor_b32 s24, s98, 22528
ds_read_b64_tr_b16 a[108:109], v9 offset:25360
ds_read_b64_tr_b16 a[110:111], v9 offset:25872
v_mfma_f32_16x16x32_bf16 v[172:175], a[52:55], v[236:239], v[172:175]
s_add_u32 m0, s29, 67584
ds_read_b64_tr_b16 a[112:113], v9 offset:25368
ds_read_b64_tr_b16 a[114:115], v9 offset:25880
ds_read_b64_tr_b16 a[116:117], v9 offset:25472
v_mfma_f32_16x16x32_bf16 v[140:143], a[32:35], v[180:183], v[140:143]
ds_read_b64_tr_b16 a[118:119], v9 offset:25984
ds_read_b64_tr_b16 a[120:121], v9 offset:25480
ds_read_b64_tr_b16 a[122:123], v9 offset:25992
v_mfma_f32_16x16x32_bf16 v[144:147], a[32:35], v[200:203], v[144:147]
s_waitcnt lgkmcnt(10)
ds_read_b64_tr_b16 a[124:125], v9 offset:25488
ds_read_b64_tr_b16 a[126:127], v9 offset:26000
v_mfma_f32_16x16x32_bf16 v[148:151], a[32:35], v[220:223], v[148:151]
ds_read_b128 a[68:71], v6 offset:16896
ds_read_b64_tr_b16 a[128:129], v9 offset:25496
ds_read_b64_tr_b16 a[130:131], v9 offset:26008
v_mfma_f32_16x16x32_bf16 v[44:47], a[100:103], v[188:191], v[44:47]
ds_read_b128 a[72:75], v6 offset:16960
ds_read_b128 a[76:79], v6 offset:17024
v_cvt_pk_bf16_f32 v206, v164, v165
v_mfma_f32_16x16x32_bf16 v[76:79], a[100:103], v[208:211], v[76:79]
s_waitcnt lgkmcnt(15)
v_exp_f32 v167, v167
v_mfma_f32_16x16x32_bf16 v[108:111], a[100:103], v[228:231], v[108:111]
ds_read_b128 a[80:83], v6 offset:17088
ds_read_b128 a[96:99], v6 offset:17600
v_cvt_pk_bf16_f32 v207, v166, v167
v_mfma_f32_16x16x32_bf16 v[112:115], a[104:107], v[228:231], v[112:115]
v_exp_f32 v160, v160
v_mfma_f32_16x16x32_bf16 v[80:83], a[104:107], v[208:211], v[80:83]
s_waitcnt lgkmcnt(13)
ds_read_b128 a[92:95], v6 offset:17536
v_exp_f32 v161, v161
v_mfma_f32_16x16x32_bf16 v[48:51], a[104:107], v[188:191], v[48:51]
ds_read_b128 a[88:91], v6 offset:17472
v_exp_f32 v162, v162
v_mfma_f32_16x16x32_bf16 v[52:55], a[108:111], v[188:191], v[52:55]
ds_read_b128 a[84:87], v6 offset:17408
v_cvt_pk_bf16_f32 v204, v160, v161
v_mfma_f32_16x16x32_bf16 v[84:87], a[108:111], v[208:211], v[84:87]
v_exp_f32 v163, v163
v_mfma_f32_16x16x32_bf16 v[116:119], a[108:111], v[228:231], v[116:119]
v_cvt_pk_bf16_f32 v205, v162, v163
v_exp_f32 v168, v168
v_mfma_f32_16x16x32_bf16 v[120:123], a[112:115], v[228:231], v[120:123]
v_exp_f32 v169, v169
v_mfma_f32_16x16x32_bf16 v[88:91], a[112:115], v[208:211], v[88:91]
s_waitcnt lgkmcnt(7)
v_exp_f32 v170, v170
v_exp_f32 v171, v171
v_mfma_f32_16x16x32_bf16 v[56:59], a[112:115], v[188:191], v[56:59]
v_exp_f32 v172, v172
v_mfma_f32_16x16x32_bf16 v[60:63], a[116:119], v[188:191], v[60:63]
v_exp_f32 v173, v173
v_cvt_pk_bf16_f32 v224, v168, v169
v_mfma_f32_16x16x32_bf16 v[92:95], a[116:119], v[208:211], v[92:95]
v_exp_f32 v174, v174
v_cvt_pk_bf16_f32 v225, v170, v171
v_mfma_f32_16x16x32_bf16 v[124:127], a[116:119], v[228:231], v[124:127]
v_exp_f32 v175, v175
v_mfma_f32_16x16x32_bf16 v[128:131], a[120:123], v[228:231], v[128:131]
v_cvt_pk_bf16_f32 v226, v172, v173
v_cvt_pk_bf16_f32 v227, v174, v175
v_mfma_f32_16x16x32_bf16 v[96:99], a[120:123], v[208:211], v[96:99]
v_mfma_f32_16x16x32_bf16 v[64:67], a[120:123], v[188:191], v[64:67]
v_mfma_f32_16x16x32_bf16 v[68:71], a[124:127], v[188:191], v[68:71]
v_mfma_f32_16x16x32_bf16 v[100:103], a[124:127], v[208:211], v[100:103]
v_mfma_f32_16x16x32_bf16 v[132:135], a[124:127], v[228:231], v[132:135]
v_mfma_f32_16x16x32_bf16 v[136:139], a[128:131], v[228:231], v[136:139]
v_mfma_f32_16x16x32_bf16 v[104:107], a[128:131], v[208:211], v[104:107]
s_waitcnt lgkmcnt(4)
buffer_load_dwordx4 v2, s[12:15], s24 offen offset:0 nt lds
v_mfma_f32_16x16x32_bf16 v[72:75], a[128:131], v[188:191], v[72:75]
s_add_u32 m0, m0, 8
v_mfma_f32_16x16x32_bf16 v[152:155], a[68:71], a[0:3], v[32:35]
buffer_load_dwordx4 v2, s[12:15], s24 offen offset:1024 nt lds
v_mfma_f32_16x16x32_bf16 v[152:155], a[72:75], a[4:7], v[152:155]
s_xor_b32 s24, s101, 24576
v_mfma_f32_16x16x32_bf16 v[152:155], a[76:79], a[8:11], v[152:155]
s_waitcnt lgkmcnt(0)
v_mfma_f32_16x16x32_bf16 v[152:155], a[80:83], a[12:15], v[152:155]
s_add_u32 m0, s29, 76032
v_mfma_f32_16x16x32_bf16 v[156:159], a[96:99], a[12:15], v[32:35]
v_mfma_f32_16x16x32_bf16 v[156:159], a[92:95], a[8:11], v[156:159]
v_mfma_f32_16x16x32_bf16 v[156:159], a[88:91], a[4:7], v[156:159]
buffer_load_dwordx4 v4, s[12:15], s24 offen offset:0 nt lds
v_mfma_f32_16x16x32_bf16 v[156:159], a[84:87], a[0:3], v[156:159]
s_add_u32 m0, m0, 8
v_mfma_f32_16x16x32_bf16 v[164:167], a[84:87], a[16:19], v[36:39]
buffer_load_dwordx4 v4, s[12:15], s24 offen offset:1024 nt lds
v_mfma_f32_16x16x32_bf16 v[164:167], a[88:91], a[20:23], v[164:167]
s_xor_b32 s24, s101, 28672
v_mfma_f32_16x16x32_bf16 v[164:167], a[92:95], a[24:27], v[164:167]
s_add_u32 m0, s29, 84480
v_exp_f32 v152, v152
v_exp_f32 v153, v153
v_exp_f32 v154, v154
v_exp_f32 v155, v155
v_exp_f32 v156, v156
v_exp_f32 v157, v157
v_exp_f32 v158, v158
v_mfma_f32_16x16x32_bf16 v[164:167], a[96:99], a[28:31], v[164:167]
v_cvt_pk_bf16_f32 v188, v152, v153
v_cvt_pk_bf16_f32 v189, v154, v155
v_cvt_pk_bf16_f32 v190, v156, v157
v_mfma_f32_16x16x32_bf16 v[160:163], a[80:83], a[28:31], v[36:39]
v_exp_f32 v159, v159
v_mfma_f32_16x16x32_bf16 v[160:163], a[76:79], a[24:27], v[160:163]
v_cvt_pk_bf16_f32 v191, v158, v159
v_mfma_f32_16x16x32_bf16 v[160:163], a[72:75], a[20:23], v[160:163]
v_mfma_f32_16x16x32_bf16 v[160:163], a[68:71], a[16:19], v[160:163]
v_mfma_f32_16x16x32_bf16 v[168:171], a[68:71], v[236:239], v[40:43]
v_mfma_f32_16x16x32_bf16 v[168:171], a[72:75], v[240:243], v[168:171]
v_mfma_f32_16x16x32_bf16 v[168:171], a[76:79], v[244:247], v[168:171]
v_exp_f32 v164, v164
v_exp_f32 v165, v165
v_exp_f32 v166, v166
v_mfma_f32_16x16x32_bf16 v[168:171], a[80:83], v[248:251], v[168:171]
s_waitcnt vmcnt(8)
s_barrier
v_mfma_f32_16x16x32_bf16 v[172:175], a[96:99], v[248:251], v[40:43]
ds_read_b64_tr_b16 a[132:133], v9 offset:42240
ds_read_b64_tr_b16 a[134:135], v9 offset:42752
ds_read_b64_tr_b16 a[136:137], v9 offset:42248
v_mfma_f32_16x16x32_bf16 v[172:175], a[92:95], v[244:247], v[172:175]
ds_read_b64_tr_b16 a[138:139], v9 offset:42760
ds_read_b64_tr_b16 a[140:141], v9 offset:42256
ds_read_b64_tr_b16 a[142:143], v9 offset:42768
v_mfma_f32_16x16x32_bf16 v[172:175], a[88:91], v[240:243], v[172:175]
ds_read_b64_tr_b16 a[144:145], v9 offset:42264
ds_read_b64_tr_b16 a[146:147], v9 offset:42776
ds_read_b64_tr_b16 a[148:149], v9 offset:42368
v_mfma_f32_16x16x32_bf16 v[172:175], a[84:87], v[236:239], v[172:175]
ds_read_b64_tr_b16 a[150:151], v9 offset:42880
ds_read_b64_tr_b16 a[152:153], v9 offset:42376
v_mfma_f32_16x16x32_bf16 v[140:143], a[32:35], v[184:187], v[140:143]
ds_read_b64_tr_b16 a[154:155], v9 offset:42888
ds_read_b64_tr_b16 a[156:157], v9 offset:42384
ds_read_b64_tr_b16 a[158:159], v9 offset:42896
v_mfma_f32_16x16x32_bf16 v[144:147], a[32:35], v[204:207], v[144:147]
s_waitcnt lgkmcnt(12)
ds_read_b64_tr_b16 a[160:161], v9 offset:42392
ds_read_b64_tr_b16 a[162:163], v9 offset:42904
v_mfma_f32_16x16x32_bf16 v[148:151], a[32:35], v[224:227], v[148:151]
ds_read_b128 a[36:39], v6 offset:33792
ds_read_b128 a[40:43], v6 offset:33856
v_cvt_pk_bf16_f32 v210, v164, v165
v_mfma_f32_16x16x32_bf16 v[44:47], a[132:135], v[192:195], v[44:47]
ds_read_b128 a[44:47], v6 offset:33920
v_exp_f32 v167, v167
v_mfma_f32_16x16x32_bf16 v[76:79], a[132:135], v[212:215], v[76:79]
s_waitcnt lgkmcnt(15)
ds_read_b128 a[48:51], v6 offset:33984
v_cvt_pk_bf16_f32 v211, v166, v167
v_mfma_f32_16x16x32_bf16 v[108:111], a[132:135], v[232:235], v[108:111]
ds_read_b128 a[64:67], v6 offset:34496
v_exp_f32 v160, v160
v_mfma_f32_16x16x32_bf16 v[112:115], a[136:139], v[232:235], v[112:115]
v_exp_f32 v161, v161
v_mfma_f32_16x16x32_bf16 v[80:83], a[136:139], v[212:215], v[80:83]
s_waitcnt lgkmcnt(13)
ds_read_b128 a[60:63], v6 offset:34432
buffer_load_dwordx4 v4, s[12:15], s24 offen offset:0 nt lds
v_mfma_f32_16x16x32_bf16 v[48:51], a[136:139], v[192:195], v[48:51]
s_add_u32 m0, m0, 8
ds_read_b128 a[56:59], v6 offset:34368
v_exp_f32 v162, v162
v_mfma_f32_16x16x32_bf16 v[52:55], a[140:143], v[192:195], v[52:55]
buffer_load_dwordx4 v4, s[12:15], s24 offen offset:1024 nt lds
v_mfma_f32_16x16x32_bf16 v[84:87], a[140:143], v[212:215], v[84:87]
s_xor_b32 s24, s101, 24704
ds_read_b128 a[52:55], v6 offset:34304
v_exp_f32 v163, v163
v_mfma_f32_16x16x32_bf16 v[116:119], a[140:143], v[232:235], v[116:119]
s_add_u32 m0, s29, 92928
v_cvt_pk_bf16_f32 v208, v160, v161
v_cvt_pk_bf16_f32 v209, v162, v163
v_mfma_f32_16x16x32_bf16 v[120:123], a[144:147], v[232:235], v[120:123]
v_exp_f32 v168, v168
v_mfma_f32_16x16x32_bf16 v[88:91], a[144:147], v[212:215], v[88:91]
s_waitcnt lgkmcnt(8)
v_exp_f32 v169, v169
v_mfma_f32_16x16x32_bf16 v[56:59], a[144:147], v[192:195], v[56:59]
v_exp_f32 v170, v170
v_exp_f32 v171, v171
v_mfma_f32_16x16x32_bf16 v[60:63], a[148:151], v[192:195], v[60:63]
v_exp_f32 v172, v172
v_cvt_pk_bf16_f32 v228, v168, v169
v_mfma_f32_16x16x32_bf16 v[92:95], a[148:151], v[212:215], v[92:95]
v_exp_f32 v173, v173
v_mfma_f32_16x16x32_bf16 v[124:127], a[148:151], v[232:235], v[124:127]
v_exp_f32 v174, v174
v_cvt_pk_bf16_f32 v229, v170, v171
v_mfma_f32_16x16x32_bf16 v[128:131], a[152:155], v[232:235], v[128:131]
v_exp_f32 v175, v175
v_mfma_f32_16x16x32_bf16 v[96:99], a[152:155], v[212:215], v[96:99]
v_cvt_pk_bf16_f32 v230, v172, v173
v_cvt_pk_bf16_f32 v231, v174, v175
v_mfma_f32_16x16x32_bf16 v[64:67], a[152:155], v[192:195], v[64:67]
v_mfma_f32_16x16x32_bf16 v[68:71], a[156:159], v[192:195], v[68:71]
v_mfma_f32_16x16x32_bf16 v[100:103], a[156:159], v[212:215], v[100:103]
v_mfma_f32_16x16x32_bf16 v[132:135], a[156:159], v[232:235], v[132:135]
v_mfma_f32_16x16x32_bf16 v[136:139], a[160:163], v[232:235], v[136:139]
v_mfma_f32_16x16x32_bf16 v[104:107], a[160:163], v[212:215], v[104:107]
s_waitcnt lgkmcnt(4)
v_mfma_f32_16x16x32_bf16 v[72:75], a[160:163], v[192:195], v[72:75]
v_mfma_f32_16x16x32_bf16 v[152:155], a[36:39], a[0:3], v[32:35]
v_mfma_f32_16x16x32_bf16 v[152:155], a[40:43], a[4:7], v[152:155]
v_mfma_f32_16x16x32_bf16 v[152:155], a[44:47], a[8:11], v[152:155]
s_waitcnt lgkmcnt(0)
v_mfma_f32_16x16x32_bf16 v[152:155], a[48:51], a[12:15], v[152:155]
buffer_load_dwordx4 v4, s[12:15], s24 offen offset:0 nt lds
v_mfma_f32_16x16x32_bf16 v[156:159], a[64:67], a[12:15], v[32:35]
s_add_u32 m0, m0, 8
v_mfma_f32_16x16x32_bf16 v[156:159], a[60:63], a[8:11], v[156:159]
buffer_load_dwordx4 v4, s[12:15], s24 offen offset:1024 nt lds
v_mfma_f32_16x16x32_bf16 v[156:159], a[56:59], a[4:7], v[156:159]
s_xor_b32 s24, s101, 28800
v_mfma_f32_16x16x32_bf16 v[156:159], a[52:55], a[0:3], v[156:159]
s_add_u32 m0, s29, 101376
v_mfma_f32_16x16x32_bf16 v[164:167], a[52:55], a[16:19], v[36:39]
v_mfma_f32_16x16x32_bf16 v[164:167], a[56:59], a[20:23], v[164:167]
v_mfma_f32_16x16x32_bf16 v[164:167], a[60:63], a[24:27], v[164:167]
v_exp_f32 v152, v152
v_exp_f32 v153, v153
v_exp_f32 v154, v154
v_exp_f32 v155, v155
v_exp_f32 v156, v156
v_exp_f32 v157, v157
v_exp_f32 v158, v158
v_mfma_f32_16x16x32_bf16 v[164:167], a[64:67], a[28:31], v[164:167]
buffer_load_dwordx4 v4, s[12:15], s24 offen offset:0 nt lds
v_mfma_f32_16x16x32_bf16 v[160:163], a[48:51], a[28:31], v[36:39]
s_add_u32 m0, m0, 8
v_cvt_pk_bf16_f32 v192, v152, v153
v_cvt_pk_bf16_f32 v193, v154, v155
v_cvt_pk_bf16_f32 v194, v156, v157
v_mfma_f32_16x16x32_bf16 v[160:163], a[44:47], a[24:27], v[160:163]
buffer_load_dwordx4 v4, s[12:15], s24 offen offset:1024 nt lds
v_mfma_f32_16x16x32_bf16 v[160:163], a[40:43], a[20:23], v[160:163]
v_exp_f32 v159, v159
v_mfma_f32_16x16x32_bf16 v[160:163], a[36:39], a[16:19], v[160:163]
v_cvt_pk_bf16_f32 v195, v158, v159
v_mfma_f32_16x16x32_bf16 v[168:171], a[36:39], v[236:239], v[40:43]
v_mfma_f32_16x16x32_bf16 v[168:171], a[40:43], v[240:243], v[168:171]
v_mfma_f32_16x16x32_bf16 v[168:171], a[44:47], v[244:247], v[168:171]
v_exp_f32 v164, v164
v_exp_f32 v165, v165
v_mfma_f32_16x16x32_bf16 v[168:171], a[48:51], v[248:251], v[168:171]
s_waitcnt vmcnt(10)
s_barrier
v_mfma_f32_16x16x32_bf16 v[172:175], a[64:67], v[248:251], v[40:43]
ds_read_b64_tr_b16 a[164:165], v10 offset:0
ds_read_b64_tr_b16 a[166:167], v10 offset:512
ds_read_b64_tr_b16 a[168:169], v10 offset:8
v_cvt_pk_bf16_f32 v214, v164, v165
v_mfma_f32_16x16x32_bf16 v[172:175], a[60:63], v[244:247], v[172:175]
v_exp_f32 v166, v166
v_mfma_f32_16x16x32_bf16 v[172:175], a[56:59], v[240:243], v[172:175]
ds_read_b64_tr_b16 a[170:171], v10 offset:520
ds_read_b64_tr_b16 a[172:173], v10 offset:16
v_mfma_f32_16x16x32_bf16 v[172:175], a[52:55], v[236:239], v[172:175]
v_exp_f32 v167, v167
v_mfma_f32_16x16x32_bf16 v[140:143], a[32:35], v[188:191], v[140:143]
ds_read_b64_tr_b16 a[174:175], v10 offset:528
ds_read_b64_tr_b16 a[176:177], v10 offset:24
v_mfma_f32_16x16x32_bf16 v[144:147], a[32:35], v[208:211], v[144:147]
s_waitcnt lgkmcnt(5)
ds_read_b64_tr_b16 a[178:179], v10 offset:536
ds_read_b64_tr_b16 a[180:181], v10 offset:128
v_mfma_f32_16x16x32_bf16 v[148:151], a[32:35], v[228:231], v[148:151]
ds_read_b64_tr_b16 a[182:183], v10 offset:640
v_cvt_pk_bf16_f32 v215, v166, v167
v_mfma_f32_16x16x32_bf16 v[44:47], a[164:167], v[176:179], v[44:47]
ds_read_b64_tr_b16 a[184:185], v10 offset:136
v_exp_f32 v160, v160
v_mfma_f32_16x16x32_bf16 v[76:79], a[164:167], v[196:199], v[76:79]
s_waitcnt lgkmcnt(7)
v_exp_f32 v161, v161
v_mfma_f32_16x16x32_bf16 v[108:111], a[164:167], v[216:219], v[108:111]
ds_read_b64_tr_b16 a[186:187], v10 offset:648
ds_read_b64_tr_b16 a[188:189], v10 offset:144
v_mfma_f32_16x16x32_bf16 v[112:115], a[168:171], v[216:219], v[112:115]
ds_read_b64_tr_b16 a[190:191], v10 offset:656
v_cvt_pk_bf16_f32 v212, v160, v161
v_mfma_f32_16x16x32_bf16 v[80:83], a[168:171], v[196:199], v[80:83]
s_waitcnt lgkmcnt(6)
ds_read_b64_tr_b16 a[192:193], v10 offset:152
ds_read_b64_tr_b16 a[194:195], v10 offset:664
v_mfma_f32_16x16x32_bf16 v[48:51], a[168:171], v[176:179], v[48:51]
v_exp_f32 v162, v162
v_mfma_f32_16x16x32_bf16 v[52:55], a[172:175], v[176:179], v[52:55]
v_exp_f32 v163, v163
v_mfma_f32_16x16x32_bf16 v[84:87], a[172:175], v[196:199], v[84:87]
ds_read_b128 a[68:71], v6 offset:50688
v_exp_f32 v168, v168
v_mfma_f32_16x16x32_bf16 v[116:119], a[172:175], v[216:219], v[116:119]
ds_read_b128 a[72:75], v6 offset:50752
v_cvt_pk_bf16_f32 v213, v162, v163
v_mfma_f32_16x16x32_bf16 v[120:123], a[176:179], v[216:219], v[120:123]
v_exp_f32 v169, v169
v_mfma_f32_16x16x32_bf16 v[88:91], a[176:179], v[196:199], v[88:91]
s_waitcnt lgkmcnt(2)
ds_read_b128 a[76:79], v6 offset:50816
v_cvt_pk_bf16_f32 v232, v168, v169
v_mfma_f32_16x16x32_bf16 v[56:59], a[176:179], v[176:179], v[56:59]
v_exp_f32 v170, v170
v_mfma_f32_16x16x32_bf16 v[60:63], a[180:183], v[176:179], v[60:63]
v_exp_f32 v171, v171
v_mfma_f32_16x16x32_bf16 v[92:95], a[180:183], v[196:199], v[92:95]
ds_read_b128 a[80:83], v6 offset:50880
v_cvt_pk_bf16_f32 v233, v170, v171
v_mfma_f32_16x16x32_bf16 v[124:127], a[180:183], v[216:219], v[124:127]
ds_read_b128 a[96:99], v6 offset:51392
v_exp_f32 v172, v172
v_mfma_f32_16x16x32_bf16 v[128:131], a[184:187], v[216:219], v[128:131]
v_exp_f32 v173, v173
v_mfma_f32_16x16x32_bf16 v[96:99], a[184:187], v[196:199], v[96:99]
ds_read_b128 a[92:95], v6 offset:51328
v_cvt_pk_bf16_f32 v234, v172, v173
v_mfma_f32_16x16x32_bf16 v[64:67], a[184:187], v[176:179], v[64:67]
v_exp_f32 v174, v174
v_mfma_f32_16x16x32_bf16 v[68:71], a[188:191], v[176:179], v[68:71]
v_exp_f32 v175, v175
v_mfma_f32_16x16x32_bf16 v[100:103], a[188:191], v[196:199], v[100:103]
ds_read_b128 a[88:91], v6 offset:51264
v_cvt_pk_bf16_f32 v235, v174, v175
v_mfma_f32_16x16x32_bf16 v[132:135], a[188:191], v[216:219], v[132:135]
ds_read_b128 a[84:87], v6 offset:51200
v_mfma_f32_16x16x32_bf16 v[136:139], a[192:195], v[216:219], v[136:139]
v_mfma_f32_16x16x32_bf16 v[104:107], a[192:195], v[196:199], v[104:107]
s_waitcnt lgkmcnt(4)
v_mfma_f32_16x16x32_bf16 v[72:75], a[192:195], v[176:179], v[72:75]
v_mfma_f32_16x16x32_bf16 v[152:155], a[68:71], a[0:3], v[32:35]
v_mfma_f32_16x16x32_bf16 v[152:155], a[72:75], a[4:7], v[152:155]
v_mfma_f32_16x16x32_bf16 v[152:155], a[76:79], a[8:11], v[152:155]
s_waitcnt lgkmcnt(0)
v_mfma_f32_16x16x32_bf16 v[152:155], a[80:83], a[12:15], v[152:155]
v_mfma_f32_16x16x32_bf16 v[156:159], a[96:99], a[12:15], v[32:35]
v_mfma_f32_16x16x32_bf16 v[156:159], a[92:95], a[8:11], v[156:159]
v_mfma_f32_16x16x32_bf16 v[156:159], a[88:91], a[4:7], v[156:159]
v_mfma_f32_16x16x32_bf16 v[156:159], a[84:87], a[0:3], v[156:159]
s_waitcnt vmcnt(6)
s_barrier
v_mfma_f32_16x16x32_bf16 v[164:167], a[84:87], a[16:19], v[36:39]
L_touch3:
s_cbranch_scc1 L_touch_ret
ds_read_b64_tr_b16 a[196:197], v10 offset:8448
ds_read_b64_tr_b16 a[198:199], v10 offset:8960
v_mfma_f32_16x16x32_bf16 v[164:167], a[88:91], a[20:23], v[164:167]
ds_read_b64_tr_b16 a[200:201], v10 offset:8456
ds_read_b64_tr_b16 a[202:203], v10 offset:8968
v_mfma_f32_16x16x32_bf16 v[164:167], a[92:95], a[24:27], v[164:167]
v_exp_f32 v152, v152
v_mfma_f32_16x16x32_bf16 v[164:167], a[96:99], a[28:31], v[164:167]
ds_read_b64_tr_b16 a[204:205], v10 offset:8464
ds_read_b64_tr_b16 a[206:207], v10 offset:8976
v_mfma_f32_16x16x32_bf16 v[160:163], a[80:83], a[28:31], v[36:39]
v_exp_f32 v153, v153
v_mfma_f32_16x16x32_bf16 v[160:163], a[76:79], a[24:27], v[160:163]
ds_read_b64_tr_b16 a[208:209], v10 offset:8472
ds_read_b64_tr_b16 a[210:211], v10 offset:8984
v_mfma_f32_16x16x32_bf16 v[160:163], a[72:75], a[20:23], v[160:163]
ds_read_b64_tr_b16 a[212:213], v10 offset:8576
v_cvt_pk_bf16_f32 v176, v152, v153
v_mfma_f32_16x16x32_bf16 v[160:163], a[68:71], a[16:19], v[160:163]
v_exp_f32 v154, v154
v_mfma_f32_16x16x32_bf16 v[168:171], a[68:71], v[236:239], v[40:43]
ds_read_b64_tr_b16 a[214:215], v10 offset:9088
ds_read_b64_tr_b16 a[216:217], v10 offset:8584
v_mfma_f32_16x16x32_bf16 v[168:171], a[72:75], v[240:243], v[168:171]
ds_read_b64_tr_b16 a[218:219], v10 offset:9096
ds_read_b64_tr_b16 a[220:221], v10 offset:8592
v_mfma_f32_16x16x32_bf16 v[168:171], a[76:79], v[244:247], v[168:171]
v_exp_f32 v155, v155
v_mfma_f32_16x16x32_bf16 v[168:171], a[80:83], v[248:251], v[168:171]
ds_read_b64_tr_b16 a[222:223], v10 offset:9104
ds_read_b64_tr_b16 a[224:225], v10 offset:8600
v_mfma_f32_16x16x32_bf16 v[172:175], a[96:99], v[248:251], v[40:43]
ds_read_b64_tr_b16 a[226:227], v10 offset:9112
v_cvt_pk_bf16_f32 v177, v154, v155
v_mfma_f32_16x16x32_bf16 v[172:175], a[92:95], v[244:247], v[172:175]
v_exp_f32 v156, v156
v_mfma_f32_16x16x32_bf16 v[172:175], a[88:91], v[240:243], v[172:175]
ds_read_b64_tr_b16 a[100:101], v12 offset:0
ds_read_b64_tr_b16 a[102:103], v12 offset:256
v_mfma_f32_16x16x32_bf16 v[172:175], a[84:87], v[236:239], v[172:175]
v_exp_f32 v157, v157
v_mfma_f32_16x16x32_bf16 v[140:143], a[32:35], v[192:195], v[140:143]
ds_read_b64_tr_b16 a[104:105], v12 offset:8
ds_read_b64_tr_b16 a[106:107], v12 offset:264
v_mfma_f32_16x16x32_bf16 v[144:147], a[32:35], v[212:215], v[144:147]
s_waitcnt lgkmcnt(15)
ds_read_b64_tr_b16 a[108:109], v12 offset:16
v_cvt_pk_bf16_f32 v178, v156, v157
v_mfma_f32_16x16x32_bf16 v[148:151], a[32:35], v[232:235], v[148:151]
ds_read_b64_tr_b16 a[110:111], v12 offset:272
ds_read_b64_tr_b16 a[112:113], v12 offset:24
v_mfma_f32_16x16x32_bf16 v[44:47], a[196:199], v[180:183], v[44:47]
v_exp_f32 v158, v158
v_mfma_f32_16x16x32_bf16 v[76:79], a[196:199], v[200:203], v[76:79]
ds_read_b64_tr_b16 a[114:115], v12 offset:280
ds_read_b64_tr_b16 a[116:117], v12 offset:512
v_mfma_f32_16x16x32_bf16 v[108:111], a[196:199], v[220:223], v[108:111]
v_exp_f32 v159, v159
v_mfma_f32_16x16x32_bf16 v[112:115], a[200:203], v[220:223], v[112:115]
ds_read_b64_tr_b16 a[118:119], v12 offset:768
v_cvt_pk_bf16_f32 v179, v158, v159
v_mfma_f32_16x16x32_bf16 v[80:83], a[200:203], v[200:203], v[80:83]
s_waitcnt lgkmcnt(15)
ds_read_b64_tr_b16 a[120:121], v12 offset:520
ds_read_b64_tr_b16 a[122:123], v12 offset:776
v_mfma_f32_16x16x32_bf16 v[48:51], a[200:203], v[180:183], v[48:51]
v_exp_f32 v164, v164
v_mfma_f32_16x16x32_bf16 v[52:55], a[204:207], v[180:183], v[52:55]
ds_read_b64_tr_b16 a[124:125], v12 offset:528
ds_read_b64_tr_b16 a[126:127], v12 offset:784
v_mfma_f32_16x16x32_bf16 v[84:87], a[204:207], v[200:203], v[84:87]
v_exp_f32 v165, v165
v_mfma_f32_16x16x32_bf16 v[116:119], a[204:207], v[220:223], v[116:119]
ds_read_b64_tr_b16 a[128:129], v12 offset:536
ds_read_b64_tr_b16 a[130:131], v12 offset:792
v_mfma_f32_16x16x32_bf16 v[120:123], a[208:211], v[220:223], v[120:123]
v_exp_f32 v166, v166
v_mfma_f32_16x16x32_bf16 v[88:91], a[208:211], v[200:203], v[88:91]
s_waitcnt lgkmcnt(15)
v_exp_f32 v167, v167
v_mfma_f32_16x16x32_bf16 v[56:59], a[208:211], v[180:183], v[56:59]
v_exp_f32 v160, v160
v_mfma_f32_16x16x32_bf16 v[60:63], a[212:215], v[180:183], v[60:63]
v_exp_f32 v161, v161
v_mfma_f32_16x16x32_bf16 v[92:95], a[212:215], v[200:203], v[92:95]
s_waitcnt vmcnt(4)
s_barrier
v_mfma_f32_16x16x32_bf16 v[124:127], a[212:215], v[220:223], v[124:127]
ds_read_b64_tr_b16 a[132:133], v12 offset:8448
ds_read_b64_tr_b16 a[134:135], v12 offset:8704
v_mfma_f32_16x16x32_bf16 v[128:131], a[216:219], v[220:223], v[128:131]
ds_read_b64_tr_b16 a[136:137], v12 offset:8456
ds_read_b64_tr_b16 a[138:139], v12 offset:8712
v_mfma_f32_16x16x32_bf16 v[96:99], a[216:219], v[200:203], v[96:99]
ds_read_b64_tr_b16 a[140:141], v12 offset:8464
v_cvt_pk_bf16_f32 v198, v164, v165
v_mfma_f32_16x16x32_bf16 v[64:67], a[216:219], v[180:183], v[64:67]
ds_read_b64_tr_b16 a[142:143], v12 offset:8720
v_cvt_pk_bf16_f32 v199, v166, v167
v_mfma_f32_16x16x32_bf16 v[68:71], a[220:223], v[180:183], v[68:71]
ds_read_b64_tr_b16 a[144:145], v12 offset:8472
v_cvt_pk_bf16_f32 v196, v160, v161
v_mfma_f32_16x16x32_bf16 v[100:103], a[220:223], v[200:203], v[100:103]
v_exp_f32 v162, v162
v_mfma_f32_16x16x32_bf16 v[132:135], a[220:223], v[220:223], v[132:135]
ds_read_b64_tr_b16 a[146:147], v12 offset:8728
ds_read_b64_tr_b16 a[148:149], v12 offset:8960
v_mfma_f32_16x16x32_bf16 v[136:139], a[224:227], v[220:223], v[136:139]
v_exp_f32 v163, v163
v_mfma_f32_16x16x32_bf16 v[104:107], a[224:227], v[200:203], v[104:107]
ds_read_b64_tr_b16 a[150:151], v12 offset:9216
ds_read_b64_tr_b16 a[152:153], v12 offset:8968
v_mfma_f32_16x16x32_bf16 v[72:75], a[224:227], v[180:183], v[72:75]
s_waitcnt lgkmcnt(15)
ds_read_b64_tr_b16 a[154:155], v12 offset:9224
ds_read_b64_tr_b16 a[156:157], v12 offset:8976
v_mfma_f32_16x16x32_bf16 v[140:143], a[32:35], v[176:179], v[140:143]
s_mov_b32 vcc_lo, 0xaaaaaaaa
ds_read_b64_tr_b16 a[158:159], v12 offset:9232
v_cvt_pk_bf16_f32 v197, v162, v163
v_mfma_f32_16x16x32_bf16 v[44:47], a[100:103], v[184:187], v[44:47]
s_mov_b32 vcc_hi, 0xaaaaaaaa
v_exp_f32 v168, v168
v_mfma_f32_16x16x32_bf16 v[48:51], a[104:107], v[184:187], v[48:51]
ds_read_b64_tr_b16 a[160:161], v12 offset:8984
ds_read_b64_tr_b16 a[162:163], v12 offset:9240
v_mfma_f32_16x16x32_bf16 v[52:55], a[108:111], v[184:187], v[52:55]
s_waitcnt lgkmcnt(15)
v_exp_f32 v169, v169
v_mfma_f32_16x16x32_bf16 v[56:59], a[112:115], v[184:187], v[56:59]
v_rcp_f32 v32, v140
v_mfma_f32_16x16x32_bf16 v[44:47], a[116:119], v[188:191], v[44:47]
v_cvt_pk_bf16_f32 v216, v168, v169
v_mov_b32 v33, v32
v_mfma_f32_16x16x32_bf16 v[48:51], a[120:123], v[188:191], v[48:51]
v_exp_f32 v170, v170
v_mfma_f32_16x16x32_bf16 v[52:55], a[124:127], v[188:191], v[52:55]
s_waitcnt lgkmcnt(8)
v_exp_f32 v171, v171
v_mfma_f32_16x16x32_bf16 v[56:59], a[128:131], v[188:191], v[56:59]
s_waitcnt lgkmcnt(0)
v_exp_f32 v172, v172
v_mfma_f32_16x16x32_bf16 v[44:47], a[132:135], v[192:195], v[44:47]
v_exp_f32 v173, v173
v_mfma_f32_16x16x32_bf16 v[44:47], a[148:151], v[176:179], v[44:47]
v_exp_f32 v174, v174
v_mfma_f32_16x16x32_bf16 v[48:51], a[152:155], v[176:179], v[48:51]
v_cvt_pk_bf16_f32 v217, v170, v171
v_cvt_pk_bf16_f32 v218, v172, v173
v_mfma_f32_16x16x32_bf16 v[48:51], a[136:139], v[192:195], v[48:51]
v_exp_f32 v175, v175
v_mfma_f32_16x16x32_bf16 v[52:55], a[140:143], v[192:195], v[52:55]
v_cvt_pk_bf16_f32 v219, v174, v175
v_mfma_f32_16x16x32_bf16 v[52:55], a[156:159], v[176:179], v[52:55]
v_mul_f32 v44, v44, v32
v_mul_f32 v45, v45, v32
v_mfma_f32_16x16x32_bf16 v[56:59], a[160:163], v[176:179], v[56:59]
v_mul_f32 v46, v46, v32
v_mul_f32 v47, v47, v32
v_mfma_f32_16x16x32_bf16 v[56:59], a[144:147], v[192:195], v[56:59]
v_cvt_pk_bf16_f32 v44, v44, v45
v_cvt_pk_bf16_f32 v45, v46, v47
v_mfma_f32_16x16x32_bf16 v[144:147], a[32:35], v[196:199], v[144:147]
v_mul_f32 v48, v48, v32
v_mul_f32 v49, v49, v32
v_mfma_f32_16x16x32_bf16 v[76:79], a[100:103], v[204:207], v[76:79]
v_mul_f32 v50, v50, v32
v_mul_f32 v51, v51, v32
v_mfma_f32_16x16x32_bf16 v[76:79], a[116:119], v[208:211], v[76:79]
v_cvt_pk_bf16_f32 v46, v48, v49
v_cvt_pk_bf16_f32 v47, v50, v51
v_mfma_f32_16x16x32_bf16 v[76:79], a[132:135], v[212:215], v[76:79]
v_mul_f32 v52, v52, v32
v_mul_f32 v53, v53, v32
v_mfma_f32_16x16x32_bf16 v[76:79], a[148:151], v[196:199], v[76:79]
v_rcp_f32 v36, v144
v_mfma_f32_16x16x32_bf16 v[80:83], a[152:155], v[196:199], v[80:83]
v_mov_b32 v37, v36
v_mul_f32 v54, v54, v32
v_mfma_f32_16x16x32_bf16 v[80:83], a[136:139], v[212:215], v[80:83]
v_mul_f32 v55, v55, v32
v_cvt_pk_bf16_f32 v52, v52, v53
v_mfma_f32_16x16x32_bf16 v[80:83], a[120:123], v[208:211], v[80:83]
v_cvt_pk_bf16_f32 v53, v54, v55
v_mul_f32 v56, v56, v32
v_mfma_f32_16x16x32_bf16 v[80:83], a[104:107], v[204:207], v[80:83]
v_mul_f32 v57, v57, v32
v_mul_f32 v58, v58, v32
v_mfma_f32_16x16x32_bf16 v[84:87], a[108:111], v[204:207], v[84:87]
v_mul_f32 v59, v59, v32
v_cvt_pk_bf16_f32 v54, v56, v57
v_mfma_f32_16x16x32_bf16 v[84:87], a[124:127], v[208:211], v[84:87]
v_cvt_pk_bf16_f32 v55, v58, v59
v_cndmask_b32_dpp v56, v44, v52, vcc quad_perm:[1,0,3,2] row_mask:0xf bank_mask:0xf
v_mfma_f32_16x16x32_bf16 v[84:87], a[140:143], v[212:215], v[84:87]
v_cndmask_b32_dpp v57, v45, v53, vcc quad_perm:[1,0,3,2] row_mask:0xf bank_mask:0xf
v_cndmask_b32_dpp v58, v46, v54, vcc quad_perm:[1,0,3,2] row_mask:0xf bank_mask:0xf
v_mfma_f32_16x16x32_bf16 v[84:87], a[156:159], v[196:199], v[84:87]
v_cndmask_b32_dpp v59, v47, v55, vcc quad_perm:[1,0,3,2] row_mask:0xf bank_mask:0xf
s_brev_b64 vcc, vcc
v_cndmask_b32_dpp v48, v52, v44, vcc quad_perm:[1,0,3,2] row_mask:0xf bank_mask:0xf
v_mfma_f32_16x16x32_bf16 v[88:91], a[160:163], v[196:199], v[88:91]
v_cndmask_b32_dpp v49, v53, v45, vcc quad_perm:[1,0,3,2] row_mask:0xf bank_mask:0xf
v_cndmask_b32_dpp v50, v54, v46, vcc quad_perm:[1,0,3,2] row_mask:0xf bank_mask:0xf
v_mfma_f32_16x16x32_bf16 v[88:91], a[144:147], v[212:215], v[88:91]
v_cndmask_b32_dpp v51, v55, v47, vcc quad_perm:[1,0,3,2] row_mask:0xf bank_mask:0xf
v_mul_f32 v76, v76, v36
v_mfma_f32_16x16x32_bf16 v[88:91], a[128:131], v[208:211], v[88:91]
v_mul_f32 v77, v77, v36
v_mul_f32 v78, v78, v36
v_mfma_f32_16x16x32_bf16 v[88:91], a[112:115], v[204:207], v[88:91]
v_mul_f32 v79, v79, v36
v_cvt_pk_bf16_f32 v76, v76, v77
v_mfma_f32_16x16x32_bf16 v[148:151], a[32:35], v[216:219], v[148:151]
v_cvt_pk_bf16_f32 v77, v78, v79
v_mul_f32 v80, v80, v36
v_mfma_f32_16x16x32_bf16 v[108:111], a[100:103], v[224:227], v[108:111]
s_waitcnt vmcnt(0)
s_barrier
v_mfma_f32_16x16x32_bf16 v[108:111], a[116:119], v[228:231], v[108:111]
ds_read_b64_tr_b16 a[164:165], v12 offset:16896
ds_read_b64_tr_b16 a[166:167], v12 offset:17152
ds_read_b64_tr_b16 a[168:169], v12 offset:16904
v_mul_f32 v81, v81, v36
v_mfma_f32_16x16x32_bf16 v[108:111], a[132:135], v[232:235], v[108:111]
ds_read_b64_tr_b16 a[170:171], v12 offset:17160
v_mul_f32 v82, v82, v36
v_mul_f32 v83, v83, v36
v_mfma_f32_16x16x32_bf16 v[108:111], a[148:151], v[216:219], v[108:111]
ds_read_b64_tr_b16 a[172:173], v12 offset:16912
v_rcp_f32 v40, v148
v_mfma_f32_16x16x32_bf16 v[112:115], a[152:155], v[216:219], v[112:115]
ds_read_b64_tr_b16 a[174:175], v12 offset:17168
ds_read_b64_tr_b16 a[176:177], v12 offset:16920
v_mov_b32 v41, v40
v_mfma_f32_16x16x32_bf16 v[112:115], a[136:139], v[232:235], v[112:115]
ds_read_b64_tr_b16 a[178:179], v12 offset:17176
buffer_store_dwordx4 v[56:59], v5, s[16:19], s93 offen offset:256 nt
v_mfma_f32_16x16x32_bf16 v[112:115], a[120:123], v[228:231], v[112:115]
ds_read_b64_tr_b16 a[180:181], v12 offset:17408
ds_read_b64_tr_b16 a[182:183], v12 offset:17664
v_cvt_pk_bf16_f32 v78, v80, v81
v_mfma_f32_16x16x32_bf16 v[112:115], a[104:107], v[224:227], v[112:115]
ds_read_b64_tr_b16 a[184:185], v12 offset:17416
v_cvt_pk_bf16_f32 v79, v82, v83
v_mul_f32 v84, v84, v36
v_mfma_f32_16x16x32_bf16 v[116:119], a[108:111], v[224:227], v[116:119]
ds_read_b64_tr_b16 a[186:187], v12 offset:17672
ds_read_b64_tr_b16 a[188:189], v12 offset:17424
v_mul_f32 v85, v85, v36
v_mfma_f32_16x16x32_bf16 v[116:119], a[124:127], v[228:231], v[116:119]
ds_read_b64_tr_b16 a[190:191], v12 offset:17680
v_mul_f32 v86, v86, v36
v_mul_f32 v87, v87, v36
v_mfma_f32_16x16x32_bf16 v[116:119], a[140:143], v[232:235], v[116:119]
ds_read_b64_tr_b16 a[192:193], v12 offset:17432
buffer_store_dwordx4 v[48:51], v5, s[16:19], s93 offen offset:0 nt
v_cvt_pk_bf16_f32 v84, v84, v85
v_mfma_f32_16x16x32_bf16 v[116:119], a[156:159], v[216:219], v[116:119]
ds_read_b64_tr_b16 a[194:195], v12 offset:17688
ds_read_b64_tr_b16 a[196:197], v12 offset:25344
v_cvt_pk_bf16_f32 v85, v86, v87
v_mfma_f32_16x16x32_bf16 v[120:123], a[160:163], v[216:219], v[120:123]
ds_read_b64_tr_b16 a[198:199], v12 offset:25600
v_mul_f32 v88, v88, v36
v_mul_f32 v89, v89, v36
v_mfma_f32_16x16x32_bf16 v[120:123], a[144:147], v[232:235], v[120:123]
ds_read_b64_tr_b16 a[200:201], v12 offset:25352
ds_read_b64_tr_b16 a[202:203], v12 offset:25608
v_mul_f32 v90, v90, v36
v_mfma_f32_16x16x32_bf16 v[120:123], a[128:131], v[228:231], v[120:123]
s_waitcnt lgkmcnt(12)
ds_read_b64_tr_b16 a[204:205], v12 offset:25360
v_mul_f32 v91, v91, v36
v_cvt_pk_bf16_f32 v86, v88, v89
v_mfma_f32_16x16x32_bf16 v[120:123], a[112:115], v[224:227], v[120:123]
ds_read_b64_tr_b16 a[206:207], v12 offset:25616
ds_read_b64_tr_b16 a[208:209], v12 offset:25368
v_cvt_pk_bf16_f32 v87, v90, v91
v_mfma_f32_16x16x32_bf16 v[60:63], a[164:167], v[184:187], v[60:63]
ds_read_b64_tr_b16 a[210:211], v12 offset:25624
ds_read_b64_tr_b16 a[212:213], v12 offset:25856
ds_read_b64_tr_b16 a[214:215], v12 offset:26112
v_mfma_f32_16x16x32_bf16 v[64:67], a[168:171], v[184:187], v[64:67]
ds_read_b64_tr_b16 a[216:217], v12 offset:25864
ds_read_b64_tr_b16 a[218:219], v12 offset:26120
v_cndmask_b32_dpp v80, v84, v76, vcc quad_perm:[1,0,3,2] row_mask:0xf bank_mask:0xf
v_mfma_f32_16x16x32_bf16 v[68:71], a[172:175], v[184:187], v[68:71]
s_waitcnt lgkmcnt(12)
ds_read_b64_tr_b16 a[220:221], v12 offset:25872
ds_read_b64_tr_b16 a[222:223], v12 offset:26128
v_cndmask_b32_dpp v81, v85, v77, vcc quad_perm:[1,0,3,2] row_mask:0xf bank_mask:0xf
v_mfma_f32_16x16x32_bf16 v[72:75], a[176:179], v[184:187], v[72:75]
ds_read_b64_tr_b16 a[224:225], v12 offset:25880
ds_read_b64_tr_b16 a[226:227], v12 offset:26136
v_cndmask_b32_dpp v82, v86, v78, vcc quad_perm:[1,0,3,2] row_mask:0xf bank_mask:0xf
v_mfma_f32_16x16x32_bf16 v[60:63], a[180:183], v[188:191], v[60:63]
v_cndmask_b32_dpp v83, v87, v79, vcc quad_perm:[1,0,3,2] row_mask:0xf bank_mask:0xf
s_brev_b64 vcc, vcc
v_cndmask_b32_dpp v88, v76, v84, vcc quad_perm:[1,0,3,2] row_mask:0xf bank_mask:0xf
v_cndmask_b32_dpp v89, v77, v85, vcc quad_perm:[1,0,3,2] row_mask:0xf bank_mask:0xf
v_mfma_f32_16x16x32_bf16 v[64:67], a[184:187], v[188:191], v[64:67]
buffer_store_dwordx4 v[80:83], v5, s[16:19], s99 offen offset:0 nt
v_cndmask_b32_dpp v90, v78, v86, vcc quad_perm:[1,0,3,2] row_mask:0xf bank_mask:0xf
v_cndmask_b32_dpp v91, v79, v87, vcc quad_perm:[1,0,3,2] row_mask:0xf bank_mask:0xf
v_mfma_f32_16x16x32_bf16 v[68:71], a[188:191], v[188:191], v[68:71]
s_waitcnt lgkmcnt(8)
v_mul_f32 v108, v108, v40
v_mul_f32 v109, v109, v40
v_mul_f32 v110, v110, v40
v_mfma_f32_16x16x32_bf16 v[72:75], a[192:195], v[188:191], v[72:75]
s_waitcnt lgkmcnt(0)
v_mul_f32 v111, v111, v40
v_cvt_pk_bf16_f32 v108, v108, v109
v_cvt_pk_bf16_f32 v109, v110, v111
v_mfma_f32_16x16x32_bf16 v[60:63], a[196:199], v[192:195], v[60:63]
v_mul_f32 v112, v112, v40
v_mul_f32 v113, v113, v40
v_mul_f32 v114, v114, v40
v_mfma_f32_16x16x32_bf16 v[60:63], a[212:215], v[176:179], v[60:63]
v_mul_f32 v115, v115, v40
v_cvt_pk_bf16_f32 v110, v112, v113
v_cvt_pk_bf16_f32 v111, v114, v115
v_mfma_f32_16x16x32_bf16 v[64:67], a[216:219], v[176:179], v[64:67]
buffer_store_dwordx4 v[88:91], v5, s[16:19], s99 offen offset:256 nt
v_mul_f32 v116, v116, v40
v_mfma_f32_16x16x32_bf16 v[64:67], a[200:203], v[192:195], v[64:67]
v_mul_f32 v117, v117, v40
v_mul_f32 v118, v118, v40
v_mul_f32 v119, v119, v40
v_mfma_f32_16x16x32_bf16 v[68:71], a[204:207], v[192:195], v[68:71]
v_cvt_pk_bf16_f32 v116, v116, v117
v_cvt_pk_bf16_f32 v117, v118, v119
v_mul_f32 v120, v120, v40
v_mfma_f32_16x16x32_bf16 v[68:71], a[220:223], v[176:179], v[68:71]
v_mul_f32 v121, v121, v40
v_mul_f32 v122, v122, v40
v_mul_f32 v123, v123, v40
v_mfma_f32_16x16x32_bf16 v[72:75], a[224:227], v[176:179], v[72:75]
v_cvt_pk_bf16_f32 v118, v120, v121
v_cvt_pk_bf16_f32 v119, v122, v123
v_cndmask_b32_dpp v120, v108, v116, vcc quad_perm:[1,0,3,2] row_mask:0xf bank_mask:0xf
v_mfma_f32_16x16x32_bf16 v[72:75], a[208:211], v[192:195], v[72:75]
v_cndmask_b32_dpp v121, v109, v117, vcc quad_perm:[1,0,3,2] row_mask:0xf bank_mask:0xf
v_cndmask_b32_dpp v122, v110, v118, vcc quad_perm:[1,0,3,2] row_mask:0xf bank_mask:0xf
v_cndmask_b32_dpp v123, v111, v119, vcc quad_perm:[1,0,3,2] row_mask:0xf bank_mask:0xf
s_brev_b64 vcc, vcc
v_cndmask_b32_dpp v112, v116, v108, vcc quad_perm:[1,0,3,2] row_mask:0xf bank_mask:0xf
v_mfma_f32_16x16x32_bf16 v[92:95], a[164:167], v[204:207], v[92:95]
buffer_store_dwordx4 v[120:123], v5, s[16:19], s100 offen offset:256 nt
v_cndmask_b32_dpp v113, v117, v109, vcc quad_perm:[1,0,3,2] row_mask:0xf bank_mask:0xf
v_mfma_f32_16x16x32_bf16 v[92:95], a[180:183], v[208:211], v[92:95]
v_cndmask_b32_dpp v114, v118, v110, vcc quad_perm:[1,0,3,2] row_mask:0xf bank_mask:0xf
v_cndmask_b32_dpp v115, v119, v111, vcc quad_perm:[1,0,3,2] row_mask:0xf bank_mask:0xf
v_mul_f32 v60, v60, v32
v_mfma_f32_16x16x32_bf16 v[92:95], a[196:199], v[212:215], v[92:95]
v_mul_f32 v61, v61, v32
v_mul_f32 v62, v62, v32
v_mul_f32 v63, v63, v32
v_mfma_f32_16x16x32_bf16 v[92:95], a[212:215], v[196:199], v[92:95]
v_cvt_pk_bf16_f32 v60, v60, v61
v_cvt_pk_bf16_f32 v61, v62, v63
v_mul_f32 v64, v64, v32
v_mfma_f32_16x16x32_bf16 v[96:99], a[216:219], v[196:199], v[96:99]
v_mul_f32 v65, v65, v32
v_mul_f32 v66, v66, v32
v_mul_f32 v67, v67, v32
v_mfma_f32_16x16x32_bf16 v[96:99], a[200:203], v[212:215], v[96:99]
buffer_store_dwordx4 v[112:115], v5, s[16:19], s100 offen offset:0 nt
v_cvt_pk_bf16_f32 v62, v64, v65
v_mfma_f32_16x16x32_bf16 v[96:99], a[184:187], v[208:211], v[96:99]
v_cvt_pk_bf16_f32 v63, v66, v67
v_mul_f32 v68, v68, v32
v_mul_f32 v69, v69, v32
v_mfma_f32_16x16x32_bf16 v[96:99], a[168:171], v[204:207], v[96:99]
v_mul_f32 v70, v70, v32
v_mul_f32 v71, v71, v32
v_cvt_pk_bf16_f32 v68, v68, v69
v_mfma_f32_16x16x32_bf16 v[100:103], a[172:175], v[204:207], v[100:103]
v_cvt_pk_bf16_f32 v69, v70, v71
v_mul_f32 v72, v72, v32
v_mul_f32 v73, v73, v32
v_mfma_f32_16x16x32_bf16 v[100:103], a[188:191], v[208:211], v[100:103]
v_mul_f32 v74, v74, v32
v_mul_f32 v75, v75, v32
v_cvt_pk_bf16_f32 v70, v72, v73
v_mfma_f32_16x16x32_bf16 v[100:103], a[204:207], v[212:215], v[100:103]
v_cvt_pk_bf16_f32 v71, v74, v75
v_cndmask_b32_dpp v64, v68, v60, vcc quad_perm:[1,0,3,2] row_mask:0xf bank_mask:0xf
v_cndmask_b32_dpp v65, v69, v61, vcc quad_perm:[1,0,3,2] row_mask:0xf bank_mask:0xf
v_cndmask_b32_dpp v66, v70, v62, vcc quad_perm:[1,0,3,2] row_mask:0xf bank_mask:0xf
v_mfma_f32_16x16x32_bf16 v[100:103], a[220:223], v[196:199], v[100:103]
v_cndmask_b32_dpp v67, v71, v63, vcc quad_perm:[1,0,3,2] row_mask:0xf bank_mask:0xf
s_brev_b64 vcc, vcc
v_cndmask_b32_dpp v72, v60, v68, vcc quad_perm:[1,0,3,2] row_mask:0xf bank_mask:0xf
v_cndmask_b32_dpp v73, v61, v69, vcc quad_perm:[1,0,3,2] row_mask:0xf bank_mask:0xf
v_mfma_f32_16x16x32_bf16 v[104:107], a[224:227], v[196:199], v[104:107]
buffer_store_dwordx4 v[64:67], v5, s[16:19], s93 offen offset:128 nt
v_cndmask_b32_dpp v74, v62, v70, vcc quad_perm:[1,0,3,2] row_mask:0xf bank_mask:0xf
v_mfma_f32_16x16x32_bf16 v[104:107], a[208:211], v[212:215], v[104:107]
v_cndmask_b32_dpp v75, v63, v71, vcc quad_perm:[1,0,3,2] row_mask:0xf bank_mask:0xf
v_mul_f32 v92, v92, v36
v_mul_f32 v93, v93, v36
v_mfma_f32_16x16x32_bf16 v[104:107], a[192:195], v[208:211], v[104:107]
v_mul_f32 v94, v94, v36
v_mul_f32 v95, v95, v36
v_cvt_pk_bf16_f32 v92, v92, v93
v_mfma_f32_16x16x32_bf16 v[104:107], a[176:179], v[204:207], v[104:107]
v_cvt_pk_bf16_f32 v93, v94, v95
v_mul_f32 v96, v96, v36
v_mul_f32 v97, v97, v36
v_mfma_f32_16x16x32_bf16 v[124:127], a[164:167], v[224:227], v[124:127]
v_mul_f32 v98, v98, v36
v_mul_f32 v99, v99, v36
v_cvt_pk_bf16_f32 v94, v96, v97
v_mfma_f32_16x16x32_bf16 v[124:127], a[180:183], v[228:231], v[124:127]
buffer_store_dwordx4 v[72:75], v5, s[16:19], s93 offen offset:384 nt
v_cvt_pk_bf16_f32 v95, v98, v99
v_mfma_f32_16x16x32_bf16 v[124:127], a[196:199], v[232:235], v[124:127]
v_mul_f32 v100, v100, v36
v_mul_f32 v101, v101, v36
v_mul_f32 v102, v102, v36
v_mfma_f32_16x16x32_bf16 v[124:127], a[212:215], v[216:219], v[124:127]
v_mul_f32 v103, v103, v36
v_cvt_pk_bf16_f32 v100, v100, v101
v_cvt_pk_bf16_f32 v101, v102, v103
v_mfma_f32_16x16x32_bf16 v[128:131], a[216:219], v[216:219], v[128:131]
v_mul_f32 v104, v104, v36
v_mul_f32 v105, v105, v36
v_mul_f32 v106, v106, v36
v_mfma_f32_16x16x32_bf16 v[128:131], a[200:203], v[232:235], v[128:131]
v_mul_f32 v107, v107, v36
v_cvt_pk_bf16_f32 v102, v104, v105
v_cvt_pk_bf16_f32 v103, v106, v107
v_cndmask_b32_dpp v104, v92, v100, vcc quad_perm:[1,0,3,2] row_mask:0xf bank_mask:0xf
v_mfma_f32_16x16x32_bf16 v[128:131], a[184:187], v[228:231], v[128:131]
v_cndmask_b32_dpp v105, v93, v101, vcc quad_perm:[1,0,3,2] row_mask:0xf bank_mask:0xf
v_cndmask_b32_dpp v106, v94, v102, vcc quad_perm:[1,0,3,2] row_mask:0xf bank_mask:0xf
v_cndmask_b32_dpp v107, v95, v103, vcc quad_perm:[1,0,3,2] row_mask:0xf bank_mask:0xf
s_brev_b64 vcc, vcc
v_mfma_f32_16x16x32_bf16 v[128:131], a[168:171], v[224:227], v[128:131]
buffer_store_dwordx4 v[104:107], v5, s[16:19], s99 offen offset:384 nt
v_cndmask_b32_dpp v96, v100, v92, vcc quad_perm:[1,0,3,2] row_mask:0xf bank_mask:0xf
v_mfma_f32_16x16x32_bf16 v[132:135], a[172:175], v[224:227], v[132:135]
v_cndmask_b32_dpp v97, v101, v93, vcc quad_perm:[1,0,3,2] row_mask:0xf bank_mask:0xf
v_cndmask_b32_dpp v98, v102, v94, vcc quad_perm:[1,0,3,2] row_mask:0xf bank_mask:0xf
v_cndmask_b32_dpp v99, v103, v95, vcc quad_perm:[1,0,3,2] row_mask:0xf bank_mask:0xf
v_mfma_f32_16x16x32_bf16 v[132:135], a[188:191], v[228:231], v[132:135]
v_mul_f32 v124, v124, v40
v_mul_f32 v125, v125, v40
v_mul_f32 v126, v126, v40
v_mfma_f32_16x16x32_bf16 v[132:135], a[204:207], v[232:235], v[132:135]
v_mul_f32 v127, v127, v40
v_cvt_pk_bf16_f32 v124, v124, v125
v_cvt_pk_bf16_f32 v125, v126, v127
v_mfma_f32_16x16x32_bf16 v[132:135], a[220:223], v[216:219], v[132:135]
v_mul_f32 v128, v128, v40
v_mul_f32 v129, v129, v40
v_mul_f32 v130, v130, v40
v_mfma_f32_16x16x32_bf16 v[136:139], a[224:227], v[216:219], v[136:139]
buffer_store_dwordx4 v[96:99], v5, s[16:19], s99 offen offset:128 nt
v_mul_f32 v131, v131, v40
v_mfma_f32_16x16x32_bf16 v[136:139], a[208:211], v[232:235], v[136:139]
v_cvt_pk_bf16_f32 v126, v128, v129
v_cvt_pk_bf16_f32 v127, v130, v131
v_mfma_f32_16x16x32_bf16 v[136:139], a[192:195], v[228:231], v[136:139]
v_mfma_f32_16x16x32_bf16 v[136:139], a[176:179], v[224:227], v[136:139]
v_mul_f32 v132, v132, v40
v_mul_f32 v133, v133, v40
v_mul_f32 v134, v134, v40
v_mul_f32 v135, v135, v40
v_cvt_pk_bf16_f32 v132, v132, v133
v_cvt_pk_bf16_f32 v133, v134, v135
s_nop 1
v_pk_mul_f32 v[136:137], v[136:137], v[40:41]
v_pk_mul_f32 v[138:139], v[138:139], v[40:41]
v_cvt_pk_bf16_f32 v134, v136, v137
v_cvt_pk_bf16_f32 v135, v138, v139
v_cndmask_b32_dpp v128, v132, v124, vcc quad_perm:[1,0,3,2] row_mask:0xf bank_mask:0xf
v_cndmask_b32_dpp v129, v133, v125, vcc quad_perm:[1,0,3,2] row_mask:0xf bank_mask:0xf
v_cndmask_b32_dpp v130, v134, v126, vcc quad_perm:[1,0,3,2] row_mask:0xf bank_mask:0xf
v_cndmask_b32_dpp v131, v135, v127, vcc quad_perm:[1,0,3,2] row_mask:0xf bank_mask:0xf
buffer_store_dwordx4 v[128:131], v5, s[16:19], s100 offen offset:128 nt
s_brev_b64 vcc, vcc
v_cndmask_b32_dpp v136, v124, v132, vcc quad_perm:[1,0,3,2] row_mask:0xf bank_mask:0xf
v_cndmask_b32_dpp v137, v125, v133, vcc quad_perm:[1,0,3,2] row_mask:0xf bank_mask:0xf
v_cndmask_b32_dpp v138, v126, v134, vcc quad_perm:[1,0,3,2] row_mask:0xf bank_mask:0xf
v_cndmask_b32_dpp v139, v127, v135, vcc quad_perm:[1,0,3,2] row_mask:0xf bank_mask:0xf
buffer_store_dwordx4 v[136:139], v5, s[16:19], s100 offen offset:384 nt
v_add_f32 v21, v140, v144
v_add_f32 v21, v21, v148
v_cmp_nge_f32 vcc, s22, v21
s_cbranch_vccnz L_setflag
L_setflag_ret:
s_barrier
ds_read_b32 v25, v15 offset:0
s_waitcnt lgkmcnt(0)
v_readfirstlane_b32 s25, v25
s_nop 0
s_cmp_gt_u32 s25, s27
s_cbranch_scc1 L_fallback
L_end:
s_endpgm
L_setflag:
v_mov_b32 v20, 1
s_nop 0
ds_write_b32 v15, v20 offset:0
s_waitcnt lgkmcnt(0)
s_branch L_setflag_ret
.p2align 12
L_touch0_o1:
s_branch L_touch_ret
L_odd1:
s_cmp_lg_u32 s20, s20
v_pk_mul_f32 v[20:21], v[20:21], s[30:31]
v_cvt_pk_bf16_f32 v242, v20, v21
s_xor_b32 s24, s98, 6144
s_add_u32 m0, s23, 25344
s_nop 0
buffer_load_dwordx4 v2, s[8:11], s24 offen offset:0 nt lds
v_lshlrev_b32 v22, 16, v243
v_and_b32 v23, 0xffff0000, v243
v_pk_mul_f32 v[22:23], v[22:23], s[30:31]
v_cvt_pk_bf16_f32 v243, v22, v23
s_waitcnt lgkmcnt(1)
v_lshlrev_b32 v20, 16, v244
v_and_b32 v21, 0xffff0000, v244
v_pk_mul_f32 v[20:21], v[20:21], s[30:31]
v_cvt_pk_bf16_f32 v244, v20, v21
v_lshlrev_b32 v22, 16, v245
v_and_b32 v23, 0xffff0000, v245
v_pk_mul_f32 v[22:23], v[22:23], s[30:31]
v_cvt_pk_bf16_f32 v245, v22, v23
v_lshlrev_b32 v20, 16, v246
v_and_b32 v21, 0xffff0000, v246
v_pk_mul_f32 v[20:21], v[20:21], s[30:31]
v_cvt_pk_bf16_f32 v246, v20, v21
s_add_u32 m0, m0, 32
s_nop 0
buffer_load_dwordx4 v2, s[8:11], s24 offen offset:1024 nt lds
v_lshlrev_b32 v22, 16, v247
v_and_b32 v23, 0xffff0000, v247
v_pk_mul_f32 v[22:23], v[22:23], s[30:31]
v_cvt_pk_bf16_f32 v247, v22, v23
s_waitcnt lgkmcnt(0)
v_lshlrev_b32 v20, 16, v248
v_and_b32 v21, 0xffff0000, v248
v_pk_mul_f32 v[20:21], v[20:21], s[30:31]
v_cvt_pk_bf16_f32 v248, v20, v21
v_lshlrev_b32 v22, 16, v249
v_and_b32 v23, 0xffff0000, v249
v_pk_mul_f32 v[22:23], v[22:23], s[30:31]
v_cvt_pk_bf16_f32 v249, v22, v23
v_lshlrev_b32 v20, 16, v250
v_and_b32 v21, 0xffff0000, v250
v_pk_mul_f32 v[20:21], v[20:21], s[30:31]
v_cvt_pk_bf16_f32 v250, v20, v21
v_lshlrev_b32 v22, 16, v251
v_and_b32 v23, 0xffff0000, v251
v_pk_mul_f32 v[22:23], v[22:23], s[30:31]
v_cvt_pk_bf16_f32 v251, v22, v23
s_waitcnt vmcnt(4)
s_barrier
ds_read_b128 a[68:71], v6 offset:8448
ds_read_b128 a[72:75], v6 offset:8512
v_mfma_f32_16x16x32_bf16 v[168:171], a[36:39], v[236:239], 0
ds_read_b128 a[76:79], v6 offset:8576
v_mfma_f32_16x16x32_bf16 v[168:171], a[40:43], v[240:243], v[168:171]
ds_read_b128 a[80:83], v6 offset:8640
v_mfma_f32_16x16x32_bf16 v[168:171], a[44:47], v[244:247], v[168:171]
ds_read_b128 a[96:99], v6 offset:9152
v_mfma_f32_16x16x32_bf16 v[168:171], a[48:51], v[248:251], v[168:171]
ds_read_b128 a[92:95], v6 offset:9088
v_mfma_f32_16x16x32_bf16 v[172:175], a[64:67], v[248:251], 0
ds_read_b128 a[88:91], v6 offset:9024
v_mfma_f32_16x16x32_bf16 v[172:175], a[60:63], v[244:247], v[172:175]
ds_read_b128 a[84:87], v6 offset:8960
v_mfma_f32_16x16x32_bf16 v[172:175], a[56:59], v[240:243], v[172:175]
v_mfma_f32_16x16x32_bf16 v[172:175], a[52:55], v[236:239], v[172:175]
v_max3_f32 v24, v168, v169, v170
s_nop 6
v_max3_f32 v25, v171, v172, v173
v_max3_f32 v24, v24, v174, v175
v_max3_f32 v24, v24, v25, v28
v_mov_b32 v25, v24
s_nop 1
v_permlane32_swap_b32 v24, v25
v_max_f32 v24, v24, v25
v_mov_b32 v25, v24
s_nop 1
v_permlane16_swap_b32 v24, v25
v_max_f32 v24, v24, v25
v_sub_f32 v168, v168, v24
v_sub_f32 v169, v169, v24
v_sub_f32 v170, v170, v24
v_sub_f32 v171, v171, v24
v_sub_f32 v172, v172, v24
v_sub_f32 v173, v173, v24
v_sub_f32 v174, v174, v24
v_sub_f32 v175, v175, v24
v_sub_f32 v40, 0, v24
v_sub_f32 v41, 0, v24
v_sub_f32 v42, 0, v24
v_sub_f32 v43, 0, v24
s_waitcnt lgkmcnt(0)
v_mfma_f32_16x16x32_bf16 v[152:155], a[68:71], a[0:3], v[32:35]
s_xor_b32 s24, s98, 8192
v_exp_f32 v168, v168
v_mfma_f32_16x16x32_bf16 v[152:155], a[72:75], a[4:7], v[152:155]
s_add_u32 m0, s23, 33792
v_exp_f32 v169, v169
v_mfma_f32_16x16x32_bf16 v[152:155], a[76:79], a[8:11], v[152:155]
v_exp_f32 v170, v170
v_exp_f32 v171, v171
v_mfma_f32_16x16x32_bf16 v[152:155], a[80:83], a[12:15], v[152:155]
v_exp_f32 v172, v172
v_cvt_pk_bf16_f32 v216, v168, v169
v_mfma_f32_16x16x32_bf16 v[156:159], a[96:99], a[12:15], v[32:35]
v_exp_f32 v173, v173
v_mfma_f32_16x16x32_bf16 v[156:159], a[92:95], a[8:11], v[156:159]
v_exp_f32 v174, v174
v_cvt_pk_bf16_f32 v217, v170, v171
v_mfma_f32_16x16x32_bf16 v[156:159], a[88:91], a[4:7], v[156:159]
v_exp_f32 v175, v175
v_cvt_pk_bf16_f32 v218, v172, v173
v_mfma_f32_16x16x32_bf16 v[156:159], a[84:87], a[0:3], v[156:159]
v_cvt_pk_bf16_f32 v219, v174, v175
v_mfma_f32_16x16x32_bf16 v[164:167], a[84:87], a[16:19], v[36:39]
v_mfma_f32_16x16x32_bf16 v[164:167], a[88:91], a[20:23], v[164:167]
buffer_load_dwordx4 v2, s[8:11], s24 offen offset:0 nt lds
v_mfma_f32_16x16x32_bf16 v[164:167], a[92:95], a[24:27], v[164:167]
s_add_u32 m0, m0, 32
v_exp_f32 v152, v152
v_exp_f32 v153, v153
v_mfma_f32_16x16x32_bf16 v[164:167], a[96:99], a[28:31], v[164:167]
buffer_load_dwordx4 v2, s[8:11], s24 offen offset:1024 nt lds
v_exp_f32 v154, v154
v_mfma_f32_16x16x32_bf16 v[160:163], a[80:83], a[28:31], v[36:39]
s_xor_b32 s24, s98, 10240
v_exp_f32 v155, v155
v_cvt_pk_bf16_f32 v180, v152, v153
v_mfma_f32_16x16x32_bf16 v[160:163], a[76:79], a[24:27], v[160:163]
s_add_u32 m0, s23, 42240
v_exp_f32 v156, v156
v_cvt_pk_bf16_f32 v181, v154, v155
v_mfma_f32_16x16x32_bf16 v[160:163], a[72:75], a[20:23], v[160:163]
v_exp_f32 v157, v157
v_mfma_f32_16x16x32_bf16 v[160:163], a[68:71], a[16:19], v[160:163]
v_exp_f32 v158, v158
v_cvt_pk_bf16_f32 v182, v156, v157
v_mfma_f32_16x16x32_bf16 v[168:171], a[68:71], v[236:239], v[40:43]
v_exp_f32 v159, v159
v_mfma_f32_16x16x32_bf16 v[168:171], a[72:75], v[240:243], v[168:171]
v_cvt_pk_bf16_f32 v183, v158, v159
v_mfma_f32_16x16x32_bf16 v[168:171], a[76:79], v[244:247], v[168:171]
buffer_load_dwordx4 v2, s[8:11], s24 offen offset:0 nt lds
v_exp_f32 v164, v164
v_mfma_f32_16x16x32_bf16 v[168:171], a[80:83], v[248:251], v[168:171]
s_add_u32 m0, m0, 32
v_exp_f32 v165, v165
v_exp_f32 v166, v166
v_mfma_f32_16x16x32_bf16 v[172:175], a[96:99], v[248:251], v[40:43]
v_exp_f32 v167, v167
v_mfma_f32_16x16x32_bf16 v[172:175], a[92:95], v[244:247], v[172:175]
v_exp_f32 v160, v160
v_cvt_pk_bf16_f32 v202, v164, v165
v_mfma_f32_16x16x32_bf16 v[172:175], a[88:91], v[240:243], v[172:175]
s_waitcnt vmcnt(5)
s_barrier
v_mfma_f32_16x16x32_bf16 v[172:175], a[84:87], v[236:239], v[172:175]
ds_read_b128 a[36:39], v6 offset:16896
ds_read_b128 a[40:43], v6 offset:16960
ds_read_b128 a[44:47], v6 offset:17024
ds_read_b128 a[48:51], v6 offset:17088
ds_read_b128 a[64:67], v6 offset:17600
ds_read_b128 a[60:63], v6 offset:17536
ds_read_b128 a[56:59], v6 offset:17472
ds_read_b128 a[52:55], v6 offset:17408
buffer_load_dwordx4 v2, s[8:11], s24 offen offset:1024 nt lds
v_cvt_pk_bf16_f32 v203, v166, v167
v_mfma_f32_16x16x32_bf16 v[148:151], a[32:35], v[216:219], 0
s_waitcnt lgkmcnt(7)
v_exp_f32 v161, v161
v_exp_f32 v162, v162
v_exp_f32 v163, v163
v_mfma_f32_16x16x32_bf16 v[152:155], a[36:39], a[0:3], v[32:35]
s_waitcnt lgkmcnt(6)
v_cvt_pk_bf16_f32 v200, v160, v161
v_cvt_pk_bf16_f32 v201, v162, v163
v_mfma_f32_16x16x32_bf16 v[152:155], a[40:43], a[4:7], v[152:155]
s_waitcnt lgkmcnt(5)
v_exp_f32 v168, v168
v_exp_f32 v169, v169
v_exp_f32 v170, v170
v_exp_f32 v171, v171
v_exp_f32 v172, v172
v_mfma_f32_16x16x32_bf16 v[152:155], a[44:47], a[8:11], v[152:155]
s_waitcnt lgkmcnt(4)
s_xor_b32 s24, s98, 0
s_add_u32 m0, s29, 50688
v_exp_f32 v173, v173
v_exp_f32 v174, v174
v_cvt_pk_bf16_f32 v220, v168, v169
v_mfma_f32_16x16x32_bf16 v[152:155], a[48:51], a[12:15], v[152:155]
s_waitcnt lgkmcnt(3)
buffer_load_dwordx4 v2, s[12:15], s24 offen offset:0 nt lds
v_exp_f32 v175, v175
v_cvt_pk_bf16_f32 v221, v170, v171
v_cvt_pk_bf16_f32 v222, v172, v173
v_mfma_f32_16x16x32_bf16 v[156:159], a[64:67], a[12:15], v[32:35]
s_waitcnt lgkmcnt(2)
s_add_u32 m0, m0, 8
v_cvt_pk_bf16_f32 v223, v174, v175
v_mfma_f32_16x16x32_bf16 v[156:159], a[60:63], a[8:11], v[156:159]
s_waitcnt lgkmcnt(1)
buffer_load_dwordx4 v2, s[12:15], s24 offen offset:1024 nt lds
v_mfma_f32_16x16x32_bf16 v[156:159], a[56:59], a[4:7], v[156:159]
s_waitcnt lgkmcnt(0)
v_mfma_f32_16x16x32_bf16 v[156:159], a[52:55], a[0:3], v[156:159]
s_xor_b32 s24, s98, 12288
v_mfma_f32_16x16x32_bf16 v[164:167], a[52:55], a[16:19], v[36:39]
s_add_u32 m0, s23, 59136
v_mfma_f32_16x16x32_bf16 v[164:167], a[56:59], a[20:23], v[164:167]
v_mfma_f32_16x16x32_bf16 v[164:167], a[60:63], a[24:27], v[164:167]
v_exp_f32 v152, v152
v_exp_f32 v153, v153
v_exp_f32 v154, v154
v_exp_f32 v155, v155
v_exp_f32 v156, v156
v_exp_f32 v157, v157
v_exp_f32 v158, v158
v_exp_f32 v159, v159
v_mfma_f32_16x16x32_bf16 v[164:167], a[64:67], a[28:31], v[164:167]
v_cvt_pk_bf16_f32 v184, v152, v153
v_cvt_pk_bf16_f32 v185, v154, v155
v_cvt_pk_bf16_f32 v186, v156, v157
v_cvt_pk_bf16_f32 v187, v158, v159
v_mfma_f32_16x16x32_bf16 v[160:163], a[48:51], a[28:31], v[36:39]
v_mfma_f32_16x16x32_bf16 v[160:163], a[44:47], a[24:27], v[160:163]
v_mfma_f32_16x16x32_bf16 v[160:163], a[40:43], a[20:23], v[160:163]
v_mfma_f32_16x16x32_bf16 v[160:163], a[36:39], a[16:19], v[160:163]
v_mfma_f32_16x16x32_bf16 v[168:171], a[36:39], v[236:239], v[40:43]
v_mfma_f32_16x16x32_bf16 v[168:171], a[40:43], v[240:243], v[168:171]
v_mfma_f32_16x16x32_bf16 v[168:171], a[44:47], v[244:247], v[168:171]
v_exp_f32 v164, v164
v_exp_f32 v165, v165
v_exp_f32 v166, v166
v_exp_f32 v167, v167
v_exp_f32 v160, v160
v_exp_f32 v161, v161
v_exp_f32 v162, v162
v_exp_f32 v163, v163
v_mfma_f32_16x16x32_bf16 v[168:171], a[48:51], v[248:251], v[168:171]
v_cvt_pk_bf16_f32 v206, v164, v165
v_cvt_pk_bf16_f32 v207, v166, v167
v_cvt_pk_bf16_f32 v204, v160, v161
v_cvt_pk_bf16_f32 v205, v162, v163
v_mfma_f32_16x16x32_bf16 v[172:175], a[64:67], v[248:251], v[40:43]
v_mfma_f32_16x16x32_bf16 v[172:175], a[60:63], v[244:247], v[172:175]
v_mfma_f32_16x16x32_bf16 v[172:175], a[56:59], v[240:243], v[172:175]
v_mfma_f32_16x16x32_bf16 v[172:175], a[52:55], v[236:239], v[172:175]
v_mfma_f32_16x16x32_bf16 v[140:143], a[32:35], v[180:183], v[140:143]
s_waitcnt vmcnt(6)
s_barrier
v_mfma_f32_16x16x32_bf16 v[144:147], a[32:35], v[200:203], v[144:147]
ds_read_b128 a[68:71], v6 offset:25344
ds_read_b128 a[72:75], v6 offset:25408
ds_read_b128 a[76:79], v6 offset:25472
ds_read_b128 a[80:83], v6 offset:25536
ds_read_b128 a[96:99], v6 offset:26048
ds_read_b128 a[92:95], v6 offset:25984
ds_read_b128 a[88:91], v6 offset:25920
ds_read_b128 a[84:87], v6 offset:25856
v_mfma_f32_16x16x32_bf16 v[148:151], a[32:35], v[220:223], v[148:151]
s_waitcnt lgkmcnt(7)
v_exp_f32 v168, v168
v_exp_f32 v169, v169
v_exp_f32 v170, v170
v_exp_f32 v171, v171
v_exp_f32 v172, v172
v_exp_f32 v173, v173
v_exp_f32 v174, v174
v_exp_f32 v175, v175
v_mfma_f32_16x16x32_bf16 v[152:155], a[68:71], a[0:3], v[32:35]
s_waitcnt lgkmcnt(6)
v_cvt_pk_bf16_f32 v224, v168, v169
v_cvt_pk_bf16_f32 v225, v170, v171
v_cvt_pk_bf16_f32 v226, v172, v173
v_cvt_pk_bf16_f32 v227, v174, v175
v_mfma_f32_16x16x32_bf16 v[152:155], a[72:75], a[4:7], v[152:155]
s_waitcnt lgkmcnt(5)
v_mfma_f32_16x16x32_bf16 v[152:155], a[76:79], a[8:11], v[152:155]
s_waitcnt lgkmcnt(4)
v_mfma_f32_16x16x32_bf16 v[152:155], a[80:83], a[12:15], v[152:155]
s_waitcnt lgkmcnt(3)
v_mfma_f32_16x16x32_bf16 v[156:159], a[96:99], a[12:15], v[32:35]
s_waitcnt lgkmcnt(2)
v_mfma_f32_16x16x32_bf16 v[156:159], a[92:95], a[8:11], v[156:159]
s_waitcnt lgkmcnt(1)
v_mfma_f32_16x16x32_bf16 v[156:159], a[88:91], a[4:7], v[156:159]
s_waitcnt lgkmcnt(0)
v_mfma_f32_16x16x32_bf16 v[156:159], a[84:87], a[0:3], v[156:159]
buffer_load_dwordx4 v2, s[8:11], s24 offen offset:0 nt lds
v_mfma_f32_16x16x32_bf16 v[164:167], a[84:87], a[16:19], v[36:39]
s_add_u32 m0, m0, 32
v_mfma_f32_16x16x32_bf16 v[164:167], a[88:91], a[20:23], v[164:167]
buffer_load_dwordx4 v2, s[8:11], s24 offen offset:1024 nt lds
v_mfma_f32_16x16x32_bf16 v[164:167], a[92:95], a[24:27], v[164:167]
s_xor_b32 s24, s98, 2048
v_exp_f32 v152, v152
v_exp_f32 v153, v153
v_exp_f32 v154, v154
v_exp_f32 v155, v155
v_exp_f32 v156, v156
v_exp_f32 v157, v157
v_exp_f32 v158, v158
v_exp_f32 v159, v159
v_mfma_f32_16x16x32_bf16 v[164:167], a[96:99], a[28:31], v[164:167]
s_add_u32 m0, s29, 67584
v_cvt_pk_bf16_f32 v188, v152, v153
v_cvt_pk_bf16_f32 v189, v154, v155
v_cvt_pk_bf16_f32 v190, v156, v157
v_cvt_pk_bf16_f32 v191, v158, v159
v_mfma_f32_16x16x32_bf16 v[160:163], a[80:83], a[28:31], v[36:39]
v_mfma_f32_16x16x32_bf16 v[160:163], a[76:79], a[24:27], v[160:163]
v_mfma_f32_16x16x32_bf16 v[160:163], a[72:75], a[20:23], v[160:163]
v_mfma_f32_16x16x32_bf16 v[160:163], a[68:71], a[16:19], v[160:163]
buffer_load_dwordx4 v2, s[12:15], s24 offen offset:0 nt lds
v_mfma_f32_16x16x32_bf16 v[168:171], a[68:71], v[236:239], v[40:43]
s_add_u32 m0, m0, 8
v_mfma_f32_16x16x32_bf16 v[168:171], a[72:75], v[240:243], v[168:171]
buffer_load_dwordx4 v2, s[12:15], s24 offen offset:1024 nt lds
v_mfma_f32_16x16x32_bf16 v[168:171], a[76:79], v[244:247], v[168:171]
s_xor_b32 s24, s98, 14336
v_exp_f32 v164, v164
v_exp_f32 v165, v165
v_exp_f32 v166, v166
v_exp_f32 v167, v167
v_exp_f32 v160, v160
v_exp_f32 v161, v161
v_exp_f32 v162, v162
v_exp_f32 v163, v163
v_mfma_f32_16x16x32_bf16 v[168:171], a[80:83], v[248:251], v[168:171]
s_add_u32 m0, s23, 76032
v_cvt_pk_bf16_f32 v210, v164, v165
v_cvt_pk_bf16_f32 v211, v166, v167
v_cvt_pk_bf16_f32 v208, v160, v161
v_cvt_pk_bf16_f32 v209, v162, v163
v_mfma_f32_16x16x32_bf16 v[172:175], a[96:99], v[248:251], v[40:43]
v_mfma_f32_16x16x32_bf16 v[172:175], a[92:95], v[244:247], v[172:175]
v_mfma_f32_16x16x32_bf16 v[172:175], a[88:91], v[240:243], v[172:175]
v_mfma_f32_16x16x32_bf16 v[172:175], a[84:87], v[236:239], v[172:175]
v_mfma_f32_16x16x32_bf16 v[140:143], a[32:35], v[184:187], v[140:143]
s_waitcnt vmcnt(8)
s_barrier
v_mfma_f32_16x16x32_bf16 v[144:147], a[32:35], v[204:207], v[144:147]
ds_read_b128 a[36:39], v6 offset:33792
ds_read_b128 a[40:43], v6 offset:33856
ds_read_b128 a[44:47], v6 offset:33920
ds_read_b128 a[48:51], v6 offset:33984
ds_read_b128 a[64:67], v6 offset:34496
ds_read_b128 a[60:63], v6 offset:34432
ds_read_b128 a[56:59], v6 offset:34368
ds_read_b128 a[52:55], v6 offset:34304
v_mfma_f32_16x16x32_bf16 v[148:151], a[32:35], v[224:227], v[148:151]
s_waitcnt lgkmcnt(7)
v_exp_f32 v168, v168
v_exp_f32 v169, v169
v_exp_f32 v170, v170
v_exp_f32 v171, v171
v_exp_f32 v172, v172
v_exp_f32 v173, v173
v_exp_f32 v174, v174
v_exp_f32 v175, v175
v_mfma_f32_16x16x32_bf16 v[152:155], a[36:39], a[0:3], v[32:35]
s_waitcnt lgkmcnt(6)
v_cvt_pk_bf16_f32 v228, v168, v169
v_cvt_pk_bf16_f32 v229, v170, v171
v_cvt_pk_bf16_f32 v230, v172, v173
v_cvt_pk_bf16_f32 v231, v174, v175
v_mfma_f32_16x16x32_bf16 v[152:155], a[40:43], a[4:7], v[152:155]
s_waitcnt lgkmcnt(5)
v_mfma_f32_16x16x32_bf16 v[152:155], a[44:47], a[8:11], v[152:155]
s_waitcnt lgkmcnt(4)
v_mfma_f32_16x16x32_bf16 v[152:155], a[48:51], a[12:15], v[152:155]
s_waitcnt lgkmcnt(3)
v_mfma_f32_16x16x32_bf16 v[156:159], a[64:67], a[12:15], v[32:35]
s_waitcnt lgkmcnt(2)
v_mfma_f32_16x16x32_bf16 v[156:159], a[60:63], a[8:11], v[156:159]
s_waitcnt lgkmcnt(1)
v_mfma_f32_16x16x32_bf16 v[156:159], a[56:59], a[4:7], v[156:159]
s_waitcnt lgkmcnt(0)
v_mfma_f32_16x16x32_bf16 v[156:159], a[52:55], a[0:3], v[156:159]
v_mfma_f32_16x16x32_bf16 v[164:167], a[52:55], a[16:19], v[36:39]
v_mfma_f32_16x16x32_bf16 v[164:167], a[56:59], a[20:23], v[164:167]
v_mfma_f32_16x16x32_bf16 v[164:167], a[60:63], a[24:27], v[164:167]
v_exp_f32 v152, v152
v_exp_f32 v153, v153
v_exp_f32 v154, v154
v_exp_f32 v155, v155
v_exp_f32 v156, v156
v_exp_f32 v157, v157
v_exp_f32 v158, v158
v_exp_f32 v159, v159
v_mfma_f32_16x16x32_bf16 v[164:167], a[64:67], a[28:31], v[164:167]
v_cvt_pk_bf16_f32 v192, v152, v153
v_cvt_pk_bf16_f32 v193, v154, v155
v_cvt_pk_bf16_f32 v194, v156, v157
v_cvt_pk_bf16_f32 v195, v158, v159
v_mfma_f32_16x16x32_bf16 v[160:163], a[48:51], a[28:31], v[36:39]
v_mfma_f32_16x16x32_bf16 v[160:163], a[44:47], a[24:27], v[160:163]
v_mfma_f32_16x16x32_bf16 v[160:163], a[40:43], a[20:23], v[160:163]
v_mfma_f32_16x16x32_bf16 v[160:163], a[36:39], a[16:19], v[160:163]
v_mfma_f32_16x16x32_bf16 v[168:171], a[36:39], v[236:239], v[40:43]
v_mfma_f32_16x16x32_bf16 v[168:171], a[40:43], v[240:243], v[168:171]
buffer_load_dwordx4 v2, s[8:11], s24 offen offset:0 nt lds
v_mfma_f32_16x16x32_bf16 v[168:171], a[44:47], v[244:247], v[168:171]
s_add_u32 m0, m0, 32
v_exp_f32 v164, v164
v_exp_f32 v165, v165
v_exp_f32 v166, v166
v_exp_f32 v167, v167
v_exp_f32 v160, v160
v_exp_f32 v161, v161
v_exp_f32 v162, v162
v_exp_f32 v163, v163
v_mfma_f32_16x16x32_bf16 v[168:171], a[48:51], v[248:251], v[168:171]
buffer_load_dwordx4 v2, s[8:11], s24 offen offset:1024 nt lds
v_cvt_pk_bf16_f32 v214, v164, v165
v_cvt_pk_bf16_f32 v215, v166, v167
v_cvt_pk_bf16_f32 v212, v160, v161
v_cvt_pk_bf16_f32 v213, v162, v163
v_mfma_f32_16x16x32_bf16 v[172:175], a[64:67], v[248:251], v[40:43]
s_xor_b32 s24, s98, 4096
v_mfma_f32_16x16x32_bf16 v[172:175], a[60:63], v[244:247], v[172:175]
s_add_u32 m0, s29, 84480
v_mfma_f32_16x16x32_bf16 v[172:175], a[56:59], v[240:243], v[172:175]
v_mfma_f32_16x16x32_bf16 v[172:175], a[52:55], v[236:239], v[172:175]
v_mfma_f32_16x16x32_bf16 v[140:143], a[32:35], v[188:191], v[140:143]
s_waitcnt vmcnt(6)
s_barrier
v_mfma_f32_16x16x32_bf16 v[144:147], a[32:35], v[208:211], v[144:147]
ds_read_b64_tr_b16 a[100:101], v9 offset:50688
ds_read_b64_tr_b16 a[102:103], v9 offset:51200
s_waitcnt lgkmcnt(0)
ds_read_b64_tr_b16 a[104:105], v9 offset:50696
ds_read_b64_tr_b16 a[106:107], v9 offset:51208
ds_read_b64_tr_b16 a[108:109], v9 offset:50704
ds_read_b64_tr_b16 a[110:111], v9 offset:51216
ds_read_b64_tr_b16 a[112:113], v9 offset:50712
ds_read_b64_tr_b16 a[114:115], v9 offset:51224
ds_read_b64_tr_b16 a[116:117], v9 offset:50816
ds_read_b64_tr_b16 a[118:119], v9 offset:51328
ds_read_b64_tr_b16 a[120:121], v9 offset:50824
ds_read_b64_tr_b16 a[122:123], v9 offset:51336
ds_read_b64_tr_b16 a[124:125], v9 offset:50832
ds_read_b64_tr_b16 a[126:127], v9 offset:51344
ds_read_b64_tr_b16 a[128:129], v9 offset:50840
ds_read_b64_tr_b16 a[130:131], v9 offset:51352
v_mfma_f32_16x16x32_bf16 v[148:151], a[32:35], v[228:231], v[148:151]
ds_read_b128 a[68:71], v6 offset:42240
ds_read_b128 a[72:75], v6 offset:42304
ds_read_b128 a[76:79], v6 offset:42368
v_exp_f32 v168, v168
v_exp_f32 v169, v169
v_exp_f32 v170, v170
v_exp_f32 v171, v171
v_exp_f32 v172, v172
v_exp_f32 v173, v173
v_exp_f32 v174, v174
v_exp_f32 v175, v175
v_mfma_f32_16x16x32_bf16 v[44:47], a[100:103], v[176:179], 0
ds_read_b128 a[80:83], v6 offset:42432
ds_read_b128 a[96:99], v6 offset:42944
ds_read_b128 a[92:95], v6 offset:42880
v_cvt_pk_bf16_f32 v232, v168, v169
v_mfma_f32_16x16x32_bf16 v[76:79], a[100:103], v[196:199], 0
s_waitcnt lgkmcnt(15)
ds_read_b128 a[88:91], v6 offset:42816
v_cvt_pk_bf16_f32 v233, v170, v171
v_cvt_pk_bf16_f32 v234, v172, v173
v_mfma_f32_16x16x32_bf16 v[108:111], a[100:103], v[216:219], 0
ds_read_b128 a[84:87], v6 offset:42752
buffer_load_dwordx4 v2, s[12:15], s24 offen offset:0 nt lds
v_cvt_pk_bf16_f32 v235, v174, v175
v_mfma_f32_16x16x32_bf16 v[112:115], a[104:107], v[216:219], 0
s_add_u32 m0, m0, 8
v_mfma_f32_16x16x32_bf16 v[80:83], a[104:107], v[196:199], 0
s_waitcnt lgkmcnt(15)
buffer_load_dwordx4 v2, s[12:15], s24 offen offset:1024 nt lds
v_mfma_f32_16x16x32_bf16 v[48:51], a[104:107], v[176:179], 0
s_xor_b32 s24, s98, 16384
v_mfma_f32_16x16x32_bf16 v[52:55], a[108:111], v[176:179], 0
s_add_u32 m0, s23, 92928
v_mfma_f32_16x16x32_bf16 v[84:87], a[108:111], v[196:199], 0
v_mfma_f32_16x16x32_bf16 v[116:119], a[108:111], v[216:219], 0
v_mfma_f32_16x16x32_bf16 v[120:123], a[112:115], v[216:219], 0
v_mfma_f32_16x16x32_bf16 v[88:91], a[112:115], v[196:199], 0
s_waitcnt lgkmcnt(8)
v_mfma_f32_16x16x32_bf16 v[56:59], a[112:115], v[176:179], 0
v_mfma_f32_16x16x32_bf16 v[60:63], a[116:119], v[176:179], 0
v_mfma_f32_16x16x32_bf16 v[92:95], a[116:119], v[196:199], 0
v_mfma_f32_16x16x32_bf16 v[124:127], a[116:119], v[216:219], 0
v_mfma_f32_16x16x32_bf16 v[128:131], a[120:123], v[216:219], 0
v_mfma_f32_16x16x32_bf16 v[96:99], a[120:123], v[196:199], 0
v_mfma_f32_16x16x32_bf16 v[64:67], a[120:123], v[176:179], 0
v_mfma_f32_16x16x32_bf16 v[68:71], a[124:127], v[176:179], 0
v_mfma_f32_16x16x32_bf16 v[100:103], a[124:127], v[196:199], 0
v_mfma_f32_16x16x32_bf16 v[132:135], a[124:127], v[216:219], 0
v_mfma_f32_16x16x32_bf16 v[136:139], a[128:131], v[216:219], 0
v_mfma_f32_16x16x32_bf16 v[104:107], a[128:131], v[196:199], 0
s_waitcnt lgkmcnt(4)
v_mfma_f32_16x16x32_bf16 v[72:75], a[128:131], v[176:179], 0
v_mfma_f32_16x16x32_bf16 v[152:155], a[68:71], a[0:3], v[32:35]
v_mfma_f32_16x16x32_bf16 v[152:155], a[72:75], a[4:7], v[152:155]
v_mfma_f32_16x16x32_bf16 v[152:155], a[76:79], a[8:11], v[152:155]
s_waitcnt lgkmcnt(0)
v_mfma_f32_16x16x32_bf16 v[152:155], a[80:83], a[12:15], v[152:155]
v_mfma_f32_16x16x32_bf16 v[156:159], a[96:99], a[12:15], v[32:35]
buffer_load_dwordx4 v2, s[8:11], s24 offen offset:0 nt lds
v_mfma_f32_16x16x32_bf16 v[156:159], a[92:95], a[8:11], v[156:159]
s_add_u32 m0, m0, 32
v_mfma_f32_16x16x32_bf16 v[156:159], a[88:91], a[4:7], v[156:159]
buffer_load_dwordx4 v2, s[8:11], s24 offen offset:1024 nt lds
v_mfma_f32_16x16x32_bf16 v[156:159], a[84:87], a[0:3], v[156:159]
s_xor_b32 s24, s98, 6144
v_mfma_f32_16x16x32_bf16 v[164:167], a[84:87], a[16:19], v[36:39]
s_add_u32 m0, s29, 101376
v_mfma_f32_16x16x32_bf16 v[164:167], a[88:91], a[20:23], v[164:167]
v_mfma_f32_16x16x32_bf16 v[164:167], a[92:95], a[24:27], v[164:167]
v_exp_f32 v152, v152
v_exp_f32 v153, v153
v_exp_f32 v154, v154
v_exp_f32 v155, v155
v_exp_f32 v156, v156
v_exp_f32 v157, v157
v_exp_f32 v158, v158
v_exp_f32 v159, v159
v_mfma_f32_16x16x32_bf16 v[164:167], a[96:99], a[28:31], v[164:167]
v_cvt_pk_bf16_f32 v176, v152, v153
v_cvt_pk_bf16_f32 v177, v154, v155
v_cvt_pk_bf16_f32 v178, v156, v157
v_cvt_pk_bf16_f32 v179, v158, v159
v_mfma_f32_16x16x32_bf16 v[160:163], a[80:83], a[28:31], v[36:39]
v_mfma_f32_16x16x32_bf16 v[160:163], a[76:79], a[24:27], v[160:163]
v_mfma_f32_16x16x32_bf16 v[160:163], a[72:75], a[20:23], v[160:163]
v_mfma_f32_16x16x32_bf16 v[160:163], a[68:71], a[16:19], v[160:163]
v_mfma_f32_16x16x32_bf16 v[168:171], a[68:71], v[236:239], v[40:43]
v_mfma_f32_16x16x32_bf16 v[168:171], a[72:75], v[240:243], v[168:171]
v_mfma_f32_16x16x32_bf16 v[168:171], a[76:79], v[244:247], v[168:171]
v_exp_f32 v164, v164
v_exp_f32 v165, v165
v_exp_f32 v166, v166
v_exp_f32 v167, v167
v_exp_f32 v160, v160
v_exp_f32 v161, v161
v_exp_f32 v162, v162
v_exp_f32 v163, v163
v_mfma_f32_16x16x32_bf16 v[168:171], a[80:83], v[248:251], v[168:171]
v_cvt_pk_bf16_f32 v198, v164, v165
v_cvt_pk_bf16_f32 v199, v166, v167
v_cvt_pk_bf16_f32 v196, v160, v161
v_cvt_pk_bf16_f32 v197, v162, v163
v_mfma_f32_16x16x32_bf16 v[172:175], a[96:99], v[248:251], v[40:43]
buffer_load_dwordx4 v2, s[12:15], s24 offen offset:0 nt lds
v_mfma_f32_16x16x32_bf16 v[172:175], a[92:95], v[244:247], v[172:175]
s_add_u32 m0, m0, 8
v_mfma_f32_16x16x32_bf16 v[172:175], a[88:91], v[240:243], v[172:175]
v_mfma_f32_16x16x32_bf16 v[172:175], a[84:87], v[236:239], v[172:175]
v_mfma_f32_16x16x32_bf16 v[140:143], a[32:35], v[192:195], v[140:143]
s_waitcnt vmcnt(7)
s_barrier
v_mfma_f32_16x16x32_bf16 v[144:147], a[32:35], v[212:215], v[144:147]
ds_read_b64_tr_b16 a[132:133], v10 offset:8448
ds_read_b64_tr_b16 a[134:135], v10 offset:8960
s_waitcnt lgkmcnt(0)
ds_read_b64_tr_b16 a[136:137], v10 offset:8456
ds_read_b64_tr_b16 a[138:139], v10 offset:8968
ds_read_b64_tr_b16 a[140:141], v10 offset:8464
ds_read_b64_tr_b16 a[142:143], v10 offset:8976
ds_read_b64_tr_b16 a[144:145], v10 offset:8472
ds_read_b64_tr_b16 a[146:147], v10 offset:8984
ds_read_b64_tr_b16 a[148:149], v10 offset:8576
ds_read_b64_tr_b16 a[150:151], v10 offset:9088
ds_read_b64_tr_b16 a[152:153], v10 offset:8584
ds_read_b64_tr_b16 a[154:155], v10 offset:9096
ds_read_b64_tr_b16 a[156:157], v10 offset:8592
ds_read_b64_tr_b16 a[158:159], v10 offset:9104
ds_read_b64_tr_b16 a[160:161], v10 offset:8600
ds_read_b64_tr_b16 a[162:163], v10 offset:9112
buffer_load_dwordx4 v2, s[12:15], s24 offen offset:1024 nt lds
v_mfma_f32_16x16x32_bf16 v[148:151], a[32:35], v[232:235], v[148:151]
s_xor_b32 s24, s98, 18432
ds_read_b128 a[36:39], v7 offset:0
ds_read_b128 a[40:43], v7 offset:64
ds_read_b128 a[44:47], v7 offset:128
v_exp_f32 v168, v168
v_exp_f32 v169, v169
v_exp_f32 v170, v170
v_mfma_f32_16x16x32_bf16 v[44:47], a[132:135], v[180:183], v[44:47]
s_add_u32 m0, s23, 109824
ds_read_b128 a[48:51], v7 offset:192
ds_read_b128 a[64:67], v7 offset:704
v_exp_f32 v171, v171
v_mfma_f32_16x16x32_bf16 v[76:79], a[132:135], v[200:203], v[76:79]
s_waitcnt lgkmcnt(15)
ds_read_b128 a[60:63], v7 offset:640
v_exp_f32 v172, v172
v_mfma_f32_16x16x32_bf16 v[108:111], a[132:135], v[220:223], v[108:111]
v_exp_f32 v173, v173
v_cvt_pk_bf16_f32 v216, v168, v169
v_cvt_pk_bf16_f32 v217, v170, v171
v_mfma_f32_16x16x32_bf16 v[112:115], a[136:139], v[220:223], v[112:115]
ds_read_b128 a[56:59], v7 offset:576
v_exp_f32 v174, v174
v_mfma_f32_16x16x32_bf16 v[80:83], a[136:139], v[200:203], v[80:83]
s_waitcnt lgkmcnt(15)
ds_read_b128 a[52:55], v7 offset:512
v_exp_f32 v175, v175
v_mfma_f32_16x16x32_bf16 v[48:51], a[136:139], v[180:183], v[48:51]
v_cvt_pk_bf16_f32 v218, v172, v173
v_cvt_pk_bf16_f32 v219, v174, v175
v_mfma_f32_16x16x32_bf16 v[52:55], a[140:143], v[180:183], v[52:55]
v_mfma_f32_16x16x32_bf16 v[84:87], a[140:143], v[200:203], v[84:87]
v_mfma_f32_16x16x32_bf16 v[116:119], a[140:143], v[220:223], v[116:119]
v_mfma_f32_16x16x32_bf16 v[120:123], a[144:147], v[220:223], v[120:123]
v_mfma_f32_16x16x32_bf16 v[88:91], a[144:147], v[200:203], v[88:91]
s_waitcnt lgkmcnt(8)
v_mfma_f32_16x16x32_bf16 v[56:59], a[144:147], v[180:183], v[56:59]
v_mfma_f32_16x16x32_bf16 v[60:63], a[148:151], v[180:183], v[60:63]
v_mfma_f32_16x16x32_bf16 v[92:95], a[148:151], v[200:203], v[92:95]
v_mfma_f32_16x16x32_bf16 v[124:127], a[148:151], v[220:223], v[124:127]
v_mfma_f32_16x16x32_bf16 v[128:131], a[152:155], v[220:223], v[128:131]
v_mfma_f32_16x16x32_bf16 v[96:99], a[152:155], v[200:203], v[96:99]
v_mfma_f32_16x16x32_bf16 v[64:67], a[152:155], v[180:183], v[64:67]
L_touch1_o1:
s_cbranch_scc1 L_touch_ret
v_mfma_f32_16x16x32_bf16 v[68:71], a[156:159], v[180:183], v[68:71]
v_mfma_f32_16x16x32_bf16 v[100:103], a[156:159], v[200:203], v[100:103]
v_mfma_f32_16x16x32_bf16 v[132:135], a[156:159], v[220:223], v[132:135]
buffer_load_dwordx4 v2, s[8:11], s24 offen offset:0 nt lds
v_mfma_f32_16x16x32_bf16 v[136:139], a[160:163], v[220:223], v[136:139]
s_add_u32 m0, m0, 32
v_mfma_f32_16x16x32_bf16 v[104:107], a[160:163], v[200:203], v[104:107]
s_waitcnt lgkmcnt(4)
buffer_load_dwordx4 v2, s[8:11], s24 offen offset:1024 nt lds
v_mfma_f32_16x16x32_bf16 v[72:75], a[160:163], v[180:183], v[72:75]
s_xor_b32 s24, s98, 8192
v_mfma_f32_16x16x32_bf16 v[152:155], a[36:39], a[0:3], v[32:35]
s_add_u32 m0, s29, 118272
v_mfma_f32_16x16x32_bf16 v[152:155], a[40:43], a[4:7], v[152:155]
v_mfma_f32_16x16x32_bf16 v[152:155], a[44:47], a[8:11], v[152:155]
s_waitcnt lgkmcnt(0)
v_mfma_f32_16x16x32_bf16 v[152:155], a[48:51], a[12:15], v[152:155]
v_mfma_f32_16x16x32_bf16 v[156:159], a[64:67], a[12:15], v[32:35]
v_mfma_f32_16x16x32_bf16 v[156:159], a[60:63], a[8:11], v[156:159]
v_mfma_f32_16x16x32_bf16 v[156:159], a[56:59], a[4:7], v[156:159]
v_mfma_f32_16x16x32_bf16 v[156:159], a[52:55], a[0:3], v[156:159]
v_mfma_f32_16x16x32_bf16 v[164:167], a[52:55], a[16:19], v[36:39]
v_mfma_f32_16x16x32_bf16 v[164:167], a[56:59], a[20:23], v[164:167]
v_mfma_f32_16x16x32_bf16 v[164:167], a[60:63], a[24:27], v[164:167]
v_exp_f32 v152, v152
v_exp_f32 v153, v153
v_exp_f32 v154, v154
v_exp_f32 v155, v155
v_exp_f32 v156, v156
v_exp_f32 v157, v157
v_exp_f32 v158, v158
v_exp_f32 v159, v159
v_mfma_f32_16x16x32_bf16 v[164:167], a[64:67], a[28:31], v[164:167]
v_cvt_pk_bf16_f32 v180, v152, v153
v_cvt_pk_bf16_f32 v181, v154, v155
v_cvt_pk_bf16_f32 v182, v156, v157
v_cvt_pk_bf16_f32 v183, v158, v159
v_mfma_f32_16x16x32_bf16 v[160:163], a[48:51], a[28:31], v[36:39]
v_mfma_f32_16x16x32_bf16 v[160:163], a[44:47], a[24:27], v[160:163]
v_mfma_f32_16x16x32_bf16 v[160:163], a[40:43], a[20:23], v[160:163]
v_mfma_f32_16x16x32_bf16 v[160:163], a[36:39], a[16:19], v[160:163]
v_mfma_f32_16x16x32_bf16 v[168:171], a[36:39], v[236:239], v[40:43]
buffer_load_dwordx4 v2, s[12:15], s24 offen offset:0 nt lds
v_mfma_f32_16x16x32_bf16 v[168:171], a[40:43], v[240:243], v[168:171]
s_add_u32 m0, m0, 8
v_mfma_f32_16x16x32_bf16 v[168:171], a[44:47], v[244:247], v[168:171]
buffer_load_dwordx4 v2, s[12:15], s24 offen offset:1024 nt lds
v_exp_f32 v164, v164
v_exp_f32 v165, v165
v_exp_f32 v166, v166
v_exp_f32 v167, v167
v_exp_f32 v160, v160
v_exp_f32 v161, v161
v_exp_f32 v162, v162
v_exp_f32 v163, v163
v_mfma_f32_16x16x32_bf16 v[168:171], a[48:51], v[248:251], v[168:171]
s_xor_b32 s24, s98, 20480
v_cvt_pk_bf16_f32 v202, v164, v165
v_cvt_pk_bf16_f32 v203, v166, v167
v_cvt_pk_bf16_f32 v200, v160, v161
v_cvt_pk_bf16_f32 v201, v162, v163
v_mfma_f32_16x16x32_bf16 v[172:175], a[64:67], v[248:251], v[40:43]
s_add_u32 m0, s23, 126720
v_mfma_f32_16x16x32_bf16 v[172:175], a[60:63], v[244:247], v[172:175]
v_mfma_f32_16x16x32_bf16 v[172:175], a[56:59], v[240:243], v[172:175]
v_mfma_f32_16x16x32_bf16 v[172:175], a[52:55], v[236:239], v[172:175]
v_mfma_f32_16x16x32_bf16 v[140:143], a[32:35], v[176:179], v[140:143]
s_waitcnt vmcnt(8)
s_barrier
v_mfma_f32_16x16x32_bf16 v[144:147], a[32:35], v[196:199], v[144:147]
ds_read_b64_tr_b16 a[164:165], v10 offset:25344
ds_read_b64_tr_b16 a[166:167], v10 offset:25856
s_waitcnt lgkmcnt(0)
ds_read_b64_tr_b16 a[168:169], v10 offset:25352
ds_read_b64_tr_b16 a[170:171], v10 offset:25864
ds_read_b64_tr_b16 a[172:173], v10 offset:25360
ds_read_b64_tr_b16 a[174:175], v10 offset:25872
ds_read_b64_tr_b16 a[176:177], v10 offset:25368
ds_read_b64_tr_b16 a[178:179], v10 offset:25880
ds_read_b64_tr_b16 a[180:181], v10 offset:25472
ds_read_b64_tr_b16 a[182:183], v10 offset:25984
ds_read_b64_tr_b16 a[184:185], v10 offset:25480
ds_read_b64_tr_b16 a[186:187], v10 offset:25992
ds_read_b64_tr_b16 a[188:189], v10 offset:25488
ds_read_b64_tr_b16 a[190:191], v10 offset:26000
ds_read_b64_tr_b16 a[192:193], v10 offset:25496
ds_read_b64_tr_b16 a[194:195], v10 offset:26008
v_mfma_f32_16x16x32_bf16 v[148:151], a[32:35], v[216:219], v[148:151]
ds_read_b128 a[68:71], v7 offset:16896
ds_read_b128 a[72:75], v7 offset:16960
v_exp_f32 v168, v168
v_mfma_f32_16x16x32_bf16 v[44:47], a[164:167], v[184:187], v[44:47]
ds_read_b128 a[76:79], v7 offset:17024
v_exp_f32 v169, v169
v_mfma_f32_16x16x32_bf16 v[76:79], a[164:167], v[204:207], v[76:79]
s_waitcnt lgkmcnt(15)
ds_read_b128 a[80:83], v7 offset:17088
v_exp_f32 v170, v170
v_mfma_f32_16x16x32_bf16 v[108:111], a[164:167], v[224:227], v[108:111]
ds_read_b128 a[96:99], v7 offset:17600
v_cvt_pk_bf16_f32 v220, v168, v169
v_mfma_f32_16x16x32_bf16 v[112:115], a[168:171], v[224:227], v[112:115]
ds_read_b128 a[92:95], v7 offset:17536
v_exp_f32 v171, v171
v_mfma_f32_16x16x32_bf16 v[80:83], a[168:171], v[204:207], v[80:83]
s_waitcnt lgkmcnt(14)
ds_read_b128 a[88:91], v7 offset:17472
v_exp_f32 v172, v172
v_mfma_f32_16x16x32_bf16 v[48:51], a[168:171], v[184:187], v[48:51]
v_exp_f32 v173, v173
v_cvt_pk_bf16_f32 v221, v170, v171
v_mfma_f32_16x16x32_bf16 v[52:55], a[172:175], v[184:187], v[52:55]
ds_read_b128 a[84:87], v7 offset:17408
v_exp_f32 v174, v174
v_mfma_f32_16x16x32_bf16 v[84:87], a[172:175], v[204:207], v[84:87]
v_exp_f32 v175, v175
v_cvt_pk_bf16_f32 v222, v172, v173
v_mfma_f32_16x16x32_bf16 v[116:119], a[172:175], v[224:227], v[116:119]
v_cvt_pk_bf16_f32 v223, v174, v175
v_mfma_f32_16x16x32_bf16 v[120:123], a[176:179], v[224:227], v[120:123]
v_mfma_f32_16x16x32_bf16 v[88:91], a[176:179], v[204:207], v[88:91]
s_waitcnt lgkmcnt(8)
v_mfma_f32_16x16x32_bf16 v[56:59], a[176:179], v[184:187], v[56:59]
v_mfma_f32_16x16x32_bf16 v[60:63], a[180:183], v[184:187], v[60:63]
v_mfma_f32_16x16x32_bf16 v[92:95], a[180:183], v[204:207], v[92:95]
v_mfma_f32_16x16x32_bf16 v[124:127], a[180:183], v[224:227], v[124:127]
v_mfma_f32_16x16x32_bf16 v[128:131], a[184:187], v[224:227], v[128:131]
v_mfma_f32_16x16x32_bf16 v[96:99], a[184:187], v[204:207], v[96:99]
buffer_load_dwordx4 v2, s[8:11], s24 offen offset:0 nt lds
v_mfma_f32_16x16x32_bf16 v[64:67], a[184:187], v[184:187], v[64:67]
s_add_u32 m0, m0, 32
v_mfma_f32_16x16x32_bf16 v[68:71], a[188:191], v[184:187], v[68:71]
buffer_load_dwordx4 v2, s[8:11], s24 offen offset:1024 nt lds
v_mfma_f32_16x16x32_bf16 v[100:103], a[188:191], v[204:207], v[100:103]
s_xor_b32 s24, s98, 10240
v_mfma_f32_16x16x32_bf16 v[132:135], a[188:191], v[224:227], v[132:135]
s_add_u32 m0, s29, 135168
v_mfma_f32_16x16x32_bf16 v[136:139], a[192:195], v[224:227], v[136:139]
v_mfma_f32_16x16x32_bf16 v[104:107], a[192:195], v[204:207], v[104:107]
s_waitcnt lgkmcnt(4)
v_mfma_f32_16x16x32_bf16 v[72:75], a[192:195], v[184:187], v[72:75]
v_mfma_f32_16x16x32_bf16 v[152:155], a[68:71], a[0:3], v[32:35]
v_mfma_f32_16x16x32_bf16 v[152:155], a[72:75], a[4:7], v[152:155]
v_mfma_f32_16x16x32_bf16 v[152:155], a[76:79], a[8:11], v[152:155]
s_waitcnt lgkmcnt(0)
v_mfma_f32_16x16x32_bf16 v[152:155], a[80:83], a[12:15], v[152:155]
v_mfma_f32_16x16x32_bf16 v[156:159], a[96:99], a[12:15], v[32:35]
v_mfma_f32_16x16x32_bf16 v[156:159], a[92:95], a[8:11], v[156:159]
v_mfma_f32_16x16x32_bf16 v[156:159], a[88:91], a[4:7], v[156:159]
v_mfma_f32_16x16x32_bf16 v[156:159], a[84:87], a[0:3], v[156:159]
v_mfma_f32_16x16x32_bf16 v[164:167], a[84:87], a[16:19], v[36:39]
v_mfma_f32_16x16x32_bf16 v[164:167], a[88:91], a[20:23], v[164:167]
v_mfma_f32_16x16x32_bf16 v[164:167], a[92:95], a[24:27], v[164:167]
v_exp_f32 v152, v152
v_exp_f32 v153, v153
v_exp_f32 v154, v154
v_exp_f32 v155, v155
v_exp_f32 v156, v156
v_exp_f32 v157, v157
v_exp_f32 v158, v158
v_exp_f32 v159, v159
v_mfma_f32_16x16x32_bf16 v[164:167], a[96:99], a[28:31], v[164:167]
v_cvt_pk_bf16_f32 v184, v152, v153
v_cvt_pk_bf16_f32 v185, v154, v155
v_cvt_pk_bf16_f32 v186, v156, v157
v_cvt_pk_bf16_f32 v187, v158, v159
v_mfma_f32_16x16x32_bf16 v[160:163], a[80:83], a[28:31], v[36:39]
v_mfma_f32_16x16x32_bf16 v[160:163], a[76:79], a[24:27], v[160:163]
v_mfma_f32_16x16x32_bf16 v[160:163], a[72:75], a[20:23], v[160:163]
v_mfma_f32_16x16x32_bf16 v[160:163], a[68:71], a[16:19], v[160:163]
v_mfma_f32_16x16x32_bf16 v[168:171], a[68:71], v[236:239], v[40:43]
buffer_load_dwordx4 v2, s[12:15], s24 offen offset:0 nt lds
v_mfma_f32_16x16x32_bf16 v[168:171], a[72:75], v[240:243], v[168:171]
s_add_u32 m0, m0, 8
v_mfma_f32_16x16x32_bf16 v[168:171], a[76:79], v[244:247], v[168:171]
buffer_load_dwordx4 v2, s[12:15], s24 offen offset:1024 nt lds
v_exp_f32 v164, v164
v_exp_f32 v165, v165
v_exp_f32 v166, v166
v_exp_f32 v167, v167
v_exp_f32 v160, v160
v_exp_f32 v161, v161
v_exp_f32 v162, v162
v_exp_f32 v163, v163
v_mfma_f32_16x16x32_bf16 v[168:171], a[80:83], v[248:251], v[168:171]
s_xor_b32 s24, s98, 22528
v_cvt_pk_bf16_f32 v206, v164, v165
v_cvt_pk_bf16_f32 v207, v166, v167
v_cvt_pk_bf16_f32 v204, v160, v161
v_cvt_pk_bf16_f32 v205, v162, v163
v_mfma_f32_16x16x32_bf16 v[172:175], a[96:99], v[248:251], v[40:43]
s_add_u32 m0, s23, 143616
v_mfma_f32_16x16x32_bf16 v[172:175], a[92:95], v[244:247], v[172:175]
s_waitcnt vmcnt(8)
s_barrier
v_mfma_f32_16x16x32_bf16 v[172:175], a[88:91], v[240:243], v[172:175]
ds_read_b64_tr_b16 a[196:197], v10 offset:42240
ds_read_b64_tr_b16 a[198:199], v10 offset:42752
ds_read_b64_tr_b16 a[200:201], v10 offset:42248
ds_read_b64_tr_b16 a[202:203], v10 offset:42760
ds_read_b64_tr_b16 a[204:205], v10 offset:42256
v_mfma_f32_16x16x32_bf16 v[172:175], a[84:87], v[236:239], v[172:175]
ds_read_b64_tr_b16 a[206:207], v10 offset:42768
ds_read_b64_tr_b16 a[208:209], v10 offset:42264
ds_read_b64_tr_b16 a[210:211], v10 offset:42776
v_mfma_f32_16x16x32_bf16 v[140:143], a[32:35], v[180:183], v[140:143]
ds_read_b64_tr_b16 a[212:213], v10 offset:42368
ds_read_b64_tr_b16 a[214:215], v10 offset:42880
ds_read_b64_tr_b16 a[216:217], v10 offset:42376
v_mfma_f32_16x16x32_bf16 v[144:147], a[32:35], v[200:203], v[144:147]
s_waitcnt lgkmcnt(9)
ds_read_b64_tr_b16 a[218:219], v10 offset:42888
ds_read_b64_tr_b16 a[220:221], v10 offset:42384
v_mfma_f32_16x16x32_bf16 v[148:151], a[32:35], v[220:223], v[148:151]
ds_read_b64_tr_b16 a[222:223], v10 offset:42896
ds_read_b64_tr_b16 a[224:225], v10 offset:42392
ds_read_b64_tr_b16 a[226:227], v10 offset:42904
v_mfma_f32_16x16x32_bf16 v[44:47], a[196:199], v[188:191], v[44:47]
ds_read_b128 a[36:39], v7 offset:33792
ds_read_b128 a[40:43], v7 offset:33856
v_mfma_f32_16x16x32_bf16 v[76:79], a[196:199], v[208:211], v[76:79]
s_waitcnt lgkmcnt(14)
ds_read_b128 a[44:47], v7 offset:33920
v_exp_f32 v168, v168
v_mfma_f32_16x16x32_bf16 v[108:111], a[196:199], v[228:231], v[108:111]
v_exp_f32 v169, v169
v_mfma_f32_16x16x32_bf16 v[112:115], a[200:203], v[228:231], v[112:115]
ds_read_b128 a[48:51], v7 offset:33984
v_exp_f32 v170, v170
v_mfma_f32_16x16x32_bf16 v[80:83], a[200:203], v[208:211], v[80:83]
s_waitcnt lgkmcnt(12)
ds_read_b128 a[64:67], v7 offset:34496
v_exp_f32 v171, v171
v_mfma_f32_16x16x32_bf16 v[48:51], a[200:203], v[188:191], v[48:51]
ds_read_b128 a[60:63], v7 offset:34432
v_exp_f32 v172, v172
v_mfma_f32_16x16x32_bf16 v[52:55], a[204:207], v[188:191], v[52:55]
v_exp_f32 v173, v173
v_mfma_f32_16x16x32_bf16 v[84:87], a[204:207], v[208:211], v[84:87]
ds_read_b128 a[56:59], v7 offset:34368
v_cvt_pk_bf16_f32 v224, v168, v169
v_cvt_pk_bf16_f32 v225, v170, v171
v_mfma_f32_16x16x32_bf16 v[116:119], a[204:207], v[228:231], v[116:119]
ds_read_b128 a[52:55], v7 offset:34304
v_exp_f32 v174, v174
v_mfma_f32_16x16x32_bf16 v[120:123], a[208:211], v[228:231], v[120:123]
v_exp_f32 v175, v175
v_mfma_f32_16x16x32_bf16 v[88:91], a[208:211], v[208:211], v[88:91]
s_waitcnt lgkmcnt(8)
v_cvt_pk_bf16_f32 v226, v172, v173
v_cvt_pk_bf16_f32 v227, v174, v175
v_mfma_f32_16x16x32_bf16 v[56:59], a[208:211], v[188:191], v[56:59]
v_mfma_f32_16x16x32_bf16 v[60:63], a[212:215], v[188:191], v[60:63]
buffer_load_dwordx4 v2, s[8:11], s24 offen offset:0 nt lds
v_mfma_f32_16x16x32_bf16 v[92:95], a[212:215], v[208:211], v[92:95]
s_add_u32 m0, m0, 32
v_mfma_f32_16x16x32_bf16 v[124:127], a[212:215], v[228:231], v[124:127]
buffer_load_dwordx4 v2, s[8:11], s24 offen offset:1024 nt lds
v_mfma_f32_16x16x32_bf16 v[128:131], a[216:219], v[228:231], v[128:131]
s_xor_b32 s24, s98, 12288
v_mfma_f32_16x16x32_bf16 v[96:99], a[216:219], v[208:211], v[96:99]
s_add_u32 m0, s29, 152064
v_mfma_f32_16x16x32_bf16 v[64:67], a[216:219], v[188:191], v[64:67]
v_mfma_f32_16x16x32_bf16 v[68:71], a[220:223], v[188:191], v[68:71]
v_mfma_f32_16x16x32_bf16 v[100:103], a[220:223], v[208:211], v[100:103]
v_mfma_f32_16x16x32_bf16 v[132:135], a[220:223], v[228:231], v[132:135]
v_mfma_f32_16x16x32_bf16 v[136:139], a[224:227], v[228:231], v[136:139]
v_mfma_f32_16x16x32_bf16 v[104:107], a[224:227], v[208:211], v[104:107]
s_waitcnt lgkmcnt(4)
v_mfma_f32_16x16x32_bf16 v[72:75], a[224:227], v[188:191], v[72:75]
v_mfma_f32_16x16x32_bf16 v[152:155], a[36:39], a[0:3], v[32:35]
v_mfma_f32_16x16x32_bf16 v[152:155], a[40:43], a[4:7], v[152:155]
v_mfma_f32_16x16x32_bf16 v[152:155], a[44:47], a[8:11], v[152:155]
s_waitcnt lgkmcnt(0)
v_mfma_f32_16x16x32_bf16 v[152:155], a[48:51], a[12:15], v[152:155]
v_mfma_f32_16x16x32_bf16 v[156:159], a[64:67], a[12:15], v[32:35]
v_mfma_f32_16x16x32_bf16 v[156:159], a[60:63], a[8:11], v[156:159]
v_mfma_f32_16x16x32_bf16 v[156:159], a[56:59], a[4:7], v[156:159]
v_mfma_f32_16x16x32_bf16 v[156:159], a[52:55], a[0:3], v[156:159]
v_mfma_f32_16x16x32_bf16 v[164:167], a[52:55], a[16:19], v[36:39]
v_mfma_f32_16x16x32_bf16 v[164:167], a[56:59], a[20:23], v[164:167]
v_mfma_f32_16x16x32_bf16 v[164:167], a[60:63], a[24:27], v[164:167]
v_exp_f32 v152, v152
v_exp_f32 v153, v153
v_exp_f32 v154, v154
v_exp_f32 v155, v155
v_exp_f32 v156, v156
v_exp_f32 v157, v157
v_exp_f32 v158, v158
v_exp_f32 v159, v159
v_mfma_f32_16x16x32_bf16 v[164:167], a[64:67], a[28:31], v[164:167]
v_cvt_pk_bf16_f32 v188, v152, v153
v_cvt_pk_bf16_f32 v189, v154, v155
v_cvt_pk_bf16_f32 v190, v156, v157
v_cvt_pk_bf16_f32 v191, v158, v159
v_mfma_f32_16x16x32_bf16 v[160:163], a[48:51], a[28:31], v[36:39]
v_mfma_f32_16x16x32_bf16 v[160:163], a[44:47], a[24:27], v[160:163]
v_mfma_f32_16x16x32_bf16 v[160:163], a[40:43], a[20:23], v[160:163]
v_mfma_f32_16x16x32_bf16 v[160:163], a[36:39], a[16:19], v[160:163]
v_mfma_f32_16x16x32_bf16 v[168:171], a[36:39], v[236:239], v[40:43]
buffer_load_dwordx4 v2, s[12:15], s24 offen offset:0 nt lds
v_mfma_f32_16x16x32_bf16 v[168:171], a[40:43], v[240:243], v[168:171]
s_add_u32 m0, m0, 8
v_mfma_f32_16x16x32_bf16 v[168:171], a[44:47], v[244:247], v[168:171]
v_exp_f32 v164, v164
v_exp_f32 v165, v165
v_exp_f32 v166, v166
v_mfma_f32_16x16x32_bf16 v[168:171], a[48:51], v[248:251], v[168:171]
s_waitcnt vmcnt(7)
s_barrier
v_mfma_f32_16x16x32_bf16 v[172:175], a[64:67], v[248:251], v[40:43]
ds_read_b64_tr_b16 a[100:101], v11 offset:0
ds_read_b64_tr_b16 a[102:103], v11 offset:512
buffer_load_dwordx4 v2, s[12:15], s24 offen offset:1024 nt lds
v_mfma_f32_16x16x32_bf16 v[172:175], a[60:63], v[244:247], v[172:175]
s_xor_b32 s24, s98, 24576
ds_read_b64_tr_b16 a[104:105], v11 offset:8
ds_read_b64_tr_b16 a[106:107], v11 offset:520
ds_read_b64_tr_b16 a[108:109], v11 offset:16
v_mfma_f32_16x16x32_bf16 v[172:175], a[56:59], v[240:243], v[172:175]
s_add_u32 m0, s23, 0
ds_read_b64_tr_b16 a[110:111], v11 offset:528
ds_read_b64_tr_b16 a[112:113], v11 offset:24
v_mfma_f32_16x16x32_bf16 v[172:175], a[52:55], v[236:239], v[172:175]
ds_read_b64_tr_b16 a[114:115], v11 offset:536
ds_read_b64_tr_b16 a[116:117], v11 offset:128
v_mfma_f32_16x16x32_bf16 v[140:143], a[32:35], v[184:187], v[140:143]
ds_read_b64_tr_b16 a[118:119], v11 offset:640
ds_read_b64_tr_b16 a[120:121], v11 offset:136
ds_read_b64_tr_b16 a[122:123], v11 offset:648
v_mfma_f32_16x16x32_bf16 v[144:147], a[32:35], v[204:207], v[144:147]
s_waitcnt lgkmcnt(10)
ds_read_b64_tr_b16 a[124:125], v11 offset:144
ds_read_b64_tr_b16 a[126:127], v11 offset:656
v_mfma_f32_16x16x32_bf16 v[148:151], a[32:35], v[224:227], v[148:151]
ds_read_b128 a[68:71], v7 offset:50688
ds_read_b64_tr_b16 a[128:129], v11 offset:152
ds_read_b64_tr_b16 a[130:131], v11 offset:664
v_mfma_f32_16x16x32_bf16 v[44:47], a[100:103], v[192:195], v[44:47]
ds_read_b128 a[72:75], v7 offset:50752
ds_read_b128 a[76:79], v7 offset:50816
v_mfma_f32_16x16x32_bf16 v[76:79], a[100:103], v[212:215], v[76:79]
s_waitcnt lgkmcnt(15)
ds_read_b128 a[80:83], v7 offset:50880
v_exp_f32 v167, v167
v_mfma_f32_16x16x32_bf16 v[108:111], a[100:103], v[232:235], v[108:111]
ds_read_b128 a[96:99], v7 offset:51392
v_cvt_pk_bf16_f32 v210, v164, v165
v_mfma_f32_16x16x32_bf16 v[112:115], a[104:107], v[232:235], v[112:115]
v_exp_f32 v160, v160
v_cvt_pk_bf16_f32 v211, v166, v167
v_mfma_f32_16x16x32_bf16 v[80:83], a[104:107], v[212:215], v[80:83]
s_waitcnt lgkmcnt(13)
v_exp_f32 v161, v161
v_mfma_f32_16x16x32_bf16 v[48:51], a[104:107], v[192:195], v[48:51]
ds_read_b128 a[92:95], v7 offset:51328
ds_read_b128 a[88:91], v7 offset:51264
v_cvt_pk_bf16_f32 v208, v160, v161
v_mfma_f32_16x16x32_bf16 v[52:55], a[108:111], v[192:195], v[52:55]
v_exp_f32 v162, v162
v_mfma_f32_16x16x32_bf16 v[84:87], a[108:111], v[212:215], v[84:87]
v_exp_f32 v163, v163
v_mfma_f32_16x16x32_bf16 v[116:119], a[108:111], v[232:235], v[116:119]
ds_read_b128 a[84:87], v7 offset:51200
v_exp_f32 v168, v168
v_mfma_f32_16x16x32_bf16 v[120:123], a[112:115], v[232:235], v[120:123]
v_exp_f32 v169, v169
v_mfma_f32_16x16x32_bf16 v[88:91], a[112:115], v[212:215], v[88:91]
s_waitcnt lgkmcnt(7)
v_cvt_pk_bf16_f32 v209, v162, v163
v_exp_f32 v170, v170
v_mfma_f32_16x16x32_bf16 v[56:59], a[112:115], v[192:195], v[56:59]
v_exp_f32 v171, v171
v_mfma_f32_16x16x32_bf16 v[60:63], a[116:119], v[192:195], v[60:63]
buffer_load_dwordx4 v2, s[8:11], s24 offen offset:0 nt lds
v_cvt_pk_bf16_f32 v228, v168, v169
v_mfma_f32_16x16x32_bf16 v[92:95], a[116:119], v[212:215], v[92:95]
s_add_u32 m0, m0, 32
v_exp_f32 v172, v172
v_mfma_f32_16x16x32_bf16 v[124:127], a[116:119], v[232:235], v[124:127]
buffer_load_dwordx4 v2, s[8:11], s24 offen offset:1024 nt lds
v_cvt_pk_bf16_f32 v229, v170, v171
v_mfma_f32_16x16x32_bf16 v[128:131], a[120:123], v[232:235], v[128:131]
s_xor_b32 s24, s98, 14336
v_exp_f32 v173, v173
v_mfma_f32_16x16x32_bf16 v[96:99], a[120:123], v[212:215], v[96:99]
s_add_u32 m0, s29, 8448
v_exp_f32 v174, v174
v_mfma_f32_16x16x32_bf16 v[64:67], a[120:123], v[192:195], v[64:67]
v_exp_f32 v175, v175
v_cvt_pk_bf16_f32 v230, v172, v173
v_mfma_f32_16x16x32_bf16 v[68:71], a[124:127], v[192:195], v[68:71]
v_cvt_pk_bf16_f32 v231, v174, v175
v_mfma_f32_16x16x32_bf16 v[100:103], a[124:127], v[212:215], v[100:103]
v_mfma_f32_16x16x32_bf16 v[132:135], a[124:127], v[232:235], v[132:135]
v_mfma_f32_16x16x32_bf16 v[136:139], a[128:131], v[232:235], v[136:139]
v_mfma_f32_16x16x32_bf16 v[104:107], a[128:131], v[212:215], v[104:107]
s_waitcnt lgkmcnt(4)
v_mfma_f32_16x16x32_bf16 v[72:75], a[128:131], v[192:195], v[72:75]
v_mfma_f32_16x16x32_bf16 v[152:155], a[68:71], a[0:3], v[32:35]
v_mfma_f32_16x16x32_bf16 v[152:155], a[72:75], a[4:7], v[152:155]
v_mfma_f32_16x16x32_bf16 v[152:155], a[76:79], a[8:11], v[152:155]
s_waitcnt lgkmcnt(0)
v_mfma_f32_16x16x32_bf16 v[152:155], a[80:83], a[12:15], v[152:155]
v_mfma_f32_16x16x32_bf16 v[156:159], a[96:99], a[12:15], v[32:35]
v_mfma_f32_16x16x32_bf16 v[156:159], a[92:95], a[8:11], v[156:159]
v_mfma_f32_16x16x32_bf16 v[156:159], a[88:91], a[4:7], v[156:159]
v_mfma_f32_16x16x32_bf16 v[156:159], a[84:87], a[0:3], v[156:159]
v_mfma_f32_16x16x32_bf16 v[164:167], a[84:87], a[16:19], v[36:39]
v_mfma_f32_16x16x32_bf16 v[164:167], a[88:91], a[20:23], v[164:167]
v_mfma_f32_16x16x32_bf16 v[164:167], a[92:95], a[24:27], v[164:167]
v_exp_f32 v152, v152
v_exp_f32 v153, v153
v_exp_f32 v154, v154
v_exp_f32 v155, v155
v_exp_f32 v156, v156
v_mfma_f32_16x16x32_bf16 v[164:167], a[96:99], a[28:31], v[164:167]
v_exp_f32 v157, v157
v_mfma_f32_16x16x32_bf16 v[160:163], a[80:83], a[28:31], v[36:39]
v_exp_f32 v158, v158
v_cvt_pk_bf16_f32 v192, v152, v153
v_mfma_f32_16x16x32_bf16 v[160:163], a[76:79], a[24:27], v[160:163]
v_cvt_pk_bf16_f32 v193, v154, v155
v_cvt_pk_bf16_f32 v194, v156, v157
v_mfma_f32_16x16x32_bf16 v[160:163], a[72:75], a[20:23], v[160:163]
v_exp_f32 v159, v159
v_mfma_f32_16x16x32_bf16 v[160:163], a[68:71], a[16:19], v[160:163]
v_cvt_pk_bf16_f32 v195, v158, v159
v_mfma_f32_16x16x32_bf16 v[168:171], a[68:71], v[236:239], v[40:43]
buffer_load_dwordx4 v2, s[12:15], s24 offen offset:0 nt lds
v_mfma_f32_16x16x32_bf16 v[168:171], a[72:75], v[240:243], v[168:171]
s_add_u32 m0, m0, 8
v_mfma_f32_16x16x32_bf16 v[168:171], a[76:79], v[244:247], v[168:171]
v_exp_f32 v164, v164
v_exp_f32 v165, v165
v_mfma_f32_16x16x32_bf16 v[168:171], a[80:83], v[248:251], v[168:171]
s_waitcnt vmcnt(7)
s_barrier
v_mfma_f32_16x16x32_bf16 v[172:175], a[96:99], v[248:251], v[40:43]
ds_read_b64_tr_b16 a[132:133], v11 offset:16896
ds_read_b64_tr_b16 a[134:135], v11 offset:17408
ds_read_b64_tr_b16 a[136:137], v11 offset:16904
v_mfma_f32_16x16x32_bf16 v[172:175], a[92:95], v[244:247], v[172:175]
ds_read_b64_tr_b16 a[138:139], v11 offset:17416
buffer_load_dwordx4 v2, s[12:15], s24 offen offset:1024 nt lds
v_mfma_f32_16x16x32_bf16 v[172:175], a[88:91], v[240:243], v[172:175]
s_xor_b32 s24, s98, 26624
ds_read_b64_tr_b16 a[140:141], v11 offset:16912
ds_read_b64_tr_b16 a[142:143], v11 offset:17424
v_mfma_f32_16x16x32_bf16 v[172:175], a[84:87], v[236:239], v[172:175]
s_add_u32 m0, s23, 16896
ds_read_b64_tr_b16 a[144:145], v11 offset:16920
ds_read_b64_tr_b16 a[146:147], v11 offset:17432
v_mfma_f32_16x16x32_bf16 v[140:143], a[32:35], v[188:191], v[140:143]
ds_read_b64_tr_b16 a[148:149], v11 offset:17024
ds_read_b64_tr_b16 a[150:151], v11 offset:17536
ds_read_b64_tr_b16 a[152:153], v11 offset:17032
v_mfma_f32_16x16x32_bf16 v[144:147], a[32:35], v[208:211], v[144:147]
s_waitcnt lgkmcnt(9)
ds_read_b64_tr_b16 a[154:155], v11 offset:17544
ds_read_b64_tr_b16 a[156:157], v11 offset:17040
v_mfma_f32_16x16x32_bf16 v[148:151], a[32:35], v[228:231], v[148:151]
ds_read_b64_tr_b16 a[158:159], v11 offset:17552
ds_read_b64_tr_b16 a[160:161], v11 offset:17048
ds_read_b64_tr_b16 a[162:163], v11 offset:17560
v_mfma_f32_16x16x32_bf16 v[44:47], a[132:135], v[176:179], v[44:47]
ds_read_b128 a[36:39], v8 offset:8448
ds_read_b128 a[40:43], v8 offset:8512
v_mfma_f32_16x16x32_bf16 v[76:79], a[132:135], v[196:199], v[76:79]
s_waitcnt lgkmcnt(14)
ds_read_b128 a[44:47], v8 offset:8576
ds_read_b128 a[48:51], v8 offset:8640
v_cvt_pk_bf16_f32 v214, v164, v165
v_mfma_f32_16x16x32_bf16 v[108:111], a[132:135], v[216:219], v[108:111]
v_exp_f32 v166, v166
v_mfma_f32_16x16x32_bf16 v[112:115], a[136:139], v[216:219], v[112:115]
v_exp_f32 v167, v167
v_mfma_f32_16x16x32_bf16 v[80:83], a[136:139], v[196:199], v[80:83]
s_waitcnt lgkmcnt(12)
ds_read_b128 a[64:67], v8 offset:9152
ds_read_b128 a[60:63], v8 offset:9088
v_cvt_pk_bf16_f32 v215, v166, v167
v_mfma_f32_16x16x32_bf16 v[48:51], a[136:139], v[176:179], v[48:51]
v_exp_f32 v160, v160
v_mfma_f32_16x16x32_bf16 v[52:55], a[140:143], v[176:179], v[52:55]
ds_read_b128 a[56:59], v8 offset:9024
v_exp_f32 v161, v161
v_mfma_f32_16x16x32_bf16 v[84:87], a[140:143], v[196:199], v[84:87]
ds_read_b128 a[52:55], v8 offset:8960
v_cvt_pk_bf16_f32 v212, v160, v161
v_mfma_f32_16x16x32_bf16 v[116:119], a[140:143], v[216:219], v[116:119]
v_exp_f32 v162, v162
v_mfma_f32_16x16x32_bf16 v[120:123], a[144:147], v[216:219], v[120:123]
v_exp_f32 v163, v163
v_mfma_f32_16x16x32_bf16 v[88:91], a[144:147], v[196:199], v[88:91]
s_waitcnt lgkmcnt(8)
v_cvt_pk_bf16_f32 v213, v162, v163
v_exp_f32 v168, v168
v_mfma_f32_16x16x32_bf16 v[56:59], a[144:147], v[176:179], v[56:59]
v_exp_f32 v169, v169
v_mfma_f32_16x16x32_bf16 v[60:63], a[148:151], v[176:179], v[60:63]
buffer_load_dwordx4 v2, s[8:11], s24 offen offset:0 nt lds
v_cvt_pk_bf16_f32 v232, v168, v169
v_mfma_f32_16x16x32_bf16 v[92:95], a[148:151], v[196:199], v[92:95]
s_add_u32 m0, m0, 32
v_exp_f32 v170, v170
v_mfma_f32_16x16x32_bf16 v[124:127], a[148:151], v[216:219], v[124:127]
buffer_load_dwordx4 v2, s[8:11], s24 offen offset:1024 nt lds
v_mfma_f32_16x16x32_bf16 v[128:131], a[152:155], v[216:219], v[128:131]
s_xor_b32 s24, s98, 16384
v_exp_f32 v171, v171
v_exp_f32 v172, v172
v_mfma_f32_16x16x32_bf16 v[96:99], a[152:155], v[196:199], v[96:99]
s_add_u32 m0, s29, 25344
v_exp_f32 v173, v173
v_mfma_f32_16x16x32_bf16 v[64:67], a[152:155], v[176:179], v[64:67]
v_exp_f32 v174, v174
v_mfma_f32_16x16x32_bf16 v[68:71], a[156:159], v[176:179], v[68:71]
v_exp_f32 v175, v175
v_cvt_pk_bf16_f32 v233, v170, v171
v_mfma_f32_16x16x32_bf16 v[100:103], a[156:159], v[196:199], v[100:103]
v_cvt_pk_bf16_f32 v234, v172, v173
v_cvt_pk_bf16_f32 v235, v174, v175
v_mfma_f32_16x16x32_bf16 v[132:135], a[156:159], v[216:219], v[132:135]
v_mfma_f32_16x16x32_bf16 v[136:139], a[160:163], v[216:219], v[136:139]
v_mfma_f32_16x16x32_bf16 v[104:107], a[160:163], v[196:199], v[104:107]
s_waitcnt lgkmcnt(4)
v_mfma_f32_16x16x32_bf16 v[72:75], a[160:163], v[176:179], v[72:75]
v_mfma_f32_16x16x32_bf16 v[152:155], a[36:39], a[0:3], v[32:35]
v_mfma_f32_16x16x32_bf16 v[152:155], a[40:43], a[4:7], v[152:155]
v_mfma_f32_16x16x32_bf16 v[152:155], a[44:47], a[8:11], v[152:155]
s_waitcnt lgkmcnt(0)
v_mfma_f32_16x16x32_bf16 v[152:155], a[48:51], a[12:15], v[152:155]
v_mfma_f32_16x16x32_bf16 v[156:159], a[64:67], a[12:15], v[32:35]
v_mfma_f32_16x16x32_bf16 v[156:159], a[60:63], a[8:11], v[156:159]
v_mfma_f32_16x16x32_bf16 v[156:159], a[56:59], a[4:7], v[156:159]
v_mfma_f32_16x16x32_bf16 v[156:159], a[52:55], a[0:3], v[156:159]
v_mfma_f32_16x16x32_bf16 v[164:167], a[52:55], a[16:19], v[36:39]
v_mfma_f32_16x16x32_bf16 v[164:167], a[56:59], a[20:23], v[164:167]
v_mfma_f32_16x16x32_bf16 v[164:167], a[60:63], a[24:27], v[164:167]
v_exp_f32 v152, v152
v_exp_f32 v153, v153
v_exp_f32 v154, v154
v_exp_f32 v155, v155
v_mfma_f32_16x16x32_bf16 v[164:167], a[64:67], a[28:31], v[164:167]
v_exp_f32 v156, v156
v_cvt_pk_bf16_f32 v176, v152, v153
v_mfma_f32_16x16x32_bf16 v[160:163], a[48:51], a[28:31], v[36:39]
v_exp_f32 v157, v157
v_cvt_pk_bf16_f32 v177, v154, v155
v_mfma_f32_16x16x32_bf16 v[160:163], a[44:47], a[24:27], v[160:163]
v_exp_f32 v158, v158
v_mfma_f32_16x16x32_bf16 v[160:163], a[40:43], a[20:23], v[160:163]
v_exp_f32 v159, v159
v_mfma_f32_16x16x32_bf16 v[160:163], a[36:39], a[16:19], v[160:163]
v_cvt_pk_bf16_f32 v178, v156, v157
v_cvt_pk_bf16_f32 v179, v158, v159
v_mfma_f32_16x16x32_bf16 v[168:171], a[36:39], v[236:239], v[40:43]
buffer_load_dwordx4 v2, s[12:15], s24 offen offset:0 nt lds
v_mfma_f32_16x16x32_bf16 v[168:171], a[40:43], v[240:243], v[168:171]
s_add_u32 m0, m0, 8
v_mfma_f32_16x16x32_bf16 v[168:171], a[44:47], v[244:247], v[168:171]
v_exp_f32 v164, v164
v_exp_f32 v165, v165
v_mfma_f32_16x16x32_bf16 v[168:171], a[48:51], v[248:251], v[168:171]
s_waitcnt vmcnt(7)
s_barrier
v_mfma_f32_16x16x32_bf16 v[172:175], a[64:67], v[248:251], v[40:43]
ds_read_b64_tr_b16 a[164:165], v11 offset:33792
ds_read_b64_tr_b16 a[166:167], v11 offset:34304
ds_read_b64_tr_b16 a[168:169], v11 offset:33800
v_mfma_f32_16x16x32_bf16 v[172:175], a[60:63], v[244:247], v[172:175]
buffer_load_dwordx4 v2, s[12:15], s24 offen offset:1024 nt lds
v_mfma_f32_16x16x32_bf16 v[172:175], a[56:59], v[240:243], v[172:175]
s_xor_b32 s24, s98, 28672
ds_read_b64_tr_b16 a[170:171], v11 offset:34312
ds_read_b64_tr_b16 a[172:173], v11 offset:33808
v_mfma_f32_16x16x32_bf16 v[172:175], a[52:55], v[236:239], v[172:175]
s_add_u32 m0, s23, 33792
ds_read_b64_tr_b16 a[174:175], v11 offset:34320
ds_read_b64_tr_b16 a[176:177], v11 offset:33816
ds_read_b64_tr_b16 a[178:179], v11 offset:34328
v_mfma_f32_16x16x32_bf16 v[140:143], a[32:35], v[192:195], v[140:143]
ds_read_b64_tr_b16 a[180:181], v11 offset:33920
ds_read_b64_tr_b16 a[182:183], v11 offset:34432
v_mfma_f32_16x16x32_bf16 v[144:147], a[32:35], v[212:215], v[144:147]
s_waitcnt lgkmcnt(8)
ds_read_b64_tr_b16 a[184:185], v11 offset:33928
ds_read_b64_tr_b16 a[186:187], v11 offset:34440
v_mfma_f32_16x16x32_bf16 v[148:151], a[32:35], v[232:235], v[148:151]
L_touch2_o1:
s_cbranch_scc1 L_touch_ret
ds_read_b64_tr_b16 a[188:189], v11 offset:33936
ds_read_b64_tr_b16 a[190:191], v11 offset:34448
v_mfma_f32_16x16x32_bf16 v[44:47], a[164:167], v[180:183], v[44:47]
ds_read_b128 a[68:71], v8 offset:25344
ds_read_b64_tr_b16 a[192:193], v11 offset:33944
ds_read_b64_tr_b16 a[194:195], v11 offset:34456
v_mfma_f32_16x16x32_bf16 v[76:79], a[164:167], v[200:203], v[76:79]
s_waitcnt lgkmcnt(13)
ds_read_b128 a[72:75], v8 offset:25408
ds_read_b128 a[76:79], v8 offset:25472
v_mfma_f32_16x16x32_bf16 v[108:111], a[164:167], v[220:223], v[108:111]
ds_read_b128 a[80:83], v8 offset:25536
v_cvt_pk_bf16_f32 v198, v164, v165
v_mfma_f32_16x16x32_bf16 v[112:115], a[168:171], v[220:223], v[112:115]
v_exp_f32 v166, v166
v_mfma_f32_16x16x32_bf16 v[80:83], a[168:171], v[200:203], v[80:83]
s_waitcnt lgkmcnt(12)
ds_read_b128 a[96:99], v8 offset:26048
v_exp_f32 v167, v167
v_mfma_f32_16x16x32_bf16 v[48:51], a[168:171], v[180:183], v[48:51]
ds_read_b128 a[92:95], v8 offset:25984
v_cvt_pk_bf16_f32 v199, v166, v167
v_mfma_f32_16x16x32_bf16 v[52:55], a[172:175], v[180:183], v[52:55]
v_exp_f32 v160, v160
v_mfma_f32_16x16x32_bf16 v[84:87], a[172:175], v[200:203], v[84:87]
v_exp_f32 v161, v161
v_mfma_f32_16x16x32_bf16 v[116:119], a[172:175], v[220:223], v[116:119]
ds_read_b128 a[88:91], v8 offset:25920
ds_read_b128 a[84:87], v8 offset:25856
v_cvt_pk_bf16_f32 v196, v160, v161
v_mfma_f32_16x16x32_bf16 v[120:123], a[176:179], v[220:223], v[120:123]
v_exp_f32 v162, v162
v_mfma_f32_16x16x32_bf16 v[88:91], a[176:179], v[200:203], v[88:91]
s_waitcnt lgkmcnt(7)
v_exp_f32 v163, v163
v_mfma_f32_16x16x32_bf16 v[56:59], a[176:179], v[180:183], v[56:59]
v_cvt_pk_bf16_f32 v197, v162, v163
v_exp_f32 v168, v168
v_mfma_f32_16x16x32_bf16 v[60:63], a[180:183], v[180:183], v[60:63]
buffer_load_dwordx4 v2, s[8:11], s24 offen offset:0 nt lds
v_mfma_f32_16x16x32_bf16 v[92:95], a[180:183], v[200:203], v[92:95]
s_add_u32 m0, m0, 32
v_exp_f32 v169, v169
v_mfma_f32_16x16x32_bf16 v[124:127], a[180:183], v[220:223], v[124:127]
buffer_load_dwordx4 v2, s[8:11], s24 offen offset:1024 nt lds
v_mfma_f32_16x16x32_bf16 v[128:131], a[184:187], v[220:223], v[128:131]
s_xor_b32 s24, s98, 18432
v_exp_f32 v170, v170
v_cvt_pk_bf16_f32 v216, v168, v169
v_mfma_f32_16x16x32_bf16 v[96:99], a[184:187], v[200:203], v[96:99]
s_add_u32 m0, s29, 42240
v_exp_f32 v171, v171
v_mfma_f32_16x16x32_bf16 v[64:67], a[184:187], v[180:183], v[64:67]
v_exp_f32 v172, v172
v_mfma_f32_16x16x32_bf16 v[68:71], a[188:191], v[180:183], v[68:71]
v_exp_f32 v173, v173
v_mfma_f32_16x16x32_bf16 v[100:103], a[188:191], v[200:203], v[100:103]
v_exp_f32 v174, v174
v_cvt_pk_bf16_f32 v217, v170, v171
v_mfma_f32_16x16x32_bf16 v[132:135], a[188:191], v[220:223], v[132:135]
v_exp_f32 v175, v175
v_mfma_f32_16x16x32_bf16 v[136:139], a[192:195], v[220:223], v[136:139]
v_cvt_pk_bf16_f32 v218, v172, v173
v_cvt_pk_bf16_f32 v219, v174, v175
v_mfma_f32_16x16x32_bf16 v[104:107], a[192:195], v[200:203], v[104:107]
s_waitcnt lgkmcnt(4)
v_mfma_f32_16x16x32_bf16 v[72:75], a[192:195], v[180:183], v[72:75]
v_mfma_f32_16x16x32_bf16 v[152:155], a[68:71], a[0:3], v[32:35]
v_mfma_f32_16x16x32_bf16 v[152:155], a[72:75], a[4:7], v[152:155]
v_mfma_f32_16x16x32_bf16 v[152:155], a[76:79], a[8:11], v[152:155]
s_waitcnt lgkmcnt(0)
v_mfma_f32_16x16x32_bf16 v[152:155], a[80:83], a[12:15], v[152:155]
v_mfma_f32_16x16x32_bf16 v[156:159], a[96:99], a[12:15], v[32:35]
v_mfma_f32_16x16x32_bf16 v[156:159], a[92:95], a[8:11], v[156:159]
v_mfma_f32_16x16x32_bf16 v[156:159], a[88:91], a[4:7], v[156:159]
v_mfma_f32_16x16x32_bf16 v[156:159], a[84:87], a[0:3], v[156:159]
v_mfma_f32_16x16x32_bf16 v[164:167], a[84:87], a[16:19], v[36:39]
v_mfma_f32_16x16x32_bf16 v[164:167], a[88:91], a[20:23], v[164:167]
v_mfma_f32_16x16x32_bf16 v[164:167], a[92:95], a[24:27], v[164:167]
v_exp_f32 v152, v152
v_exp_f32 v153, v153
v_exp_f32 v154, v154
v_mfma_f32_16x16x32_bf16 v[164:167], a[96:99], a[28:31], v[164:167]
v_exp_f32 v155, v155
v_mfma_f32_16x16x32_bf16 v[160:163], a[80:83], a[28:31], v[36:39]
v_exp_f32 v156, v156
v_mfma_f32_16x16x32_bf16 v[160:163], a[76:79], a[24:27], v[160:163]
v_exp_f32 v157, v157
v_mfma_f32_16x16x32_bf16 v[160:163], a[72:75], a[20:23], v[160:163]
v_exp_f32 v158, v158
v_cvt_pk_bf16_f32 v180, v152, v153
v_mfma_f32_16x16x32_bf16 v[160:163], a[68:71], a[16:19], v[160:163]
v_cvt_pk_bf16_f32 v181, v154, v155
v_cvt_pk_bf16_f32 v182, v156, v157
v_mfma_f32_16x16x32_bf16 v[168:171], a[68:71], v[236:239], v[40:43]
buffer_load_dwordx4 v2, s[12:15], s24 offen offset:0 nt lds
v_mfma_f32_16x16x32_bf16 v[168:171], a[72:75], v[240:243], v[168:171]
s_add_u32 m0, m0, 8
v_exp_f32 v159, v159
v_mfma_f32_16x16x32_bf16 v[168:171], a[76:79], v[244:247], v[168:171]
v_cvt_pk_bf16_f32 v183, v158, v159
v_exp_f32 v164, v164
v_mfma_f32_16x16x32_bf16 v[168:171], a[80:83], v[248:251], v[168:171]
s_waitcnt vmcnt(7)
s_barrier
v_mfma_f32_16x16x32_bf16 v[172:175], a[96:99], v[248:251], v[40:43]
ds_read_b64_tr_b16 a[196:197], v9 offset:8448
ds_read_b64_tr_b16 a[198:199], v9 offset:8960
v_mfma_f32_16x16x32_bf16 v[172:175], a[92:95], v[244:247], v[172:175]
buffer_load_dwordx4 v2, s[12:15], s24 offen offset:1024 nt lds
v_mfma_f32_16x16x32_bf16 v[172:175], a[88:91], v[240:243], v[172:175]
s_xor_b32 s24, s98, 30720
ds_read_b64_tr_b16 a[200:201], v9 offset:8456
ds_read_b64_tr_b16 a[202:203], v9 offset:8968
v_mfma_f32_16x16x32_bf16 v[172:175], a[84:87], v[236:239], v[172:175]
s_add_u32 m0, s23, 50688
ds_read_b64_tr_b16 a[204:205], v9 offset:8464
ds_read_b64_tr_b16 a[206:207], v9 offset:8976
ds_read_b64_tr_b16 a[208:209], v9 offset:8472
v_mfma_f32_16x16x32_bf16 v[140:143], a[32:35], v[176:179], v[140:143]
ds_read_b64_tr_b16 a[210:211], v9 offset:8984
ds_read_b64_tr_b16 a[212:213], v9 offset:8576
v_mfma_f32_16x16x32_bf16 v[144:147], a[32:35], v[196:199], v[144:147]
s_waitcnt lgkmcnt(7)
ds_read_b64_tr_b16 a[214:215], v9 offset:9088
ds_read_b64_tr_b16 a[216:217], v9 offset:8584
v_mfma_f32_16x16x32_bf16 v[148:151], a[32:35], v[216:219], v[148:151]
ds_read_b64_tr_b16 a[218:219], v9 offset:9096
ds_read_b64_tr_b16 a[220:221], v9 offset:8592
v_mfma_f32_16x16x32_bf16 v[44:47], a[196:199], v[184:187], v[44:47]
ds_read_b64_tr_b16 a[222:223], v9 offset:9104
ds_read_b64_tr_b16 a[224:225], v9 offset:8600
v_mfma_f32_16x16x32_bf16 v[76:79], a[196:199], v[204:207], v[76:79]
s_waitcnt lgkmcnt(11)
ds_read_b128 a[36:39], v6 offset:0
ds_read_b128 a[40:43], v6 offset:64
ds_read_b64_tr_b16 a[226:227], v9 offset:9112
v_mfma_f32_16x16x32_bf16 v[108:111], a[196:199], v[224:227], v[108:111]
ds_read_b128 a[44:47], v6 offset:128
ds_read_b128 a[48:51], v6 offset:192
v_mfma_f32_16x16x32_bf16 v[112:115], a[200:203], v[224:227], v[112:115]
v_exp_f32 v165, v165
v_mfma_f32_16x16x32_bf16 v[80:83], a[200:203], v[204:207], v[80:83]
s_waitcnt lgkmcnt(12)
ds_read_b128 a[64:67], v6 offset:704
v_cvt_pk_bf16_f32 v202, v164, v165
v_mfma_f32_16x16x32_bf16 v[48:51], a[200:203], v[184:187], v[48:51]
v_exp_f32 v166, v166
v_mfma_f32_16x16x32_bf16 v[52:55], a[204:207], v[184:187], v[52:55]
ds_read_b128 a[60:63], v6 offset:640
v_exp_f32 v167, v167
v_mfma_f32_16x16x32_bf16 v[84:87], a[204:207], v[204:207], v[84:87]
ds_read_b128 a[56:59], v6 offset:576
v_cvt_pk_bf16_f32 v203, v166, v167
v_mfma_f32_16x16x32_bf16 v[116:119], a[204:207], v[224:227], v[116:119]
buffer_load_dwordx4 v2, s[8:11], s24 offen offset:0 nt lds
v_mfma_f32_16x16x32_bf16 v[120:123], a[208:211], v[224:227], v[120:123]
s_add_u32 m0, m0, 32
v_exp_f32 v160, v160
v_mfma_f32_16x16x32_bf16 v[88:91], a[208:211], v[204:207], v[88:91]
s_waitcnt lgkmcnt(5)
buffer_load_dwordx4 v2, s[8:11], s24 offen offset:1024 nt lds
v_mfma_f32_16x16x32_bf16 v[56:59], a[208:211], v[184:187], v[56:59]
s_xor_b32 s24, s98, 20480
ds_read_b128 a[52:55], v6 offset:512
v_exp_f32 v161, v161
v_mfma_f32_16x16x32_bf16 v[60:63], a[212:215], v[184:187], v[60:63]
s_add_u32 m0, s29, 59136
v_exp_f32 v162, v162
v_mfma_f32_16x16x32_bf16 v[92:95], a[212:215], v[204:207], v[92:95]
v_exp_f32 v163, v163
v_mfma_f32_16x16x32_bf16 v[124:127], a[212:215], v[224:227], v[124:127]
v_cvt_pk_bf16_f32 v200, v160, v161
v_cvt_pk_bf16_f32 v201, v162, v163
v_mfma_f32_16x16x32_bf16 v[128:131], a[216:219], v[224:227], v[128:131]
v_exp_f32 v168, v168
v_mfma_f32_16x16x32_bf16 v[96:99], a[216:219], v[204:207], v[96:99]
v_exp_f32 v169, v169
v_mfma_f32_16x16x32_bf16 v[64:67], a[216:219], v[184:187], v[64:67]
v_exp_f32 v170, v170
v_cvt_pk_bf16_f32 v220, v168, v169
v_mfma_f32_16x16x32_bf16 v[68:71], a[220:223], v[184:187], v[68:71]
v_exp_f32 v171, v171
v_mfma_f32_16x16x32_bf16 v[100:103], a[220:223], v[204:207], v[100:103]
v_exp_f32 v172, v172
v_mfma_f32_16x16x32_bf16 v[132:135], a[220:223], v[224:227], v[132:135]
v_exp_f32 v173, v173
v_mfma_f32_16x16x32_bf16 v[136:139], a[224:227], v[224:227], v[136:139]
v_exp_f32 v174, v174
v_cvt_pk_bf16_f32 v221, v170, v171
v_mfma_f32_16x16x32_bf16 v[104:107], a[224:227], v[204:207], v[104:107]
s_waitcnt lgkmcnt(4)
v_exp_f32 v175, v175
v_mfma_f32_16x16x32_bf16 v[72:75], a[224:227], v[184:187], v[72:75]
v_cvt_pk_bf16_f32 v222, v172, v173
v_cvt_pk_bf16_f32 v223, v174, v175
v_mfma_f32_16x16x32_bf16 v[152:155], a[36:39], a[0:3], v[32:35]
v_mfma_f32_16x16x32_bf16 v[152:155], a[40:43], a[4:7], v[152:155]
v_mfma_f32_16x16x32_bf16 v[152:155], a[44:47], a[8:11], v[152:155]
s_waitcnt lgkmcnt(0)
v_mfma_f32_16x16x32_bf16 v[152:155], a[48:51], a[12:15], v[152:155]
v_mfma_f32_16x16x32_bf16 v[156:159], a[64:67], a[12:15], v[32:35]
v_mfma_f32_16x16x32_bf16 v[156:159], a[60:63], a[8:11], v[156:159]
v_mfma_f32_16x16x32_bf16 v[156:159], a[56:59], a[4:7], v[156:159]
v_mfma_f32_16x16x32_bf16 v[156:159], a[52:55], a[0:3], v[156:159]
v_mfma_f32_16x16x32_bf16 v[164:167], a[52:55], a[16:19], v[36:39]
v_mfma_f32_16x16x32_bf16 v[164:167], a[56:59], a[20:23], v[164:167]
v_mfma_f32_16x16x32_bf16 v[164:167], a[60:63], a[24:27], v[164:167]
v_exp_f32 v152, v152
v_exp_f32 v153, v153
v_mfma_f32_16x16x32_bf16 v[164:167], a[64:67], a[28:31], v[164:167]
v_exp_f32 v154, v154
v_mfma_f32_16x16x32_bf16 v[160:163], a[48:51], a[28:31], v[36:39]
v_exp_f32 v155, v155
v_cvt_pk_bf16_f32 v184, v152, v153
v_mfma_f32_16x16x32_bf16 v[160:163], a[44:47], a[24:27], v[160:163]
v_exp_f32 v156, v156
v_mfma_f32_16x16x32_bf16 v[160:163], a[40:43], a[20:23], v[160:163]
v_exp_f32 v157, v157
v_mfma_f32_16x16x32_bf16 v[160:163], a[36:39], a[16:19], v[160:163]
v_exp_f32 v158, v158
v_mfma_f32_16x16x32_bf16 v[168:171], a[36:39], v[236:239], v[40:43]
buffer_load_dwordx4 v2, s[12:15], s24 offen offset:0 nt lds
v_mfma_f32_16x16x32_bf16 v[168:171], a[40:43], v[240:243], v[168:171]
s_add_u32 m0, m0, 8
v_exp_f32 v159, v159
v_cvt_pk_bf16_f32 v185, v154, v155
v_mfma_f32_16x16x32_bf16 v[168:171], a[44:47], v[244:247], v[168:171]
v_cvt_pk_bf16_f32 v186, v156, v157
v_cvt_pk_bf16_f32 v187, v158, v159
v_mfma_f32_16x16x32_bf16 v[168:171], a[48:51], v[248:251], v[168:171]
s_waitcnt vmcnt(7)
s_barrier
v_mfma_f32_16x16x32_bf16 v[172:175], a[64:67], v[248:251], v[40:43]
ds_read_b64_tr_b16 a[100:101], v9 offset:25344
ds_read_b64_tr_b16 a[102:103], v9 offset:25856
v_mfma_f32_16x16x32_bf16 v[172:175], a[60:63], v[244:247], v[172:175]
buffer_load_dwordx4 v2, s[12:15], s24 offen offset:1024 nt lds
v_mfma_f32_16x16x32_bf16 v[172:175], a[56:59], v[240:243], v[172:175]
s_xor_b32 s24, s98, 22528
ds_read_b64_tr_b16 a[104:105], v9 offset:25352
ds_read_b64_tr_b16 a[106:107], v9 offset:25864
v_mfma_f32_16x16x32_bf16 v[172:175], a[52:55], v[236:239], v[172:175]
s_add_u32 m0, s29, 67584
ds_read_b64_tr_b16 a[108:109], v9 offset:25360
ds_read_b64_tr_b16 a[110:111], v9 offset:25872
v_mfma_f32_16x16x32_bf16 v[140:143], a[32:35], v[180:183], v[140:143]
ds_read_b64_tr_b16 a[112:113], v9 offset:25368
ds_read_b64_tr_b16 a[114:115], v9 offset:25880
ds_read_b64_tr_b16 a[116:117], v9 offset:25472
v_mfma_f32_16x16x32_bf16 v[144:147], a[32:35], v[200:203], v[144:147]
s_waitcnt lgkmcnt(7)
ds_read_b64_tr_b16 a[118:119], v9 offset:25984
ds_read_b64_tr_b16 a[120:121], v9 offset:25480
v_mfma_f32_16x16x32_bf16 v[148:151], a[32:35], v[220:223], v[148:151]
ds_read_b64_tr_b16 a[122:123], v9 offset:25992
ds_read_b64_tr_b16 a[124:125], v9 offset:25488
v_mfma_f32_16x16x32_bf16 v[44:47], a[100:103], v[188:191], v[44:47]
ds_read_b64_tr_b16 a[126:127], v9 offset:26000
ds_read_b64_tr_b16 a[128:129], v9 offset:25496
v_mfma_f32_16x16x32_bf16 v[76:79], a[100:103], v[208:211], v[76:79]
s_waitcnt lgkmcnt(11)
ds_read_b128 a[68:71], v6 offset:16896
ds_read_b64_tr_b16 a[130:131], v9 offset:26008
v_mfma_f32_16x16x32_bf16 v[108:111], a[100:103], v[228:231], v[108:111]
ds_read_b128 a[72:75], v6 offset:16960
ds_read_b128 a[76:79], v6 offset:17024
v_mfma_f32_16x16x32_bf16 v[112:115], a[104:107], v[228:231], v[112:115]
ds_read_b128 a[80:83], v6 offset:17088
v_exp_f32 v164, v164
v_mfma_f32_16x16x32_bf16 v[80:83], a[104:107], v[208:211], v[80:83]
s_waitcnt lgkmcnt(12)
v_exp_f32 v165, v165
v_mfma_f32_16x16x32_bf16 v[48:51], a[104:107], v[188:191], v[48:51]
ds_read_b128 a[96:99], v6 offset:17600
ds_read_b128 a[92:95], v6 offset:17536
v_mfma_f32_16x16x32_bf16 v[52:55], a[108:111], v[188:191], v[52:55]
v_exp_f32 v166, v166
v_mfma_f32_16x16x32_bf16 v[84:87], a[108:111], v[208:211], v[84:87]
ds_read_b128 a[88:91], v6 offset:17472
v_cvt_pk_bf16_f32 v206, v164, v165
v_mfma_f32_16x16x32_bf16 v[116:119], a[108:111], v[228:231], v[116:119]
v_exp_f32 v167, v167
v_mfma_f32_16x16x32_bf16 v[120:123], a[112:115], v[228:231], v[120:123]
ds_read_b128 a[84:87], v6 offset:17408
v_exp_f32 v160, v160
v_mfma_f32_16x16x32_bf16 v[88:91], a[112:115], v[208:211], v[88:91]
s_waitcnt lgkmcnt(7)
v_exp_f32 v161, v161
v_mfma_f32_16x16x32_bf16 v[56:59], a[112:115], v[188:191], v[56:59]
v_exp_f32 v162, v162
v_mfma_f32_16x16x32_bf16 v[60:63], a[116:119], v[188:191], v[60:63]
v_cvt_pk_bf16_f32 v207, v166, v167
v_cvt_pk_bf16_f32 v204, v160, v161
v_mfma_f32_16x16x32_bf16 v[92:95], a[116:119], v[208:211], v[92:95]
v_exp_f32 v163, v163
v_mfma_f32_16x16x32_bf16 v[124:127], a[116:119], v[228:231], v[124:127]
v_exp_f32 v168, v168
v_mfma_f32_16x16x32_bf16 v[128:131], a[120:123], v[228:231], v[128:131]
v_exp_f32 v169, v169
v_mfma_f32_16x16x32_bf16 v[96:99], a[120:123], v[208:211], v[96:99]
v_cvt_pk_bf16_f32 v205, v162, v163
v_exp_f32 v170, v170
v_mfma_f32_16x16x32_bf16 v[64:67], a[120:123], v[188:191], v[64:67]
v_exp_f32 v171, v171
v_mfma_f32_16x16x32_bf16 v[68:71], a[124:127], v[188:191], v[68:71]
v_exp_f32 v172, v172
v_mfma_f32_16x16x32_bf16 v[100:103], a[124:127], v[208:211], v[100:103]
v_exp_f32 v173, v173
v_mfma_f32_16x16x32_bf16 v[132:135], a[124:127], v[228:231], v[132:135]
v_cvt_pk_bf16_f32 v224, v168, v169
v_cvt_pk_bf16_f32 v225, v170, v171
v_mfma_f32_16x16x32_bf16 v[136:139], a[128:131], v[228:231], v[136:139]
v_exp_f32 v174, v174
v_mfma_f32_16x16x32_bf16 v[104:107], a[128:131], v[208:211], v[104:107]
s_waitcnt lgkmcnt(4)
buffer_load_dwordx4 v2, s[12:15], s24 offen offset:0 nt lds
v_cvt_pk_bf16_f32 v226, v172, v173
v_mfma_f32_16x16x32_bf16 v[72:75], a[128:131], v[188:191], v[72:75]
s_add_u32 m0, m0, 8
v_exp_f32 v175, v175
v_mfma_f32_16x16x32_bf16 v[152:155], a[68:71], a[0:3], v[32:35]
buffer_load_dwordx4 v2, s[12:15], s24 offen offset:1024 nt lds
v_mfma_f32_16x16x32_bf16 v[152:155], a[72:75], a[4:7], v[152:155]
s_xor_b32 s24, s101, 24576
v_cvt_pk_bf16_f32 v227, v174, v175
v_mfma_f32_16x16x32_bf16 v[152:155], a[76:79], a[8:11], v[152:155]
s_waitcnt lgkmcnt(0)
v_mfma_f32_16x16x32_bf16 v[152:155], a[80:83], a[12:15], v[152:155]
s_add_u32 m0, s29, 76032
v_mfma_f32_16x16x32_bf16 v[156:159], a[96:99], a[12:15], v[32:35]
v_mfma_f32_16x16x32_bf16 v[156:159], a[92:95], a[8:11], v[156:159]
v_mfma_f32_16x16x32_bf16 v[156:159], a[88:91], a[4:7], v[156:159]
buffer_load_dwordx4 v4, s[12:15], s24 offen offset:0 nt lds
v_mfma_f32_16x16x32_bf16 v[156:159], a[84:87], a[0:3], v[156:159]
s_add_u32 m0, m0, 8
v_mfma_f32_16x16x32_bf16 v[164:167], a[84:87], a[16:19], v[36:39]
buffer_load_dwordx4 v4, s[12:15], s24 offen offset:1024 nt lds
v_mfma_f32_16x16x32_bf16 v[164:167], a[88:91], a[20:23], v[164:167]
s_xor_b32 s24, s101, 28672
v_mfma_f32_16x16x32_bf16 v[164:167], a[92:95], a[24:27], v[164:167]
s_add_u32 m0, s29, 84480
v_exp_f32 v152, v152
v_mfma_f32_16x16x32_bf16 v[164:167], a[96:99], a[28:31], v[164:167]
v_exp_f32 v153, v153
v_exp_f32 v154, v154
v_mfma_f32_16x16x32_bf16 v[160:163], a[80:83], a[28:31], v[36:39]
v_exp_f32 v155, v155
v_mfma_f32_16x16x32_bf16 v[160:163], a[76:79], a[24:27], v[160:163]
v_exp_f32 v156, v156
v_mfma_f32_16x16x32_bf16 v[160:163], a[72:75], a[20:23], v[160:163]
v_exp_f32 v157, v157
v_mfma_f32_16x16x32_bf16 v[160:163], a[68:71], a[16:19], v[160:163]
v_cvt_pk_bf16_f32 v188, v152, v153
v_cvt_pk_bf16_f32 v189, v154, v155
v_mfma_f32_16x16x32_bf16 v[168:171], a[68:71], v[236:239], v[40:43]
v_exp_f32 v158, v158
v_mfma_f32_16x16x32_bf16 v[168:171], a[72:75], v[240:243], v[168:171]
v_exp_f32 v159, v159
v_cvt_pk_bf16_f32 v190, v156, v157
v_mfma_f32_16x16x32_bf16 v[168:171], a[76:79], v[244:247], v[168:171]
v_exp_f32 v164, v164
v_mfma_f32_16x16x32_bf16 v[168:171], a[80:83], v[248:251], v[168:171]
s_waitcnt vmcnt(8)
s_barrier
v_mfma_f32_16x16x32_bf16 v[172:175], a[96:99], v[248:251], v[40:43]
ds_read_b64_tr_b16 a[132:133], v9 offset:42240
ds_read_b64_tr_b16 a[134:135], v9 offset:42752
v_mfma_f32_16x16x32_bf16 v[172:175], a[92:95], v[244:247], v[172:175]
ds_read_b64_tr_b16 a[136:137], v9 offset:42248
ds_read_b64_tr_b16 a[138:139], v9 offset:42760
v_mfma_f32_16x16x32_bf16 v[172:175], a[88:91], v[240:243], v[172:175]
ds_read_b64_tr_b16 a[140:141], v9 offset:42256
ds_read_b64_tr_b16 a[142:143], v9 offset:42768
v_mfma_f32_16x16x32_bf16 v[172:175], a[84:87], v[236:239], v[172:175]
ds_read_b64_tr_b16 a[144:145], v9 offset:42264
ds_read_b64_tr_b16 a[146:147], v9 offset:42776
v_mfma_f32_16x16x32_bf16 v[140:143], a[32:35], v[184:187], v[140:143]
ds_read_b64_tr_b16 a[148:149], v9 offset:42368
ds_read_b64_tr_b16 a[150:151], v9 offset:42880
ds_read_b64_tr_b16 a[152:153], v9 offset:42376
v_mfma_f32_16x16x32_bf16 v[144:147], a[32:35], v[204:207], v[144:147]
s_waitcnt lgkmcnt(9)
ds_read_b64_tr_b16 a[154:155], v9 offset:42888
ds_read_b64_tr_b16 a[156:157], v9 offset:42384
v_mfma_f32_16x16x32_bf16 v[148:151], a[32:35], v[224:227], v[148:151]
ds_read_b64_tr_b16 a[158:159], v9 offset:42896
ds_read_b64_tr_b16 a[160:161], v9 offset:42392
v_mfma_f32_16x16x32_bf16 v[44:47], a[132:135], v[192:195], v[44:47]
ds_read_b128 a[36:39], v6 offset:33792
ds_read_b64_tr_b16 a[162:163], v9 offset:42904
v_mfma_f32_16x16x32_bf16 v[76:79], a[132:135], v[212:215], v[76:79]
s_waitcnt lgkmcnt(13)
ds_read_b128 a[40:43], v6 offset:33856
ds_read_b128 a[44:47], v6 offset:33920
v_mfma_f32_16x16x32_bf16 v[108:111], a[132:135], v[232:235], v[108:111]
ds_read_b128 a[48:51], v6 offset:33984
v_cvt_pk_bf16_f32 v191, v158, v159
v_mfma_f32_16x16x32_bf16 v[112:115], a[136:139], v[232:235], v[112:115]
v_exp_f32 v165, v165
v_mfma_f32_16x16x32_bf16 v[80:83], a[136:139], v[212:215], v[80:83]
s_waitcnt lgkmcnt(12)
buffer_load_dwordx4 v4, s[12:15], s24 offen offset:0 nt lds
v_mfma_f32_16x16x32_bf16 v[48:51], a[136:139], v[192:195], v[48:51]
s_add_u32 m0, m0, 8
ds_read_b128 a[64:67], v6 offset:34496
ds_read_b128 a[60:63], v6 offset:34432
v_cvt_pk_bf16_f32 v210, v164, v165
v_mfma_f32_16x16x32_bf16 v[52:55], a[140:143], v[192:195], v[52:55]
buffer_load_dwordx4 v4, s[12:15], s24 offen offset:1024 nt lds
v_mfma_f32_16x16x32_bf16 v[84:87], a[140:143], v[212:215], v[84:87]
s_xor_b32 s24, s101, 24704
v_exp_f32 v166, v166
v_mfma_f32_16x16x32_bf16 v[116:119], a[140:143], v[232:235], v[116:119]
s_add_u32 m0, s29, 92928
ds_read_b128 a[56:59], v6 offset:34368
ds_read_b128 a[52:55], v6 offset:34304
v_mfma_f32_16x16x32_bf16 v[120:123], a[144:147], v[232:235], v[120:123]
v_exp_f32 v167, v167
v_mfma_f32_16x16x32_bf16 v[88:91], a[144:147], v[212:215], v[88:91]
s_waitcnt lgkmcnt(7)
v_exp_f32 v160, v160
v_mfma_f32_16x16x32_bf16 v[56:59], a[144:147], v[192:195], v[56:59]
v_exp_f32 v161, v161
v_mfma_f32_16x16x32_bf16 v[60:63], a[148:151], v[192:195], v[60:63]
v_exp_f32 v162, v162
v_cvt_pk_bf16_f32 v211, v166, v167
v_mfma_f32_16x16x32_bf16 v[92:95], a[148:151], v[212:215], v[92:95]
v_exp_f32 v163, v163
v_mfma_f32_16x16x32_bf16 v[124:127], a[148:151], v[232:235], v[124:127]
v_cvt_pk_bf16_f32 v208, v160, v161
v_cvt_pk_bf16_f32 v209, v162, v163
v_mfma_f32_16x16x32_bf16 v[128:131], a[152:155], v[232:235], v[128:131]
v_exp_f32 v168, v168
v_mfma_f32_16x16x32_bf16 v[96:99], a[152:155], v[212:215], v[96:99]
v_exp_f32 v169, v169
v_mfma_f32_16x16x32_bf16 v[64:67], a[152:155], v[192:195], v[64:67]
v_exp_f32 v170, v170
v_mfma_f32_16x16x32_bf16 v[68:71], a[156:159], v[192:195], v[68:71]
v_exp_f32 v171, v171
v_mfma_f32_16x16x32_bf16 v[100:103], a[156:159], v[212:215], v[100:103]
v_exp_f32 v172, v172
v_cvt_pk_bf16_f32 v228, v168, v169
v_mfma_f32_16x16x32_bf16 v[132:135], a[156:159], v[232:235], v[132:135]
v_exp_f32 v173, v173
v_mfma_f32_16x16x32_bf16 v[136:139], a[160:163], v[232:235], v[136:139]
v_exp_f32 v174, v174
v_mfma_f32_16x16x32_bf16 v[104:107], a[160:163], v[212:215], v[104:107]
s_waitcnt lgkmcnt(4)
v_cvt_pk_bf16_f32 v229, v170, v171
v_cvt_pk_bf16_f32 v230, v172, v173
v_mfma_f32_16x16x32_bf16 v[72:75], a[160:163], v[192:195], v[72:75]
v_exp_f32 v175, v175
v_mfma_f32_16x16x32_bf16 v[152:155], a[36:39], a[0:3], v[32:35]
v_cvt_pk_bf16_f32 v231, v174, v175
v_mfma_f32_16x16x32_bf16 v[152:155], a[40:43], a[4:7], v[152:155]
v_mfma_f32_16x16x32_bf16 v[152:155], a[44:47], a[8:11], v[152:155]
s_waitcnt lgkmcnt(0)
v_mfma_f32_16x16x32_bf16 v[152:155], a[48:51], a[12:15], v[152:155]
buffer_load_dwordx4 v4, s[12:15], s24 offen offset:0 nt lds
v_mfma_f32_16x16x32_bf16 v[156:159], a[64:67], a[12:15], v[32:35]
s_add_u32 m0, m0, 8
v_mfma_f32_16x16x32_bf16 v[156:159], a[60:63], a[8:11], v[156:159]
buffer_load_dwordx4 v4, s[12:15], s24 offen offset:1024 nt lds
v_mfma_f32_16x16x32_bf16 v[156:159], a[56:59], a[4:7], v[156:159]
s_xor_b32 s24, s101, 28800
v_mfma_f32_16x16x32_bf16 v[156:159], a[52:55], a[0:3], v[156:159]
s_add_u32 m0, s29, 101376
v_mfma_f32_16x16x32_bf16 v[164:167], a[52:55], a[16:19], v[36:39]
v_mfma_f32_16x16x32_bf16 v[164:167], a[56:59], a[20:23], v[164:167]
v_mfma_f32_16x16x32_bf16 v[164:167], a[60:63], a[24:27], v[164:167]
v_exp_f32 v152, v152
v_exp_f32 v153, v153
v_mfma_f32_16x16x32_bf16 v[164:167], a[64:67], a[28:31], v[164:167]
buffer_load_dwordx4 v4, s[12:15], s24 offen offset:0 nt lds
v_mfma_f32_16x16x32_bf16 v[160:163], a[48:51], a[28:31], v[36:39]
s_add_u32 m0, m0, 8
v_exp_f32 v154, v154
v_mfma_f32_16x16x32_bf16 v[160:163], a[44:47], a[24:27], v[160:163]
buffer_load_dwordx4 v4, s[12:15], s24 offen offset:1024 nt lds
v_mfma_f32_16x16x32_bf16 v[160:163], a[40:43], a[20:23], v[160:163]
v_exp_f32 v155, v155
v_mfma_f32_16x16x32_bf16 v[160:163], a[36:39], a[16:19], v[160:163]
v_exp_f32 v156, v156
v_mfma_f32_16x16x32_bf16 v[168:171], a[36:39], v[236:239], v[40:43]
v_exp_f32 v157, v157
v_mfma_f32_16x16x32_bf16 v[168:171], a[40:43], v[240:243], v[168:171]
v_exp_f32 v158, v158
v_cvt_pk_bf16_f32 v192, v152, v153
v_mfma_f32_16x16x32_bf16 v[168:171], a[44:47], v[244:247], v[168:171]
v_cvt_pk_bf16_f32 v193, v154, v155
v_cvt_pk_bf16_f32 v194, v156, v157
v_mfma_f32_16x16x32_bf16 v[168:171], a[48:51], v[248:251], v[168:171]
s_waitcnt vmcnt(10)
s_barrier
v_mfma_f32_16x16x32_bf16 v[172:175], a[64:67], v[248:251], v[40:43]
ds_read_b64_tr_b16 a[164:165], v10 offset:0
ds_read_b64_tr_b16 a[166:167], v10 offset:512
v_mfma_f32_16x16x32_bf16 v[172:175], a[60:63], v[244:247], v[172:175]
ds_read_b64_tr_b16 a[168:169], v10 offset:8
ds_read_b64_tr_b16 a[170:171], v10 offset:520
v_mfma_f32_16x16x32_bf16 v[172:175], a[56:59], v[240:243], v[172:175]
v_exp_f32 v159, v159
v_mfma_f32_16x16x32_bf16 v[172:175], a[52:55], v[236:239], v[172:175]
ds_read_b64_tr_b16 a[172:173], v10 offset:16
ds_read_b64_tr_b16 a[174:175], v10 offset:528
v_mfma_f32_16x16x32_bf16 v[140:143], a[32:35], v[188:191], v[140:143]
ds_read_b64_tr_b16 a[176:177], v10 offset:24
v_cvt_pk_bf16_f32 v195, v158, v159
v_mfma_f32_16x16x32_bf16 v[144:147], a[32:35], v[208:211], v[144:147]
s_waitcnt lgkmcnt(5)
v_exp_f32 v164, v164
v_mfma_f32_16x16x32_bf16 v[148:151], a[32:35], v[228:231], v[148:151]
ds_read_b64_tr_b16 a[178:179], v10 offset:536
ds_read_b64_tr_b16 a[180:181], v10 offset:128
v_mfma_f32_16x16x32_bf16 v[44:47], a[164:167], v[176:179], v[44:47]
v_exp_f32 v165, v165
v_mfma_f32_16x16x32_bf16 v[76:79], a[164:167], v[196:199], v[76:79]
s_waitcnt lgkmcnt(5)
ds_read_b64_tr_b16 a[182:183], v10 offset:640
ds_read_b64_tr_b16 a[184:185], v10 offset:136
v_mfma_f32_16x16x32_bf16 v[108:111], a[164:167], v[216:219], v[108:111]
ds_read_b64_tr_b16 a[186:187], v10 offset:648
ds_read_b64_tr_b16 a[188:189], v10 offset:144
v_mfma_f32_16x16x32_bf16 v[112:115], a[168:171], v[216:219], v[112:115]
ds_read_b64_tr_b16 a[190:191], v10 offset:656
v_cvt_pk_bf16_f32 v214, v164, v165
v_mfma_f32_16x16x32_bf16 v[80:83], a[168:171], v[196:199], v[80:83]
s_waitcnt lgkmcnt(6)
v_exp_f32 v166, v166
v_mfma_f32_16x16x32_bf16 v[48:51], a[168:171], v[176:179], v[48:51]
ds_read_b64_tr_b16 a[192:193], v10 offset:152
ds_read_b64_tr_b16 a[194:195], v10 offset:664
v_mfma_f32_16x16x32_bf16 v[52:55], a[172:175], v[176:179], v[52:55]
v_exp_f32 v167, v167
v_mfma_f32_16x16x32_bf16 v[84:87], a[172:175], v[196:199], v[84:87]
ds_read_b128 a[68:71], v6 offset:50688
v_exp_f32 v160, v160
v_mfma_f32_16x16x32_bf16 v[116:119], a[172:175], v[216:219], v[116:119]
ds_read_b128 a[72:75], v6 offset:50752
v_cvt_pk_bf16_f32 v215, v166, v167
v_mfma_f32_16x16x32_bf16 v[120:123], a[176:179], v[216:219], v[120:123]
v_exp_f32 v161, v161
v_mfma_f32_16x16x32_bf16 v[88:91], a[176:179], v[196:199], v[88:91]
s_waitcnt lgkmcnt(2)
ds_read_b128 a[76:79], v6 offset:50816
v_cvt_pk_bf16_f32 v212, v160, v161
v_mfma_f32_16x16x32_bf16 v[56:59], a[176:179], v[176:179], v[56:59]
v_exp_f32 v162, v162
v_mfma_f32_16x16x32_bf16 v[60:63], a[180:183], v[176:179], v[60:63]
v_exp_f32 v163, v163
v_mfma_f32_16x16x32_bf16 v[92:95], a[180:183], v[196:199], v[92:95]
ds_read_b128 a[80:83], v6 offset:50880
v_cvt_pk_bf16_f32 v213, v162, v163
v_mfma_f32_16x16x32_bf16 v[124:127], a[180:183], v[216:219], v[124:127]
v_exp_f32 v168, v168
v_mfma_f32_16x16x32_bf16 v[128:131], a[184:187], v[216:219], v[128:131]
v_exp_f32 v169, v169
v_mfma_f32_16x16x32_bf16 v[96:99], a[184:187], v[196:199], v[96:99]
ds_read_b128 a[96:99], v6 offset:51392
v_cvt_pk_bf16_f32 v232, v168, v169
v_mfma_f32_16x16x32_bf16 v[64:67], a[184:187], v[176:179], v[64:67]
v_exp_f32 v170, v170
v_mfma_f32_16x16x32_bf16 v[68:71], a[188:191], v[176:179], v[68:71]
v_exp_f32 v171, v171
v_mfma_f32_16x16x32_bf16 v[100:103], a[188:191], v[196:199], v[100:103]
ds_read_b128 a[92:95], v6 offset:51328
v_cvt_pk_bf16_f32 v233, v170, v171
v_mfma_f32_16x16x32_bf16 v[132:135], a[188:191], v[216:219], v[132:135]
v_exp_f32 v172, v172
v_mfma_f32_16x16x32_bf16 v[136:139], a[192:195], v[216:219], v[136:139]
ds_read_b128 a[88:91], v6 offset:51264
v_mfma_f32_16x16x32_bf16 v[104:107], a[192:195], v[196:199], v[104:107]
s_waitcnt lgkmcnt(3)
ds_read_b128 a[84:87], v6 offset:51200
v_mfma_f32_16x16x32_bf16 v[72:75], a[192:195], v[176:179], v[72:75]
v_exp_f32 v173, v173
v_mfma_f32_16x16x32_bf16 v[152:155], a[68:71], a[0:3], v[32:35]
v_exp_f32 v174, v174
v_mfma_f32_16x16x32_bf16 v[152:155], a[72:75], a[4:7], v[152:155]
v_exp_f32 v175, v175
v_mfma_f32_16x16x32_bf16 v[152:155], a[76:79], a[8:11], v[152:155]
s_waitcnt lgkmcnt(0)
v_cvt_pk_bf16_f32 v234, v172, v173
v_cvt_pk_bf16_f32 v235, v174, v175
v_mfma_f32_16x16x32_bf16 v[152:155], a[80:83], a[12:15], v[152:155]
v_mfma_f32_16x16x32_bf16 v[156:159], a[96:99], a[12:15], v[32:35]
v_mfma_f32_16x16x32_bf16 v[156:159], a[92:95], a[8:11], v[156:159]
L_touch3_o1:
s_cbranch_scc1 L_touch_ret
v_mfma_f32_16x16x32_bf16 v[156:159], a[88:91], a[4:7], v[156:159]
v_mfma_f32_16x16x32_bf16 v[156:159], a[84:87], a[0:3], v[156:159]
s_waitcnt vmcnt(6)
s_barrier
v_mfma_f32_16x16x32_bf16 v[164:167], a[84:87], a[16:19], v[36:39]
ds_read_b64_tr_b16 a[196:197], v10 offset:8448
ds_read_b64_tr_b16 a[198:199], v10 offset:8960
v_mfma_f32_16x16x32_bf16 v[164:167], a[88:91], a[20:23], v[164:167]
ds_read_b64_tr_b16 a[200:201], v10 offset:8456
ds_read_b64_tr_b16 a[202:203], v10 offset:8968
v_mfma_f32_16x16x32_bf16 v[164:167], a[92:95], a[24:27], v[164:167]
v_exp_f32 v152, v152
v_mfma_f32_16x16x32_bf16 v[164:167], a[96:99], a[28:31], v[164:167]
ds_read_b64_tr_b16 a[204:205], v10 offset:8464
ds_read_b64_tr_b16 a[206:207], v10 offset:8976
v_mfma_f32_16x16x32_bf16 v[160:163], a[80:83], a[28:31], v[36:39]
v_exp_f32 v153, v153
v_mfma_f32_16x16x32_bf16 v[160:163], a[76:79], a[24:27], v[160:163]
ds_read_b64_tr_b16 a[208:209], v10 offset:8472
ds_read_b64_tr_b16 a[210:211], v10 offset:8984
v_mfma_f32_16x16x32_bf16 v[160:163], a[72:75], a[20:23], v[160:163]
ds_read_b64_tr_b16 a[212:213], v10 offset:8576
v_cvt_pk_bf16_f32 v176, v152, v153
v_mfma_f32_16x16x32_bf16 v[160:163], a[68:71], a[16:19], v[160:163]
v_exp_f32 v154, v154
v_mfma_f32_16x16x32_bf16 v[168:171], a[68:71], v[236:239], v[40:43]
ds_read_b64_tr_b16 a[214:215], v10 offset:9088
ds_read_b64_tr_b16 a[216:217], v10 offset:8584
v_mfma_f32_16x16x32_bf16 v[168:171], a[72:75], v[240:243], v[168:171]
ds_read_b64_tr_b16 a[218:219], v10 offset:9096
ds_read_b64_tr_b16 a[220:221], v10 offset:8592
v_mfma_f32_16x16x32_bf16 v[168:171], a[76:79], v[244:247], v[168:171]
v_exp_f32 v155, v155
v_mfma_f32_16x16x32_bf16 v[168:171], a[80:83], v[248:251], v[168:171]
ds_read_b64_tr_b16 a[222:223], v10 offset:9104
ds_read_b64_tr_b16 a[224:225], v10 offset:8600
v_mfma_f32_16x16x32_bf16 v[172:175], a[96:99], v[248:251], v[40:43]
ds_read_b64_tr_b16 a[226:227], v10 offset:9112
v_cvt_pk_bf16_f32 v177, v154, v155
v_mfma_f32_16x16x32_bf16 v[172:175], a[92:95], v[244:247], v[172:175]
v_exp_f32 v156, v156
v_mfma_f32_16x16x32_bf16 v[172:175], a[88:91], v[240:243], v[172:175]
ds_read_b64_tr_b16 a[100:101], v12 offset:0
ds_read_b64_tr_b16 a[102:103], v12 offset:256
v_mfma_f32_16x16x32_bf16 v[172:175], a[84:87], v[236:239], v[172:175]
v_exp_f32 v157, v157
v_mfma_f32_16x16x32_bf16 v[140:143], a[32:35], v[192:195], v[140:143]
ds_read_b64_tr_b16 a[104:105], v12 offset:8
ds_read_b64_tr_b16 a[106:107], v12 offset:264
v_mfma_f32_16x16x32_bf16 v[144:147], a[32:35], v[212:215], v[144:147]
s_waitcnt lgkmcnt(15)
ds_read_b64_tr_b16 a[108:109], v12 offset:16
v_cvt_pk_bf16_f32 v178, v156, v157
v_mfma_f32_16x16x32_bf16 v[148:151], a[32:35], v[232:235], v[148:151]
ds_read_b64_tr_b16 a[110:111], v12 offset:272
ds_read_b64_tr_b16 a[112:113], v12 offset:24
v_mfma_f32_16x16x32_bf16 v[44:47], a[196:199], v[180:183], v[44:47]
v_exp_f32 v158, v158
v_mfma_f32_16x16x32_bf16 v[76:79], a[196:199], v[200:203], v[76:79]
ds_read_b64_tr_b16 a[114:115], v12 offset:280
ds_read_b64_tr_b16 a[116:117], v12 offset:512
v_mfma_f32_16x16x32_bf16 v[108:111], a[196:199], v[220:223], v[108:111]
v_exp_f32 v159, v159
v_mfma_f32_16x16x32_bf16 v[112:115], a[200:203], v[220:223], v[112:115]
ds_read_b64_tr_b16 a[118:119], v12 offset:768
v_cvt_pk_bf16_f32 v179, v158, v159
v_mfma_f32_16x16x32_bf16 v[80:83], a[200:203], v[200:203], v[80:83]
s_waitcnt lgkmcnt(15)
ds_read_b64_tr_b16 a[120:121], v12 offset:520
ds_read_b64_tr_b16 a[122:123], v12 offset:776
v_mfma_f32_16x16x32_bf16 v[48:51], a[200:203], v[180:183], v[48:51]
v_exp_f32 v164, v164
v_mfma_f32_16x16x32_bf16 v[52:55], a[204:207], v[180:183], v[52:55]
ds_read_b64_tr_b16 a[124:125], v12 offset:528
ds_read_b64_tr_b16 a[126:127], v12 offset:784
v_mfma_f32_16x16x32_bf16 v[84:87], a[204:207], v[200:203], v[84:87]
v_exp_f32 v165, v165
v_mfma_f32_16x16x32_bf16 v[116:119], a[204:207], v[220:223], v[116:119]
ds_read_b64_tr_b16 a[128:129], v12 offset:536
ds_read_b64_tr_b16 a[130:131], v12 offset:792
v_mfma_f32_16x16x32_bf16 v[120:123], a[208:211], v[220:223], v[120:123]
v_exp_f32 v166, v166
v_mfma_f32_16x16x32_bf16 v[88:91], a[208:211], v[200:203], v[88:91]
s_waitcnt lgkmcnt(15)
v_exp_f32 v167, v167
v_mfma_f32_16x16x32_bf16 v[56:59], a[208:211], v[180:183], v[56:59]
v_exp_f32 v160, v160
v_mfma_f32_16x16x32_bf16 v[60:63], a[212:215], v[180:183], v[60:63]
v_exp_f32 v161, v161
v_mfma_f32_16x16x32_bf16 v[92:95], a[212:215], v[200:203], v[92:95]
s_waitcnt vmcnt(4)
s_barrier
v_mfma_f32_16x16x32_bf16 v[124:127], a[212:215], v[220:223], v[124:127]
ds_read_b64_tr_b16 a[132:133], v12 offset:8448
ds_read_b64_tr_b16 a[134:135], v12 offset:8704
v_mfma_f32_16x16x32_bf16 v[128:131], a[216:219], v[220:223], v[128:131]
ds_read_b64_tr_b16 a[136:137], v12 offset:8456
ds_read_b64_tr_b16 a[138:139], v12 offset:8712
v_mfma_f32_16x16x32_bf16 v[96:99], a[216:219], v[200:203], v[96:99]
ds_read_b64_tr_b16 a[140:141], v12 offset:8464
v_cvt_pk_bf16_f32 v198, v164, v165
v_mfma_f32_16x16x32_bf16 v[64:67], a[216:219], v[180:183], v[64:67]
ds_read_b64_tr_b16 a[142:143], v12 offset:8720
v_cvt_pk_bf16_f32 v199, v166, v167
v_mfma_f32_16x16x32_bf16 v[68:71], a[220:223], v[180:183], v[68:71]
ds_read_b64_tr_b16 a[144:145], v12 offset:8472
v_cvt_pk_bf16_f32 v196, v160, v161
v_mfma_f32_16x16x32_bf16 v[100:103], a[220:223], v[200:203], v[100:103]
v_exp_f32 v162, v162
v_mfma_f32_16x16x32_bf16 v[132:135], a[220:223], v[220:223], v[132:135]
ds_read_b64_tr_b16 a[146:147], v12 offset:8728
ds_read_b64_tr_b16 a[148:149], v12 offset:8960
v_mfma_f32_16x16x32_bf16 v[136:139], a[224:227], v[220:223], v[136:139]
v_exp_f32 v163, v163
v_mfma_f32_16x16x32_bf16 v[104:107], a[224:227], v[200:203], v[104:107]
ds_read_b64_tr_b16 a[150:151], v12 offset:9216
ds_read_b64_tr_b16 a[152:153], v12 offset:8968
v_mfma_f32_16x16x32_bf16 v[72:75], a[224:227], v[180:183], v[72:75]
s_waitcnt lgkmcnt(15)
ds_read_b64_tr_b16 a[154:155], v12 offset:9224
ds_read_b64_tr_b16 a[156:157], v12 offset:8976
v_mfma_f32_16x16x32_bf16 v[140:143], a[32:35], v[176:179], v[140:143]
s_mov_b32 vcc_lo, 0xaaaaaaaa
ds_read_b64_tr_b16 a[158:159], v12 offset:9232
v_cvt_pk_bf16_f32 v197, v162, v163
v_mfma_f32_16x16x32_bf16 v[44:47], a[100:103], v[184:187], v[44:47]
s_mov_b32 vcc_hi, 0xaaaaaaaa
v_exp_f32 v168, v168
v_mfma_f32_16x16x32_bf16 v[48:51], a[104:107], v[184:187], v[48:51]
ds_read_b64_tr_b16 a[160:161], v12 offset:8984
ds_read_b64_tr_b16 a[162:163], v12 offset:9240
v_mfma_f32_16x16x32_bf16 v[52:55], a[108:111], v[184:187], v[52:55]
s_waitcnt lgkmcnt(15)
v_exp_f32 v169, v169
v_mfma_f32_16x16x32_bf16 v[56:59], a[112:115], v[184:187], v[56:59]
v_rcp_f32 v32, v140
v_mfma_f32_16x16x32_bf16 v[44:47], a[116:119], v[188:191], v[44:47]
v_cvt_pk_bf16_f32 v216, v168, v169
v_mov_b32 v33, v32
v_mfma_f32_16x16x32_bf16 v[48:51], a[120:123], v[188:191], v[48:51]
v_exp_f32 v170, v170
v_mfma_f32_16x16x32_bf16 v[52:55], a[124:127], v[188:191], v[52:55]
s_waitcnt lgkmcnt(8)
v_exp_f32 v171, v171
v_mfma_f32_16x16x32_bf16 v[56:59], a[128:131], v[188:191], v[56:59]
s_waitcnt lgkmcnt(0)
v_exp_f32 v172, v172
v_mfma_f32_16x16x32_bf16 v[44:47], a[132:135], v[192:195], v[44:47]
v_exp_f32 v173, v173
v_mfma_f32_16x16x32_bf16 v[44:47], a[148:151], v[176:179], v[44:47]
v_exp_f32 v174, v174
v_mfma_f32_16x16x32_bf16 v[48:51], a[152:155], v[176:179], v[48:51]
v_cvt_pk_bf16_f32 v217, v170, v171
v_cvt_pk_bf16_f32 v218, v172, v173
v_mfma_f32_16x16x32_bf16 v[48:51], a[136:139], v[192:195], v[48:51]
v_exp_f32 v175, v175
v_mfma_f32_16x16x32_bf16 v[52:55], a[140:143], v[192:195], v[52:55]
v_cvt_pk_bf16_f32 v219, v174, v175
v_mfma_f32_16x16x32_bf16 v[52:55], a[156:159], v[176:179], v[52:55]
v_mul_f32 v44, v44, v32
v_mul_f32 v45, v45, v32
v_mfma_f32_16x16x32_bf16 v[56:59], a[160:163], v[176:179], v[56:59]
v_mul_f32 v46, v46, v32
v_mul_f32 v47, v47, v32
v_mfma_f32_16x16x32_bf16 v[56:59], a[144:147], v[192:195], v[56:59]
v_cvt_pk_bf16_f32 v44, v44, v45
v_cvt_pk_bf16_f32 v45, v46, v47
v_mfma_f32_16x16x32_bf16 v[144:147], a[32:35], v[196:199], v[144:147]
v_mul_f32 v48, v48, v32
v_mul_f32 v49, v49, v32
v_mfma_f32_16x16x32_bf16 v[76:79], a[100:103], v[204:207], v[76:79]
v_mul_f32 v50, v50, v32
v_mul_f32 v51, v51, v32
v_mfma_f32_16x16x32_bf16 v[76:79], a[116:119], v[208:211], v[76:79]
v_cvt_pk_bf16_f32 v46, v48, v49
v_cvt_pk_bf16_f32 v47, v50, v51
v_mfma_f32_16x16x32_bf16 v[76:79], a[132:135], v[212:215], v[76:79]
v_mul_f32 v52, v52, v32
v_mul_f32 v53, v53, v32
v_mfma_f32_16x16x32_bf16 v[76:79], a[148:151], v[196:199], v[76:79]
v_rcp_f32 v36, v144
v_mfma_f32_16x16x32_bf16 v[80:83], a[152:155], v[196:199], v[80:83]
v_mov_b32 v37, v36
v_mul_f32 v54, v54, v32
v_mfma_f32_16x16x32_bf16 v[80:83], a[136:139], v[212:215], v[80:83]
v_mul_f32 v55, v55, v32
v_cvt_pk_bf16_f32 v52, v52, v53
v_mfma_f32_16x16x32_bf16 v[80:83], a[120:123], v[208:211], v[80:83]
v_cvt_pk_bf16_f32 v53, v54, v55
v_mul_f32 v56, v56, v32
v_mfma_f32_16x16x32_bf16 v[80:83], a[104:107], v[204:207], v[80:83]
v_mul_f32 v57, v57, v32
v_mul_f32 v58, v58, v32
v_mfma_f32_16x16x32_bf16 v[84:87], a[108:111], v[204:207], v[84:87]
v_mul_f32 v59, v59, v32
v_cvt_pk_bf16_f32 v54, v56, v57
v_mfma_f32_16x16x32_bf16 v[84:87], a[124:127], v[208:211], v[84:87]
v_cvt_pk_bf16_f32 v55, v58, v59
v_cndmask_b32_dpp v56, v44, v52, vcc quad_perm:[1,0,3,2] row_mask:0xf bank_mask:0xf
v_mfma_f32_16x16x32_bf16 v[84:87], a[140:143], v[212:215], v[84:87]
v_cndmask_b32_dpp v57, v45, v53, vcc quad_perm:[1,0,3,2] row_mask:0xf bank_mask:0xf
v_cndmask_b32_dpp v58, v46, v54, vcc quad_perm:[1,0,3,2] row_mask:0xf bank_mask:0xf
v_mfma_f32_16x16x32_bf16 v[84:87], a[156:159], v[196:199], v[84:87]
v_cndmask_b32_dpp v59, v47, v55, vcc quad_perm:[1,0,3,2] row_mask:0xf bank_mask:0xf
s_brev_b64 vcc, vcc
v_cndmask_b32_dpp v48, v52, v44, vcc quad_perm:[1,0,3,2] row_mask:0xf bank_mask:0xf
v_mfma_f32_16x16x32_bf16 v[88:91], a[160:163], v[196:199], v[88:91]
v_cndmask_b32_dpp v49, v53, v45, vcc quad_perm:[1,0,3,2] row_mask:0xf bank_mask:0xf
v_cndmask_b32_dpp v50, v54, v46, vcc quad_perm:[1,0,3,2] row_mask:0xf bank_mask:0xf
v_mfma_f32_16x16x32_bf16 v[88:91], a[144:147], v[212:215], v[88:91]
v_cndmask_b32_dpp v51, v55, v47, vcc quad_perm:[1,0,3,2] row_mask:0xf bank_mask:0xf
v_mul_f32 v76, v76, v36
v_mfma_f32_16x16x32_bf16 v[88:91], a[128:131], v[208:211], v[88:91]
v_mul_f32 v77, v77, v36
v_mul_f32 v78, v78, v36
v_mfma_f32_16x16x32_bf16 v[88:91], a[112:115], v[204:207], v[88:91]
v_mul_f32 v79, v79, v36
v_cvt_pk_bf16_f32 v76, v76, v77
v_mfma_f32_16x16x32_bf16 v[148:151], a[32:35], v[216:219], v[148:151]
v_cvt_pk_bf16_f32 v77, v78, v79
v_mul_f32 v80, v80, v36
v_mfma_f32_16x16x32_bf16 v[108:111], a[100:103], v[224:227], v[108:111]
s_waitcnt vmcnt(0)
s_barrier
v_mfma_f32_16x16x32_bf16 v[108:111], a[116:119], v[228:231], v[108:111]
ds_read_b64_tr_b16 a[164:165], v12 offset:16896
ds_read_b64_tr_b16 a[166:167], v12 offset:17152
ds_read_b64_tr_b16 a[168:169], v12 offset:16904
v_mul_f32 v81, v81, v36
v_mfma_f32_16x16x32_bf16 v[108:111], a[132:135], v[232:235], v[108:111]
ds_read_b64_tr_b16 a[170:171], v12 offset:17160
v_mul_f32 v82, v82, v36
v_mul_f32 v83, v83, v36
v_mfma_f32_16x16x32_bf16 v[108:111], a[148:151], v[216:219], v[108:111]
ds_read_b64_tr_b16 a[172:173], v12 offset:16912
v_rcp_f32 v40, v148
v_mfma_f32_16x16x32_bf16 v[112:115], a[152:155], v[216:219], v[112:115]
ds_read_b64_tr_b16 a[174:175], v12 offset:17168
ds_read_b64_tr_b16 a[176:177], v12 offset:16920
v_mov_b32 v41, v40
v_mfma_f32_16x16x32_bf16 v[112:115], a[136:139], v[232:235], v[112:115]
ds_read_b64_tr_b16 a[178:179], v12 offset:17176
buffer_store_dwordx4 v[56:59], v5, s[16:19], s93 offen offset:256 nt
v_mfma_f32_16x16x32_bf16 v[112:115], a[120:123], v[228:231], v[112:115]
ds_read_b64_tr_b16 a[180:181], v12 offset:17408
ds_read_b64_tr_b16 a[182:183], v12 offset:17664
v_cvt_pk_bf16_f32 v78, v80, v81
v_mfma_f32_16x16x32_bf16 v[112:115], a[104:107], v[224:227], v[112:115]
ds_read_b64_tr_b16 a[184:185], v12 offset:17416
v_cvt_pk_bf16_f32 v79, v82, v83
v_mul_f32 v84, v84, v36
v_mfma_f32_16x16x32_bf16 v[116:119], a[108:111], v[224:227], v[116:119]
ds_read_b64_tr_b16 a[186:187], v12 offset:17672
ds_read_b64_tr_b16 a[188:189], v12 offset:17424
v_mul_f32 v85, v85, v36
v_mfma_f32_16x16x32_bf16 v[116:119], a[124:127], v[228:231], v[116:119]
ds_read_b64_tr_b16 a[190:191], v12 offset:17680
v_mul_f32 v86, v86, v36
v_mul_f32 v87, v87, v36
v_mfma_f32_16x16x32_bf16 v[116:119], a[140:143], v[232:235], v[116:119]
ds_read_b64_tr_b16 a[192:193], v12 offset:17432
buffer_store_dwordx4 v[48:51], v5, s[16:19], s93 offen offset:0 nt
v_cvt_pk_bf16_f32 v84, v84, v85
v_mfma_f32_16x16x32_bf16 v[116:119], a[156:159], v[216:219], v[116:119]
ds_read_b64_tr_b16 a[194:195], v12 offset:17688
ds_read_b64_tr_b16 a[196:197], v12 offset:25344
v_cvt_pk_bf16_f32 v85, v86, v87
v_mfma_f32_16x16x32_bf16 v[120:123], a[160:163], v[216:219], v[120:123]
ds_read_b64_tr_b16 a[198:199], v12 offset:25600
v_mul_f32 v88, v88, v36
v_mul_f32 v89, v89, v36
v_mfma_f32_16x16x32_bf16 v[120:123], a[144:147], v[232:235], v[120:123]
ds_read_b64_tr_b16 a[200:201], v12 offset:25352
ds_read_b64_tr_b16 a[202:203], v12 offset:25608
v_mul_f32 v90, v90, v36
v_mfma_f32_16x16x32_bf16 v[120:123], a[128:131], v[228:231], v[120:123]
s_waitcnt lgkmcnt(12)
ds_read_b64_tr_b16 a[204:205], v12 offset:25360
v_mul_f32 v91, v91, v36
v_cvt_pk_bf16_f32 v86, v88, v89
v_mfma_f32_16x16x32_bf16 v[120:123], a[112:115], v[224:227], v[120:123]
ds_read_b64_tr_b16 a[206:207], v12 offset:25616
ds_read_b64_tr_b16 a[208:209], v12 offset:25368
v_cvt_pk_bf16_f32 v87, v90, v91
v_mfma_f32_16x16x32_bf16 v[60:63], a[164:167], v[184:187], v[60:63]
ds_read_b64_tr_b16 a[210:211], v12 offset:25624
ds_read_b64_tr_b16 a[212:213], v12 offset:25856
ds_read_b64_tr_b16 a[214:215], v12 offset:26112
v_mfma_f32_16x16x32_bf16 v[64:67], a[168:171], v[184:187], v[64:67]
ds_read_b64_tr_b16 a[216:217], v12 offset:25864
ds_read_b64_tr_b16 a[218:219], v12 offset:26120
v_cndmask_b32_dpp v80, v84, v76, vcc quad_perm:[1,0,3,2] row_mask:0xf bank_mask:0xf
v_mfma_f32_16x16x32_bf16 v[68:71], a[172:175], v[184:187], v[68:71]
s_waitcnt lgkmcnt(12)
ds_read_b64_tr_b16 a[220:221], v12 offset:25872
ds_read_b64_tr_b16 a[222:223], v12 offset:26128
v_cndmask_b32_dpp v81, v85, v77, vcc quad_perm:[1,0,3,2] row_mask:0xf bank_mask:0xf
v_mfma_f32_16x16x32_bf16 v[72:75], a[176:179], v[184:187], v[72:75]
ds_read_b64_tr_b16 a[224:225], v12 offset:25880
ds_read_b64_tr_b16 a[226:227], v12 offset:26136
v_cndmask_b32_dpp v82, v86, v78, vcc quad_perm:[1,0,3,2] row_mask:0xf bank_mask:0xf
v_mfma_f32_16x16x32_bf16 v[60:63], a[180:183], v[188:191], v[60:63]
v_cndmask_b32_dpp v83, v87, v79, vcc quad_perm:[1,0,3,2] row_mask:0xf bank_mask:0xf
s_brev_b64 vcc, vcc
v_cndmask_b32_dpp v88, v76, v84, vcc quad_perm:[1,0,3,2] row_mask:0xf bank_mask:0xf
v_cndmask_b32_dpp v89, v77, v85, vcc quad_perm:[1,0,3,2] row_mask:0xf bank_mask:0xf
v_mfma_f32_16x16x32_bf16 v[64:67], a[184:187], v[188:191], v[64:67]
buffer_store_dwordx4 v[80:83], v5, s[16:19], s99 offen offset:0 nt
v_cndmask_b32_dpp v90, v78, v86, vcc quad_perm:[1,0,3,2] row_mask:0xf bank_mask:0xf
v_cndmask_b32_dpp v91, v79, v87, vcc quad_perm:[1,0,3,2] row_mask:0xf bank_mask:0xf
v_mfma_f32_16x16x32_bf16 v[68:71], a[188:191], v[188:191], v[68:71]
s_waitcnt lgkmcnt(8)
v_mul_f32 v108, v108, v40
v_mul_f32 v109, v109, v40
v_mul_f32 v110, v110, v40
v_mfma_f32_16x16x32_bf16 v[72:75], a[192:195], v[188:191], v[72:75]
s_waitcnt lgkmcnt(0)
v_mul_f32 v111, v111, v40
v_cvt_pk_bf16_f32 v108, v108, v109
v_cvt_pk_bf16_f32 v109, v110, v111
v_mfma_f32_16x16x32_bf16 v[60:63], a[196:199], v[192:195], v[60:63]
v_mul_f32 v112, v112, v40
v_mul_f32 v113, v113, v40
v_mul_f32 v114, v114, v40
v_mfma_f32_16x16x32_bf16 v[60:63], a[212:215], v[176:179], v[60:63]
v_mul_f32 v115, v115, v40
v_cvt_pk_bf16_f32 v110, v112, v113
v_cvt_pk_bf16_f32 v111, v114, v115
v_mfma_f32_16x16x32_bf16 v[64:67], a[216:219], v[176:179], v[64:67]
buffer_store_dwordx4 v[88:91], v5, s[16:19], s99 offen offset:256 nt
v_mul_f32 v116, v116, v40
v_mfma_f32_16x16x32_bf16 v[64:67], a[200:203], v[192:195], v[64:67]
v_mul_f32 v117, v117, v40
v_mul_f32 v118, v118, v40
v_mul_f32 v119, v119, v40
v_mfma_f32_16x16x32_bf16 v[68:71], a[204:207], v[192:195], v[68:71]
v_cvt_pk_bf16_f32 v116, v116, v117
v_cvt_pk_bf16_f32 v117, v118, v119
v_mul_f32 v120, v120, v40
v_mfma_f32_16x16x32_bf16 v[68:71], a[220:223], v[176:179], v[68:71]
v_mul_f32 v121, v121, v40
v_mul_f32 v122, v122, v40
v_mul_f32 v123, v123, v40
v_mfma_f32_16x16x32_bf16 v[72:75], a[224:227], v[176:179], v[72:75]
v_cvt_pk_bf16_f32 v118, v120, v121
v_cvt_pk_bf16_f32 v119, v122, v123
v_cndmask_b32_dpp v120, v108, v116, vcc quad_perm:[1,0,3,2] row_mask:0xf bank_mask:0xf
v_mfma_f32_16x16x32_bf16 v[72:75], a[208:211], v[192:195], v[72:75]
v_cndmask_b32_dpp v121, v109, v117, vcc quad_perm:[1,0,3,2] row_mask:0xf bank_mask:0xf
v_cndmask_b32_dpp v122, v110, v118, vcc quad_perm:[1,0,3,2] row_mask:0xf bank_mask:0xf
v_cndmask_b32_dpp v123, v111, v119, vcc quad_perm:[1,0,3,2] row_mask:0xf bank_mask:0xf
s_brev_b64 vcc, vcc
v_cndmask_b32_dpp v112, v116, v108, vcc quad_perm:[1,0,3,2] row_mask:0xf bank_mask:0xf
v_mfma_f32_16x16x32_bf16 v[92:95], a[164:167], v[204:207], v[92:95]
buffer_store_dwordx4 v[120:123], v5, s[16:19], s100 offen offset:256 nt
v_cndmask_b32_dpp v113, v117, v109, vcc quad_perm:[1,0,3,2] row_mask:0xf bank_mask:0xf
v_mfma_f32_16x16x32_bf16 v[92:95], a[180:183], v[208:211], v[92:95]
v_cndmask_b32_dpp v114, v118, v110, vcc quad_perm:[1,0,3,2] row_mask:0xf bank_mask:0xf
v_cndmask_b32_dpp v115, v119, v111, vcc quad_perm:[1,0,3,2] row_mask:0xf bank_mask:0xf
v_mul_f32 v60, v60, v32
v_mfma_f32_16x16x32_bf16 v[92:95], a[196:199], v[212:215], v[92:95]
v_mul_f32 v61, v61, v32
v_mul_f32 v62, v62, v32
v_mul_f32 v63, v63, v32
v_mfma_f32_16x16x32_bf16 v[92:95], a[212:215], v[196:199], v[92:95]
v_cvt_pk_bf16_f32 v60, v60, v61
v_cvt_pk_bf16_f32 v61, v62, v63
v_mul_f32 v64, v64, v32
v_mfma_f32_16x16x32_bf16 v[96:99], a[216:219], v[196:199], v[96:99]
v_mul_f32 v65, v65, v32
v_mul_f32 v66, v66, v32
v_mul_f32 v67, v67, v32
v_mfma_f32_16x16x32_bf16 v[96:99], a[200:203], v[212:215], v[96:99]
buffer_store_dwordx4 v[112:115], v5, s[16:19], s100 offen offset:0 nt
v_cvt_pk_bf16_f32 v62, v64, v65
v_mfma_f32_16x16x32_bf16 v[96:99], a[184:187], v[208:211], v[96:99]
v_cvt_pk_bf16_f32 v63, v66, v67
v_mul_f32 v68, v68, v32
v_mul_f32 v69, v69, v32
v_mfma_f32_16x16x32_bf16 v[96:99], a[168:171], v[204:207], v[96:99]
v_mul_f32 v70, v70, v32
v_mul_f32 v71, v71, v32
v_cvt_pk_bf16_f32 v68, v68, v69
v_mfma_f32_16x16x32_bf16 v[100:103], a[172:175], v[204:207], v[100:103]
v_cvt_pk_bf16_f32 v69, v70, v71
v_mul_f32 v72, v72, v32
v_mul_f32 v73, v73, v32
v_mfma_f32_16x16x32_bf16 v[100:103], a[188:191], v[208:211], v[100:103]
v_mul_f32 v74, v74, v32
v_mul_f32 v75, v75, v32
v_cvt_pk_bf16_f32 v70, v72, v73
v_mfma_f32_16x16x32_bf16 v[100:103], a[204:207], v[212:215], v[100:103]
v_cvt_pk_bf16_f32 v71, v74, v75
v_cndmask_b32_dpp v64, v68, v60, vcc quad_perm:[1,0,3,2] row_mask:0xf bank_mask:0xf
v_cndmask_b32_dpp v65, v69, v61, vcc quad_perm:[1,0,3,2] row_mask:0xf bank_mask:0xf
v_cndmask_b32_dpp v66, v70, v62, vcc quad_perm:[1,0,3,2] row_mask:0xf bank_mask:0xf
v_mfma_f32_16x16x32_bf16 v[100:103], a[220:223], v[196:199], v[100:103]
v_cndmask_b32_dpp v67, v71, v63, vcc quad_perm:[1,0,3,2] row_mask:0xf bank_mask:0xf
s_brev_b64 vcc, vcc
v_cndmask_b32_dpp v72, v60, v68, vcc quad_perm:[1,0,3,2] row_mask:0xf bank_mask:0xf
v_cndmask_b32_dpp v73, v61, v69, vcc quad_perm:[1,0,3,2] row_mask:0xf bank_mask:0xf
v_mfma_f32_16x16x32_bf16 v[104:107], a[224:227], v[196:199], v[104:107]
buffer_store_dwordx4 v[64:67], v5, s[16:19], s93 offen offset:128 nt
v_cndmask_b32_dpp v74, v62, v70, vcc quad_perm:[1,0,3,2] row_mask:0xf bank_mask:0xf
v_mfma_f32_16x16x32_bf16 v[104:107], a[208:211], v[212:215], v[104:107]
v_cndmask_b32_dpp v75, v63, v71, vcc quad_perm:[1,0,3,2] row_mask:0xf bank_mask:0xf
v_mul_f32 v92, v92, v36
v_mul_f32 v93, v93, v36
v_mfma_f32_16x16x32_bf16 v[104:107], a[192:195], v[208:211], v[104:107]
v_mul_f32 v94, v94, v36
v_mul_f32 v95, v95, v36
v_cvt_pk_bf16_f32 v92, v92, v93
v_mfma_f32_16x16x32_bf16 v[104:107], a[176:179], v[204:207], v[104:107]
v_cvt_pk_bf16_f32 v93, v94, v95
v_mul_f32 v96, v96, v36
v_mul_f32 v97, v97, v36
v_mfma_f32_16x16x32_bf16 v[124:127], a[164:167], v[224:227], v[124:127]
v_mul_f32 v98, v98, v36
v_mul_f32 v99, v99, v36
v_cvt_pk_bf16_f32 v94, v96, v97
v_mfma_f32_16x16x32_bf16 v[124:127], a[180:183], v[228:231], v[124:127]
buffer_store_dwordx4 v[72:75], v5, s[16:19], s93 offen offset:384 nt
v_cvt_pk_bf16_f32 v95, v98, v99
v_mfma_f32_16x16x32_bf16 v[124:127], a[196:199], v[232:235], v[124:127]
v_mul_f32 v100, v100, v36
v_mul_f32 v101, v101, v36
v_mul_f32 v102, v102, v36
v_mfma_f32_16x16x32_bf16 v[124:127], a[212:215], v[216:219], v[124:127]
v_mul_f32 v103, v103, v36
v_cvt_pk_bf16_f32 v100, v100, v101
v_cvt_pk_bf16_f32 v101, v102, v103
v_mfma_f32_16x16x32_bf16 v[128:131], a[216:219], v[216:219], v[128:131]
v_mul_f32 v104, v104, v36
v_mul_f32 v105, v105, v36
v_mul_f32 v106, v106, v36
v_mfma_f32_16x16x32_bf16 v[128:131], a[200:203], v[232:235], v[128:131]
v_mul_f32 v107, v107, v36
v_cvt_pk_bf16_f32 v102, v104, v105
v_cvt_pk_bf16_f32 v103, v106, v107
v_cndmask_b32_dpp v104, v92, v100, vcc quad_perm:[1,0,3,2] row_mask:0xf bank_mask:0xf
v_mfma_f32_16x16x32_bf16 v[128:131], a[184:187], v[228:231], v[128:131]
v_cndmask_b32_dpp v105, v93, v101, vcc quad_perm:[1,0,3,2] row_mask:0xf bank_mask:0xf
v_cndmask_b32_dpp v106, v94, v102, vcc quad_perm:[1,0,3,2] row_mask:0xf bank_mask:0xf
v_cndmask_b32_dpp v107, v95, v103, vcc quad_perm:[1,0,3,2] row_mask:0xf bank_mask:0xf
s_brev_b64 vcc, vcc
v_mfma_f32_16x16x32_bf16 v[128:131], a[168:171], v[224:227], v[128:131]
buffer_store_dwordx4 v[104:107], v5, s[16:19], s99 offen offset:384 nt
v_cndmask_b32_dpp v96, v100, v92, vcc quad_perm:[1,0,3,2] row_mask:0xf bank_mask:0xf
v_mfma_f32_16x16x32_bf16 v[132:135], a[172:175], v[224:227], v[132:135]
v_cndmask_b32_dpp v97, v101, v93, vcc quad_perm:[1,0,3,2] row_mask:0xf bank_mask:0xf
v_cndmask_b32_dpp v98, v102, v94, vcc quad_perm:[1,0,3,2] row_mask:0xf bank_mask:0xf
v_cndmask_b32_dpp v99, v103, v95, vcc quad_perm:[1,0,3,2] row_mask:0xf bank_mask:0xf
v_mfma_f32_16x16x32_bf16 v[132:135], a[188:191], v[228:231], v[132:135]
v_mul_f32 v124, v124, v40
v_mul_f32 v125, v125, v40
v_mul_f32 v126, v126, v40
v_mfma_f32_16x16x32_bf16 v[132:135], a[204:207], v[232:235], v[132:135]
v_mul_f32 v127, v127, v40
v_cvt_pk_bf16_f32 v124, v124, v125
v_cvt_pk_bf16_f32 v125, v126, v127
v_mfma_f32_16x16x32_bf16 v[132:135], a[220:223], v[216:219], v[132:135]
v_mul_f32 v128, v128, v40
v_mul_f32 v129, v129, v40
v_mul_f32 v130, v130, v40
v_mfma_f32_16x16x32_bf16 v[136:139], a[224:227], v[216:219], v[136:139]
buffer_store_dwordx4 v[96:99], v5, s[16:19], s99 offen offset:128 nt
v_mul_f32 v131, v131, v40
v_mfma_f32_16x16x32_bf16 v[136:139], a[208:211], v[232:235], v[136:139]
v_cvt_pk_bf16_f32 v126, v128, v129
v_cvt_pk_bf16_f32 v127, v130, v131
v_mfma_f32_16x16x32_bf16 v[136:139], a[192:195], v[228:231], v[136:139]
v_mfma_f32_16x16x32_bf16 v[136:139], a[176:179], v[224:227], v[136:139]
v_mul_f32 v132, v132, v40
v_mul_f32 v133, v133, v40
v_mul_f32 v134, v134, v40
v_mul_f32 v135, v135, v40
v_cvt_pk_bf16_f32 v132, v132, v133
v_cvt_pk_bf16_f32 v133, v134, v135
s_nop 1
v_pk_mul_f32 v[136:137], v[136:137], v[40:41]
v_pk_mul_f32 v[138:139], v[138:139], v[40:41]
v_cvt_pk_bf16_f32 v134, v136, v137
v_cvt_pk_bf16_f32 v135, v138, v139
v_cndmask_b32_dpp v128, v132, v124, vcc quad_perm:[1,0,3,2] row_mask:0xf bank_mask:0xf
v_cndmask_b32_dpp v129, v133, v125, vcc quad_perm:[1,0,3,2] row_mask:0xf bank_mask:0xf
v_cndmask_b32_dpp v130, v134, v126, vcc quad_perm:[1,0,3,2] row_mask:0xf bank_mask:0xf
v_cndmask_b32_dpp v131, v135, v127, vcc quad_perm:[1,0,3,2] row_mask:0xf bank_mask:0xf
buffer_store_dwordx4 v[128:131], v5, s[16:19], s100 offen offset:128 nt
s_brev_b64 vcc, vcc
v_cndmask_b32_dpp v136, v124, v132, vcc quad_perm:[1,0,3,2] row_mask:0xf bank_mask:0xf
v_cndmask_b32_dpp v137, v125, v133, vcc quad_perm:[1,0,3,2] row_mask:0xf bank_mask:0xf
v_cndmask_b32_dpp v138, v126, v134, vcc quad_perm:[1,0,3,2] row_mask:0xf bank_mask:0xf
v_cndmask_b32_dpp v139, v127, v135, vcc quad_perm:[1,0,3,2] row_mask:0xf bank_mask:0xf
buffer_store_dwordx4 v[136:139], v5, s[16:19], s100 offen offset:384 nt
v_add_f32 v21, v140, v144
v_add_f32 v21, v21, v148
v_cmp_nge_f32 vcc, s22, v21
s_cbranch_vccnz L_setflag_o1
L_setflag_ret_o1:
s_barrier
ds_read_b32 v25, v15 offset:0
s_waitcnt lgkmcnt(0)
v_readfirstlane_b32 s25, v25
s_nop 0
s_cmp_gt_u32 s25, s27
s_cbranch_scc1 L_fallback
L_end_o1:
s_endpgm
L_setflag_o1:
v_mov_b32 v20, 1
s_nop 0
ds_write_b32 v15, v20 offset:0
s_waitcnt lgkmcnt(0)
s_branch L_setflag_ret_o1
.p2align 12
L_touch0_o2:
s_branch L_touch_ret
L_odd2:
s_cmp_lg_u32 s20, s20
v_pk_mul_f32 v[20:21], v[20:21], s[30:31]
v_cvt_pk_bf16_f32 v242, v20, v21
s_xor_b32 s24, s98, 6144
s_add_u32 m0, s23, 25344
s_nop 0
buffer_load_dwordx4 v2, s[8:11], s24 offen offset:0 nt lds
v_lshlrev_b32 v22, 16, v243
v_and_b32 v23, 0xffff0000, v243
v_pk_mul_f32 v[22:23], v[22:23], s[30:31]
v_cvt_pk_bf16_f32 v243, v22, v23
s_waitcnt lgkmcnt(1)
v_lshlrev_b32 v20, 16, v244
v_and_b32 v21, 0xffff0000, v244
v_pk_mul_f32 v[20:21], v[20:21], s[30:31]
v_cvt_pk_bf16_f32 v244, v20, v21
v_lshlrev_b32 v22, 16, v245
v_and_b32 v23, 0xffff0000, v245
v_pk_mul_f32 v[22:23], v[22:23], s[30:31]
v_cvt_pk_bf16_f32 v245, v22, v23
v_lshlrev_b32 v20, 16, v246
v_and_b32 v21, 0xffff0000, v246
v_pk_mul_f32 v[20:21], v[20:21], s[30:31]
v_cvt_pk_bf16_f32 v246, v20, v21
s_add_u32 m0, m0, 32
s_nop 0
buffer_load_dwordx4 v2, s[8:11], s24 offen offset:1024 nt lds
v_lshlrev_b32 v22, 16, v247
v_and_b32 v23, 0xffff0000, v247
v_pk_mul_f32 v[22:23], v[22:23], s[30:31]
v_cvt_pk_bf16_f32 v247, v22, v23
s_waitcnt lgkmcnt(0)
v_lshlrev_b32 v20, 16, v248
v_and_b32 v21, 0xffff0000, v248
v_pk_mul_f32 v[20:21], v[20:21], s[30:31]
v_cvt_pk_bf16_f32 v248, v20, v21
v_lshlrev_b32 v22, 16, v249
v_and_b32 v23, 0xffff0000, v249
v_pk_mul_f32 v[22:23], v[22:23], s[30:31]
v_cvt_pk_bf16_f32 v249, v22, v23
v_lshlrev_b32 v20, 16, v250
v_and_b32 v21, 0xffff0000, v250
v_pk_mul_f32 v[20:21], v[20:21], s[30:31]
v_cvt_pk_bf16_f32 v250, v20, v21
v_lshlrev_b32 v22, 16, v251
v_and_b32 v23, 0xffff0000, v251
v_pk_mul_f32 v[22:23], v[22:23], s[30:31]
v_cvt_pk_bf16_f32 v251, v22, v23
s_waitcnt vmcnt(4)
s_barrier
ds_read_b128 a[68:71], v6 offset:8448
ds_read_b128 a[72:75], v6 offset:8512
v_mfma_f32_16x16x32_bf16 v[168:171], a[36:39], v[236:239], 0
ds_read_b128 a[76:79], v6 offset:8576
v_mfma_f32_16x16x32_bf16 v[168:171], a[40:43], v[240:243], v[168:171]
ds_read_b128 a[80:83], v6 offset:8640
v_mfma_f32_16x16x32_bf16 v[168:171], a[44:47], v[244:247], v[168:171]
ds_read_b128 a[96:99], v6 offset:9152
v_mfma_f32_16x16x32_bf16 v[168:171], a[48:51], v[248:251], v[168:171]
ds_read_b128 a[92:95], v6 offset:9088
v_mfma_f32_16x16x32_bf16 v[172:175], a[64:67], v[248:251], 0
ds_read_b128 a[88:91], v6 offset:9024
v_mfma_f32_16x16x32_bf16 v[172:175], a[60:63], v[244:247], v[172:175]
ds_read_b128 a[84:87], v6 offset:8960
v_mfma_f32_16x16x32_bf16 v[172:175], a[56:59], v[240:243], v[172:175]
v_mfma_f32_16x16x32_bf16 v[172:175], a[52:55], v[236:239], v[172:175]
v_max3_f32 v24, v168, v169, v170
s_nop 6
v_max3_f32 v25, v171, v172, v173
v_max3_f32 v24, v24, v174, v175
v_max3_f32 v24, v24, v25, v28
v_mov_b32 v25, v24
s_nop 1
v_permlane32_swap_b32 v24, v25
v_max_f32 v24, v24, v25
v_mov_b32 v25, v24
s_nop 1
v_permlane16_swap_b32 v24, v25
v_max_f32 v24, v24, v25
v_sub_f32 v168, v168, v24
v_sub_f32 v169, v169, v24
v_sub_f32 v170, v170, v24
v_sub_f32 v171, v171, v24
v_sub_f32 v172, v172, v24
v_sub_f32 v173, v173, v24
v_sub_f32 v174, v174, v24
v_sub_f32 v175, v175, v24
v_sub_f32 v40, 0, v24
v_sub_f32 v41, 0, v24
v_sub_f32 v42, 0, v24
v_sub_f32 v43, 0, v24
s_waitcnt lgkmcnt(0)
v_mfma_f32_16x16x32_bf16 v[152:155], a[68:71], a[0:3], v[32:35]
s_xor_b32 s24, s98, 8192
v_exp_f32 v168, v168
v_mfma_f32_16x16x32_bf16 v[152:155], a[72:75], a[4:7], v[152:155]
s_add_u32 m0, s23, 33792
v_exp_f32 v169, v169
v_mfma_f32_16x16x32_bf16 v[152:155], a[76:79], a[8:11], v[152:155]
v_exp_f32 v170, v170
v_exp_f32 v171, v171
v_mfma_f32_16x16x32_bf16 v[152:155], a[80:83], a[12:15], v[152:155]
v_exp_f32 v172, v172
v_cvt_pk_bf16_f32 v216, v168, v169
v_mfma_f32_16x16x32_bf16 v[156:159], a[96:99], a[12:15], v[32:35]
v_exp_f32 v173, v173
v_cvt_pk_bf16_f32 v217, v170, v171
v_mfma_f32_16x16x32_bf16 v[156:159], a[92:95], a[8:11], v[156:159]
v_exp_f32 v174, v174
v_cvt_pk_bf16_f32 v218, v172, v173
v_mfma_f32_16x16x32_bf16 v[156:159], a[88:91], a[4:7], v[156:159]
v_exp_f32 v175, v175
v_mfma_f32_16x16x32_bf16 v[156:159], a[84:87], a[0:3], v[156:159]
v_cvt_pk_bf16_f32 v219, v174, v175
v_mfma_f32_16x16x32_bf16 v[164:167], a[84:87], a[16:19], v[36:39]
v_mfma_f32_16x16x32_bf16 v[164:167], a[88:91], a[20:23], v[164:167]
buffer_load_dwordx4 v2, s[8:11], s24 offen offset:0 nt lds
v_mfma_f32_16x16x32_bf16 v[164:167], a[92:95], a[24:27], v[164:167]
s_add_u32 m0, m0, 32
v_exp_f32 v152, v152
v_exp_f32 v153, v153
v_exp_f32 v154, v154
v_mfma_f32_16x16x32_bf16 v[164:167], a[96:99], a[28:31], v[164:167]
buffer_load_dwordx4 v2, s[8:11], s24 offen offset:1024 nt lds
v_cvt_pk_bf16_f32 v180, v152, v153
v_mfma_f32_16x16x32_bf16 v[160:163], a[80:83], a[28:31], v[36:39]
s_xor_b32 s24, s98, 10240
v_exp_f32 v155, v155
v_mfma_f32_16x16x32_bf16 v[160:163], a[76:79], a[24:27], v[160:163]
s_add_u32 m0, s23, 42240
v_exp_f32 v156, v156
v_cvt_pk_bf16_f32 v181, v154, v155
v_mfma_f32_16x16x32_bf16 v[160:163], a[72:75], a[20:23], v[160:163]
v_exp_f32 v157, v157
v_mfma_f32_16x16x32_bf16 v[160:163], a[68:71], a[16:19], v[160:163]
v_exp_f32 v158, v158
v_exp_f32 v159, v159
v_mfma_f32_16x16x32_bf16 v[168:171], a[68:71], v[236:239], v[40:43]
v_cvt_pk_bf16_f32 v182, v156, v157
v_cvt_pk_bf16_f32 v183, v158, v159
v_mfma_f32_16x16x32_bf16 v[168:171], a[72:75], v[240:243], v[168:171]
v_mfma_f32_16x16x32_bf16 v[168:171], a[76:79], v[244:247], v[168:171]
buffer_load_dwordx4 v2, s[8:11], s24 offen offset:0 nt lds
v_exp_f32 v164, v164
v_mfma_f32_16x16x32_bf16 v[168:171], a[80:83], v[248:251], v[168:171]
s_add_u32 m0, m0, 32
v_exp_f32 v165, v165
v_exp_f32 v166, v166
v_mfma_f32_16x16x32_bf16 v[172:175], a[96:99], v[248:251], v[40:43]
v_exp_f32 v167, v167
v_mfma_f32_16x16x32_bf16 v[172:175], a[92:95], v[244:247], v[172:175]
v_exp_f32 v160, v160
v_cvt_pk_bf16_f32 v202, v164, v165
v_mfma_f32_16x16x32_bf16 v[172:175], a[88:91], v[240:243], v[172:175]
s_waitcnt vmcnt(5)
s_barrier
v_mfma_f32_16x16x32_bf16 v[172:175], a[84:87], v[236:239], v[172:175]
ds_read_b128 a[36:39], v6 offset:16896
ds_read_b128 a[40:43], v6 offset:16960
ds_read_b128 a[44:47], v6 offset:17024
ds_read_b128 a[48:51], v6 offset:17088
ds_read_b128 a[64:67], v6 offset:17600
ds_read_b128 a[60:63], v6 offset:17536
ds_read_b128 a[56:59], v6 offset:17472
ds_read_b128 a[52:55], v6 offset:17408
buffer_load_dwordx4 v2, s[8:11], s24 offen offset:1024 nt lds
v_exp_f32 v161, v161
v_mfma_f32_16x16x32_bf16 v[148:151], a[32:35], v[216:219], 0
s_waitcnt lgkmcnt(7)
v_exp_f32 v162, v162
v_exp_f32 v163, v163
v_cvt_pk_bf16_f32 v203, v166, v167
v_cvt_pk_bf16_f32 v200, v160, v161
v_mfma_f32_16x16x32_bf16 v[152:155], a[36:39], a[0:3], v[32:35]
s_waitcnt lgkmcnt(6)
v_cvt_pk_bf16_f32 v201, v162, v163
v_mfma_f32_16x16x32_bf16 v[152:155], a[40:43], a[4:7], v[152:155]
s_waitcnt lgkmcnt(5)
v_exp_f32 v168, v168
v_exp_f32 v169, v169
v_exp_f32 v170, v170
v_exp_f32 v171, v171
v_exp_f32 v172, v172
v_exp_f32 v173, v173
v_mfma_f32_16x16x32_bf16 v[152:155], a[44:47], a[8:11], v[152:155]
s_waitcnt lgkmcnt(4)
s_xor_b32 s24, s98, 0
s_add_u32 m0, s29, 50688
v_exp_f32 v174, v174
v_cvt_pk_bf16_f32 v220, v168, v169
v_cvt_pk_bf16_f32 v221, v170, v171
v_mfma_f32_16x16x32_bf16 v[152:155], a[48:51], a[12:15], v[152:155]
s_waitcnt lgkmcnt(3)
buffer_load_dwordx4 v2, s[12:15], s24 offen offset:0 nt lds
v_exp_f32 v175, v175
v_cvt_pk_bf16_f32 v222, v172, v173
v_mfma_f32_16x16x32_bf16 v[156:159], a[64:67], a[12:15], v[32:35]
s_waitcnt lgkmcnt(2)
s_add_u32 m0, m0, 8
v_cvt_pk_bf16_f32 v223, v174, v175
v_mfma_f32_16x16x32_bf16 v[156:159], a[60:63], a[8:11], v[156:159]
s_waitcnt lgkmcnt(1)
buffer_load_dwordx4 v2, s[12:15], s24 offen offset:1024 nt lds
v_mfma_f32_16x16x32_bf16 v[156:159], a[56:59], a[4:7], v[156:159]
s_waitcnt lgkmcnt(0)
v_mfma_f32_16x16x32_bf16 v[156:159], a[52:55], a[0:3], v[156:159]
s_xor_b32 s24, s98, 12288
v_mfma_f32_16x16x32_bf16 v[164:167], a[52:55], a[16:19], v[36:39]
s_add_u32 m0, s23, 59136
v_mfma_f32_16x16x32_bf16 v[164:167], a[56:59], a[20:23], v[164:167]
v_mfma_f32_16x16x32_bf16 v[164:167], a[60:63], a[24:27], v[164:167]
v_exp_f32 v152, v152
v_exp_f32 v153, v153
v_exp_f32 v154, v154
v_exp_f32 v155, v155
v_exp_f32 v156, v156
v_exp_f32 v157, v157
v_exp_f32 v158, v158
v_exp_f32 v159, v159
v_mfma_f32_16x16x32_bf16 v[164:167], a[64:67], a[28:31], v[164:167]
v_cvt_pk_bf16_f32 v184, v152, v153
v_cvt_pk_bf16_f32 v185, v154, v155
v_cvt_pk_bf16_f32 v186, v156, v157
v_cvt_pk_bf16_f32 v187, v158, v159
v_mfma_f32_16x16x32_bf16 v[160:163], a[48:51], a[28:31], v[36:39]
v_mfma_f32_16x16x32_bf16 v[160:163], a[44:47], a[24:27], v[160:163]
v_mfma_f32_16x16x32_bf16 v[160:163], a[40:43], a[20:23], v[160:163]
v_mfma_f32_16x16x32_bf16 v[160:163], a[36:39], a[16:19], v[160:163]
v_mfma_f32_16x16x32_bf16 v[168:171], a[36:39], v[236:239], v[40:43]
v_mfma_f32_16x16x32_bf16 v[168:171], a[40:43], v[240:243], v[168:171]
v_mfma_f32_16x16x32_bf16 v[168:171], a[44:47], v[244:247], v[168:171]
v_exp_f32 v164, v164
v_exp_f32 v165, v165
v_exp_f32 v166, v166
v_exp_f32 v167, v167
v_exp_f32 v160, v160
v_exp_f32 v161, v161
v_exp_f32 v162, v162
v_exp_f32 v163, v163
v_mfma_f32_16x16x32_bf16 v[168:171], a[48:51], v[248:251], v[168:171]
v_cvt_pk_bf16_f32 v206, v164, v165
v_cvt_pk_bf16_f32 v207, v166, v167
v_cvt_pk_bf16_f32 v204, v160, v161
v_cvt_pk_bf16_f32 v205, v162, v163
v_mfma_f32_16x16x32_bf16 v[172:175], a[64:67], v[248:251], v[40:43]
v_mfma_f32_16x16x32_bf16 v[172:175], a[60:63], v[244:247], v[172:175]
v_mfma_f32_16x16x32_bf16 v[172:175], a[56:59], v[240:243], v[172:175]
v_mfma_f32_16x16x32_bf16 v[172:175], a[52:55], v[236:239], v[172:175]
v_mfma_f32_16x16x32_bf16 v[140:143], a[32:35], v[180:183], v[140:143]
s_waitcnt vmcnt(6)
s_barrier
v_mfma_f32_16x16x32_bf16 v[144:147], a[32:35], v[200:203], v[144:147]
ds_read_b128 a[68:71], v6 offset:25344
ds_read_b128 a[72:75], v6 offset:25408
ds_read_b128 a[76:79], v6 offset:25472
ds_read_b128 a[80:83], v6 offset:25536
ds_read_b128 a[96:99], v6 offset:26048
ds_read_b128 a[92:95], v6 offset:25984
ds_read_b128 a[88:91], v6 offset:25920
ds_read_b128 a[84:87], v6 offset:25856
v_mfma_f32_16x16x32_bf16 v[148:151], a[32:35], v[220:223], v[148:151]
s_waitcnt lgkmcnt(7)
v_exp_f32 v168, v168
v_exp_f32 v169, v169
v_exp_f32 v170, v170
v_exp_f32 v171, v171
v_exp_f32 v172, v172
v_exp_f32 v173, v173
v_exp_f32 v174, v174
v_exp_f32 v175, v175
v_mfma_f32_16x16x32_bf16 v[152:155], a[68:71], a[0:3], v[32:35]
s_waitcnt lgkmcnt(6)
v_cvt_pk_bf16_f32 v224, v168, v169
v_cvt_pk_bf16_f32 v225, v170, v171
v_cvt_pk_bf16_f32 v226, v172, v173
v_cvt_pk_bf16_f32 v227, v174, v175
v_mfma_f32_16x16x32_bf16 v[152:155], a[72:75], a[4:7], v[152:155]
s_waitcnt lgkmcnt(5)
v_mfma_f32_16x16x32_bf16 v[152:155], a[76:79], a[8:11], v[152:155]
s_waitcnt lgkmcnt(4)
v_mfma_f32_16x16x32_bf16 v[152:155], a[80:83], a[12:15], v[152:155]
s_waitcnt lgkmcnt(3)
v_mfma_f32_16x16x32_bf16 v[156:159], a[96:99], a[12:15], v[32:35]
s_waitcnt lgkmcnt(2)
v_mfma_f32_16x16x32_bf16 v[156:159], a[92:95], a[8:11], v[156:159]
s_waitcnt lgkmcnt(1)
v_mfma_f32_16x16x32_bf16 v[156:159], a[88:91], a[4:7], v[156:159]
s_waitcnt lgkmcnt(0)
v_mfma_f32_16x16x32_bf16 v[156:159], a[84:87], a[0:3], v[156:159]
buffer_load_dwordx4 v2, s[8:11], s24 offen offset:0 nt lds
v_mfma_f32_16x16x32_bf16 v[164:167], a[84:87], a[16:19], v[36:39]
s_add_u32 m0, m0, 32
v_mfma_f32_16x16x32_bf16 v[164:167], a[88:91], a[20:23], v[164:167]
buffer_load_dwordx4 v2, s[8:11], s24 offen offset:1024 nt lds
v_mfma_f32_16x16x32_bf16 v[164:167], a[92:95], a[24:27], v[164:167]
s_xor_b32 s24, s98, 2048
v_exp_f32 v152, v152
v_exp_f32 v153, v153
v_exp_f32 v154, v154
v_exp_f32 v155, v155
v_exp_f32 v156, v156
v_exp_f32 v157, v157
v_exp_f32 v158, v158
v_exp_f32 v159, v159
v_mfma_f32_16x16x32_bf16 v[164:167], a[96:99], a[28:31], v[164:167]
s_add_u32 m0, s29, 67584
v_cvt_pk_bf16_f32 v188, v152, v153
v_cvt_pk_bf16_f32 v189, v154, v155
v_cvt_pk_bf16_f32 v190, v156, v157
v_cvt_pk_bf16_f32 v191, v158, v159
v_mfma_f32_16x16x32_bf16 v[160:163], a[80:83], a[28:31], v[36:39]
v_mfma_f32_16x16x32_bf16 v[160:163], a[76:79], a[24:27], v[160:163]
v_mfma_f32_16x16x32_bf16 v[160:163], a[72:75], a[20:23], v[160:163]
v_mfma_f32_16x16x32_bf16 v[160:163], a[68:71], a[16:19], v[160:163]
buffer_load_dwordx4 v2, s[12:15], s24 offen offset:0 nt lds
v_mfma_f32_16x16x32_bf16 v[168:171], a[68:71], v[236:239], v[40:43]
s_add_u32 m0, m0, 8
v_mfma_f32_16x16x32_bf16 v[168:171], a[72:75], v[240:243], v[168:171]
buffer_load_dwordx4 v2, s[12:15], s24 offen offset:1024 nt lds
v_mfma_f32_16x16x32_bf16 v[168:171], a[76:79], v[244:247], v[168:171]
s_xor_b32 s24, s98, 14336
v_exp_f32 v164, v164
v_exp_f32 v165, v165
v_exp_f32 v166, v166
v_exp_f32 v167, v167
v_exp_f32 v160, v160
v_exp_f32 v161, v161
v_exp_f32 v162, v162
v_exp_f32 v163, v163
v_mfma_f32_16x16x32_bf16 v[168:171], a[80:83], v[248:251], v[168:171]
s_add_u32 m0, s23, 76032
v_cvt_pk_bf16_f32 v210, v164, v165
v_cvt_pk_bf16_f32 v211, v166, v167
v_cvt_pk_bf16_f32 v208, v160, v161
v_cvt_pk_bf16_f32 v209, v162, v163
v_mfma_f32_16x16x32_bf16 v[172:175], a[96:99], v[248:251], v[40:43]
v_mfma_f32_16x16x32_bf16 v[172:175], a[92:95], v[244:247], v[172:175]
v_mfma_f32_16x16x32_bf16 v[172:175], a[88:91], v[240:243], v[172:175]
v_mfma_f32_16x16x32_bf16 v[172:175], a[84:87], v[236:239], v[172:175]
v_mfma_f32_16x16x32_bf16 v[140:143], a[32:35], v[184:187], v[140:143]
s_waitcnt vmcnt(8)
s_barrier
v_mfma_f32_16x16x32_bf16 v[144:147], a[32:35], v[204:207], v[144:147]
ds_read_b128 a[36:39], v6 offset:33792
ds_read_b128 a[40:43], v6 offset:33856
ds_read_b128 a[44:47], v6 offset:33920
ds_read_b128 a[48:51], v6 offset:33984
ds_read_b128 a[64:67], v6 offset:34496
ds_read_b128 a[60:63], v6 offset:34432
ds_read_b128 a[56:59], v6 offset:34368
ds_read_b128 a[52:55], v6 offset:34304
v_mfma_f32_16x16x32_bf16 v[148:151], a[32:35], v[224:227], v[148:151]
s_waitcnt lgkmcnt(7)
v_exp_f32 v168, v168
v_exp_f32 v169, v169
v_exp_f32 v170, v170
v_exp_f32 v171, v171
v_exp_f32 v172, v172
v_exp_f32 v173, v173
v_exp_f32 v174, v174
v_exp_f32 v175, v175
v_mfma_f32_16x16x32_bf16 v[152:155], a[36:39], a[0:3], v[32:35]
s_waitcnt lgkmcnt(6)
v_cvt_pk_bf16_f32 v228, v168, v169
v_cvt_pk_bf16_f32 v229, v170, v171
v_cvt_pk_bf16_f32 v230, v172, v173
v_cvt_pk_bf16_f32 v231, v174, v175
v_mfma_f32_16x16x32_bf16 v[152:155], a[40:43], a[4:7], v[152:155]
s_waitcnt lgkmcnt(5)
v_mfma_f32_16x16x32_bf16 v[152:155], a[44:47], a[8:11], v[152:155]
s_waitcnt lgkmcnt(4)
v_mfma_f32_16x16x32_bf16 v[152:155], a[48:51], a[12:15], v[152:155]
s_waitcnt lgkmcnt(3)
v_mfma_f32_16x16x32_bf16 v[156:159], a[64:67], a[12:15], v[32:35]
s_waitcnt lgkmcnt(2)
v_mfma_f32_16x16x32_bf16 v[156:159], a[60:63], a[8:11], v[156:159]
s_waitcnt lgkmcnt(1)
v_mfma_f32_16x16x32_bf16 v[156:159], a[56:59], a[4:7], v[156:159]
s_waitcnt lgkmcnt(0)
v_mfma_f32_16x16x32_bf16 v[156:159], a[52:55], a[0:3], v[156:159]
v_mfma_f32_16x16x32_bf16 v[164:167], a[52:55], a[16:19], v[36:39]
v_mfma_f32_16x16x32_bf16 v[164:167], a[56:59], a[20:23], v[164:167]
v_mfma_f32_16x16x32_bf16 v[164:167], a[60:63], a[24:27], v[164:167]
v_exp_f32 v152, v152
v_exp_f32 v153, v153
v_exp_f32 v154, v154
v_exp_f32 v155, v155
v_exp_f32 v156, v156
v_exp_f32 v157, v157
v_exp_f32 v158, v158
v_exp_f32 v159, v159
v_mfma_f32_16x16x32_bf16 v[164:167], a[64:67], a[28:31], v[164:167]
v_cvt_pk_bf16_f32 v192, v152, v153
v_cvt_pk_bf16_f32 v193, v154, v155
v_cvt_pk_bf16_f32 v194, v156, v157
v_cvt_pk_bf16_f32 v195, v158, v159
v_mfma_f32_16x16x32_bf16 v[160:163], a[48:51], a[28:31], v[36:39]
v_mfma_f32_16x16x32_bf16 v[160:163], a[44:47], a[24:27], v[160:163]
v_mfma_f32_16x16x32_bf16 v[160:163], a[40:43], a[20:23], v[160:163]
v_mfma_f32_16x16x32_bf16 v[160:163], a[36:39], a[16:19], v[160:163]
v_mfma_f32_16x16x32_bf16 v[168:171], a[36:39], v[236:239], v[40:43]
v_mfma_f32_16x16x32_bf16 v[168:171], a[40:43], v[240:243], v[168:171]
buffer_load_dwordx4 v2, s[8:11], s24 offen offset:0 nt lds
v_mfma_f32_16x16x32_bf16 v[168:171], a[44:47], v[244:247], v[168:171]
s_add_u32 m0, m0, 32
v_exp_f32 v164, v164
v_exp_f32 v165, v165
v_exp_f32 v166, v166
v_exp_f32 v167, v167
v_exp_f32 v160, v160
v_exp_f32 v161, v161
v_exp_f32 v162, v162
v_exp_f32 v163, v163
v_mfma_f32_16x16x32_bf16 v[168:171], a[48:51], v[248:251], v[168:171]
buffer_load_dwordx4 v2, s[8:11], s24 offen offset:1024 nt lds
v_cvt_pk_bf16_f32 v214, v164, v165
v_cvt_pk_bf16_f32 v215, v166, v167
v_cvt_pk_bf16_f32 v212, v160, v161
v_cvt_pk_bf16_f32 v213, v162, v163
v_mfma_f32_16x16x32_bf16 v[172:175], a[64:67], v[248:251], v[40:43]
s_xor_b32 s24, s98, 4096
v_mfma_f32_16x16x32_bf16 v[172:175], a[60:63], v[244:247], v[172:175]
s_add_u32 m0, s29, 84480
v_mfma_f32_16x16x32_bf16 v[172:175], a[56:59], v[240:243], v[172:175]
v_mfma_f32_16x16x32_bf16 v[172:175], a[52:55], v[236:239], v[172:175]
v_mfma_f32_16x16x32_bf16 v[140:143], a[32:35], v[188:191], v[140:143]
s_waitcnt vmcnt(6)
s_barrier
v_mfma_f32_16x16x32_bf16 v[144:147], a[32:35], v[208:211], v[144:147]
ds_read_b64_tr_b16 a[100:101], v9 offset:50688
ds_read_b64_tr_b16 a[102:103], v9 offset:51200
s_waitcnt lgkmcnt(0)
ds_read_b64_tr_b16 a[104:105], v9 offset:50696
ds_read_b64_tr_b16 a[106:107], v9 offset:51208
ds_read_b64_tr_b16 a[108:109], v9 offset:50704
ds_read_b64_tr_b16 a[110:111], v9 offset:51216
ds_read_b64_tr_b16 a[112:113], v9 offset:50712
ds_read_b64_tr_b16 a[114:115], v9 offset:51224
ds_read_b64_tr_b16 a[116:117], v9 offset:50816
ds_read_b64_tr_b16 a[118:119], v9 offset:51328
ds_read_b64_tr_b16 a[120:121], v9 offset:50824
ds_read_b64_tr_b16 a[122:123], v9 offset:51336
ds_read_b64_tr_b16 a[124:125], v9 offset:50832
ds_read_b64_tr_b16 a[126:127], v9 offset:51344
ds_read_b64_tr_b16 a[128:129], v9 offset:50840
ds_read_b64_tr_b16 a[130:131], v9 offset:51352
v_mfma_f32_16x16x32_bf16 v[148:151], a[32:35], v[228:231], v[148:151]
ds_read_b128 a[68:71], v6 offset:42240
ds_read_b128 a[72:75], v6 offset:42304
ds_read_b128 a[76:79], v6 offset:42368
v_exp_f32 v168, v168
v_exp_f32 v169, v169
v_exp_f32 v170, v170
v_exp_f32 v171, v171
v_exp_f32 v172, v172
v_exp_f32 v173, v173
v_exp_f32 v174, v174
v_exp_f32 v175, v175
v_mfma_f32_16x16x32_bf16 v[44:47], a[100:103], v[176:179], 0
ds_read_b128 a[80:83], v6 offset:42432
ds_read_b128 a[96:99], v6 offset:42944
ds_read_b128 a[92:95], v6 offset:42880
v_cvt_pk_bf16_f32 v232, v168, v169
v_cvt_pk_bf16_f32 v233, v170, v171
v_cvt_pk_bf16_f32 v234, v172, v173
v_mfma_f32_16x16x32_bf16 v[76:79], a[100:103], v[196:199], 0
s_waitcnt lgkmcnt(15)
ds_read_b128 a[88:91], v6 offset:42816
v_cvt_pk_bf16_f32 v235, v174, v175
v_mfma_f32_16x16x32_bf16 v[108:111], a[100:103], v[216:219], 0
ds_read_b128 a[84:87], v6 offset:42752
buffer_load_dwordx4 v2, s[12:15], s24 offen offset:0 nt lds
v_mfma_f32_16x16x32_bf16 v[112:115], a[104:107], v[216:219], 0
s_add_u32 m0, m0, 8
v_mfma_f32_16x16x32_bf16 v[80:83], a[104:107], v[196:199], 0
s_waitcnt lgkmcnt(15)
buffer_load_dwordx4 v2, s[12:15], s24 offen offset:1024 nt lds
v_mfma_f32_16x16x32_bf16 v[48:51], a[104:107], v[176:179], 0
s_xor_b32 s24, s98, 16384
v_mfma_f32_16x16x32_bf16 v[52:55], a[108:111], v[176:179], 0
s_add_u32 m0, s23, 92928
v_mfma_f32_16x16x32_bf16 v[84:87], a[108:111], v[196:199], 0
v_mfma_f32_16x16x32_bf16 v[116:119], a[108:111], v[216:219], 0
v_mfma_f32_16x16x32_bf16 v[120:123], a[112:115], v[216:219], 0
v_mfma_f32_16x16x32_bf16 v[88:91], a[112:115], v[196:199], 0
s_waitcnt lgkmcnt(8)
v_mfma_f32_16x16x32_bf16 v[56:59], a[112:115], v[176:179], 0
v_mfma_f32_16x16x32_bf16 v[60:63], a[116:119], v[176:179], 0
v_mfma_f32_16x16x32_bf16 v[92:95], a[116:119], v[196:199], 0
v_mfma_f32_16x16x32_bf16 v[124:127], a[116:119], v[216:219], 0
v_mfma_f32_16x16x32_bf16 v[128:131], a[120:123], v[216:219], 0
v_mfma_f32_16x16x32_bf16 v[96:99], a[120:123], v[196:199], 0
v_mfma_f32_16x16x32_bf16 v[64:67], a[120:123], v[176:179], 0
v_mfma_f32_16x16x32_bf16 v[68:71], a[124:127], v[176:179], 0
v_mfma_f32_16x16x32_bf16 v[100:103], a[124:127], v[196:199], 0
v_mfma_f32_16x16x32_bf16 v[132:135], a[124:127], v[216:219], 0
v_mfma_f32_16x16x32_bf16 v[136:139], a[128:131], v[216:219], 0
v_mfma_f32_16x16x32_bf16 v[104:107], a[128:131], v[196:199], 0
s_waitcnt lgkmcnt(4)
v_mfma_f32_16x16x32_bf16 v[72:75], a[128:131], v[176:179], 0
v_mfma_f32_16x16x32_bf16 v[152:155], a[68:71], a[0:3], v[32:35]
v_mfma_f32_16x16x32_bf16 v[152:155], a[72:75], a[4:7], v[152:155]
v_mfma_f32_16x16x32_bf16 v[152:155], a[76:79], a[8:11], v[152:155]
s_waitcnt lgkmcnt(0)
v_mfma_f32_16x16x32_bf16 v[152:155], a[80:83], a[12:15], v[152:155]
v_mfma_f32_16x16x32_bf16 v[156:159], a[96:99], a[12:15], v[32:35]
buffer_load_dwordx4 v2, s[8:11], s24 offen offset:0 nt lds
v_mfma_f32_16x16x32_bf16 v[156:159], a[92:95], a[8:11], v[156:159]
s_add_u32 m0, m0, 32
v_mfma_f32_16x16x32_bf16 v[156:159], a[88:91], a[4:7], v[156:159]
buffer_load_dwordx4 v2, s[8:11], s24 offen offset:1024 nt lds
v_mfma_f32_16x16x32_bf16 v[156:159], a[84:87], a[0:3], v[156:159]
s_xor_b32 s24, s98, 6144
v_mfma_f32_16x16x32_bf16 v[164:167], a[84:87], a[16:19], v[36:39]
s_add_u32 m0, s29, 101376
v_mfma_f32_16x16x32_bf16 v[164:167], a[88:91], a[20:23], v[164:167]
v_mfma_f32_16x16x32_bf16 v[164:167], a[92:95], a[24:27], v[164:167]
v_exp_f32 v152, v152
v_exp_f32 v153, v153
v_exp_f32 v154, v154
v_exp_f32 v155, v155
v_exp_f32 v156, v156
v_exp_f32 v157, v157
v_exp_f32 v158, v158
v_exp_f32 v159, v159
v_mfma_f32_16x16x32_bf16 v[164:167], a[96:99], a[28:31], v[164:167]
v_cvt_pk_bf16_f32 v176, v152, v153
v_cvt_pk_bf16_f32 v177, v154, v155
v_cvt_pk_bf16_f32 v178, v156, v157
v_cvt_pk_bf16_f32 v179, v158, v159
v_mfma_f32_16x16x32_bf16 v[160:163], a[80:83], a[28:31], v[36:39]
v_mfma_f32_16x16x32_bf16 v[160:163], a[76:79], a[24:27], v[160:163]
v_mfma_f32_16x16x32_bf16 v[160:163], a[72:75], a[20:23], v[160:163]
v_mfma_f32_16x16x32_bf16 v[160:163], a[68:71], a[16:19], v[160:163]
v_mfma_f32_16x16x32_bf16 v[168:171], a[68:71], v[236:239], v[40:43]
v_mfma_f32_16x16x32_bf16 v[168:171], a[72:75], v[240:243], v[168:171]
v_mfma_f32_16x16x32_bf16 v[168:171], a[76:79], v[244:247], v[168:171]
v_exp_f32 v164, v164
v_exp_f32 v165, v165
v_exp_f32 v166, v166
v_exp_f32 v167, v167
v_exp_f32 v160, v160
v_exp_f32 v161, v161
v_exp_f32 v162, v162
v_exp_f32 v163, v163
v_mfma_f32_16x16x32_bf16 v[168:171], a[80:83], v[248:251], v[168:171]
v_cvt_pk_bf16_f32 v198, v164, v165
v_cvt_pk_bf16_f32 v199, v166, v167
v_cvt_pk_bf16_f32 v196, v160, v161
v_cvt_pk_bf16_f32 v197, v162, v163
v_mfma_f32_16x16x32_bf16 v[172:175], a[96:99], v[248:251], v[40:43]
buffer_load_dwordx4 v2, s[12:15], s24 offen offset:0 nt lds
v_mfma_f32_16x16x32_bf16 v[172:175], a[92:95], v[244:247], v[172:175]
s_add_u32 m0, m0, 8
v_mfma_f32_16x16x32_bf16 v[172:175], a[88:91], v[240:243], v[172:175]
v_mfma_f32_16x16x32_bf16 v[172:175], a[84:87], v[236:239], v[172:175]
v_mfma_f32_16x16x32_bf16 v[140:143], a[32:35], v[192:195], v[140:143]
s_waitcnt vmcnt(7)
s_barrier
v_mfma_f32_16x16x32_bf16 v[144:147], a[32:35], v[212:215], v[144:147]
ds_read_b64_tr_b16 a[132:133], v10 offset:8448
ds_read_b64_tr_b16 a[134:135], v10 offset:8960
s_waitcnt lgkmcnt(0)
ds_read_b64_tr_b16 a[136:137], v10 offset:8456
ds_read_b64_tr_b16 a[138:139], v10 offset:8968
ds_read_b64_tr_b16 a[140:141], v10 offset:8464
ds_read_b64_tr_b16 a[142:143], v10 offset:8976
ds_read_b64_tr_b16 a[144:145], v10 offset:8472
ds_read_b64_tr_b16 a[146:147], v10 offset:8984
ds_read_b64_tr_b16 a[148:149], v10 offset:8576
ds_read_b64_tr_b16 a[150:151], v10 offset:9088
ds_read_b64_tr_b16 a[152:153], v10 offset:8584
ds_read_b64_tr_b16 a[154:155], v10 offset:9096
ds_read_b64_tr_b16 a[156:157], v10 offset:8592
ds_read_b64_tr_b16 a[158:159], v10 offset:9104
ds_read_b64_tr_b16 a[160:161], v10 offset:8600
ds_read_b64_tr_b16 a[162:163], v10 offset:9112
buffer_load_dwordx4 v2, s[12:15], s24 offen offset:1024 nt lds
v_mfma_f32_16x16x32_bf16 v[148:151], a[32:35], v[232:235], v[148:151]
s_xor_b32 s24, s98, 18432
ds_read_b128 a[36:39], v7 offset:0
ds_read_b128 a[40:43], v7 offset:64
ds_read_b128 a[44:47], v7 offset:128
v_exp_f32 v168, v168
v_exp_f32 v169, v169
v_exp_f32 v170, v170
v_exp_f32 v171, v171
v_exp_f32 v172, v172
v_exp_f32 v173, v173
v_exp_f32 v174, v174
v_mfma_f32_16x16x32_bf16 v[44:47], a[132:135], v[180:183], v[44:47]
s_add_u32 m0, s23, 109824
ds_read_b128 a[48:51], v7 offset:192
ds_read_b128 a[64:67], v7 offset:704
ds_read_b128 a[60:63], v7 offset:640
v_cvt_pk_bf16_f32 v216, v168, v169
v_cvt_pk_bf16_f32 v217, v170, v171
v_mfma_f32_16x16x32_bf16 v[76:79], a[132:135], v[200:203], v[76:79]
s_waitcnt lgkmcnt(15)
ds_read_b128 a[56:59], v7 offset:576
v_exp_f32 v175, v175
v_cvt_pk_bf16_f32 v218, v172, v173
v_mfma_f32_16x16x32_bf16 v[108:111], a[132:135], v[220:223], v[108:111]
ds_read_b128 a[52:55], v7 offset:512
v_cvt_pk_bf16_f32 v219, v174, v175
v_mfma_f32_16x16x32_bf16 v[112:115], a[136:139], v[220:223], v[112:115]
v_mfma_f32_16x16x32_bf16 v[80:83], a[136:139], v[200:203], v[80:83]
s_waitcnt lgkmcnt(15)
v_mfma_f32_16x16x32_bf16 v[48:51], a[136:139], v[180:183], v[48:51]
v_mfma_f32_16x16x32_bf16 v[52:55], a[140:143], v[180:183], v[52:55]
v_mfma_f32_16x16x32_bf16 v[84:87], a[140:143], v[200:203], v[84:87]
v_mfma_f32_16x16x32_bf16 v[116:119], a[140:143], v[220:223], v[116:119]
v_mfma_f32_16x16x32_bf16 v[120:123], a[144:147], v[220:223], v[120:123]
v_mfma_f32_16x16x32_bf16 v[88:91], a[144:147], v[200:203], v[88:91]
s_waitcnt lgkmcnt(8)
v_mfma_f32_16x16x32_bf16 v[56:59], a[144:147], v[180:183], v[56:59]
v_mfma_f32_16x16x32_bf16 v[60:63], a[148:151], v[180:183], v[60:63]
v_mfma_f32_16x16x32_bf16 v[92:95], a[148:151], v[200:203], v[92:95]
v_mfma_f32_16x16x32_bf16 v[124:127], a[148:151], v[220:223], v[124:127]
v_mfma_f32_16x16x32_bf16 v[128:131], a[152:155], v[220:223], v[128:131]
v_mfma_f32_16x16x32_bf16 v[96:99], a[152:155], v[200:203], v[96:99]
v_mfma_f32_16x16x32_bf16 v[64:67], a[152:155], v[180:183], v[64:67]
L_touch1_o2:
s_cbranch_scc1 L_touch_ret
v_mfma_f32_16x16x32_bf16 v[68:71], a[156:159], v[180:183], v[68:71]
v_mfma_f32_16x16x32_bf16 v[100:103], a[156:159], v[200:203], v[100:103]
v_mfma_f32_16x16x32_bf16 v[132:135], a[156:159], v[220:223], v[132:135]
buffer_load_dwordx4 v2, s[8:11], s24 offen offset:0 nt lds
v_mfma_f32_16x16x32_bf16 v[136:139], a[160:163], v[220:223], v[136:139]
s_add_u32 m0, m0, 32
v_mfma_f32_16x16x32_bf16 v[104:107], a[160:163], v[200:203], v[104:107]
s_waitcnt lgkmcnt(4)
buffer_load_dwordx4 v2, s[8:11], s24 offen offset:1024 nt lds
v_mfma_f32_16x16x32_bf16 v[72:75], a[160:163], v[180:183], v[72:75]
s_xor_b32 s24, s98, 8192
v_mfma_f32_16x16x32_bf16 v[152:155], a[36:39], a[0:3], v[32:35]
s_add_u32 m0, s29, 118272
v_mfma_f32_16x16x32_bf16 v[152:155], a[40:43], a[4:7], v[152:155]
v_mfma_f32_16x16x32_bf16 v[152:155], a[44:47], a[8:11], v[152:155]
s_waitcnt lgkmcnt(0)
v_mfma_f32_16x16x32_bf16 v[152:155], a[48:51], a[12:15], v[152:155]
v_mfma_f32_16x16x32_bf16 v[156:159], a[64:67], a[12:15], v[32:35]
v_mfma_f32_16x16x32_bf16 v[156:159], a[60:63], a[8:11], v[156:159]
v_mfma_f32_16x16x32_bf16 v[156:159], a[56:59], a[4:7], v[156:159]
v_mfma_f32_16x16x32_bf16 v[156:159], a[52:55], a[0:3], v[156:159]
v_mfma_f32_16x16x32_bf16 v[164:167], a[52:55], a[16:19], v[36:39]
v_mfma_f32_16x16x32_bf16 v[164:167], a[56:59], a[20:23], v[164:167]
v_mfma_f32_16x16x32_bf16 v[164:167], a[60:63], a[24:27], v[164:167]
v_exp_f32 v152, v152
v_exp_f32 v153, v153
v_exp_f32 v154, v154
v_exp_f32 v155, v155
v_exp_f32 v156, v156
v_exp_f32 v157, v157
v_exp_f32 v158, v158
v_exp_f32 v159, v159
v_mfma_f32_16x16x32_bf16 v[164:167], a[64:67], a[28:31], v[164:167]
v_cvt_pk_bf16_f32 v180, v152, v153
v_cvt_pk_bf16_f32 v181, v154, v155
v_cvt_pk_bf16_f32 v182, v156, v157
v_cvt_pk_bf16_f32 v183, v158, v159
v_mfma_f32_16x16x32_bf16 v[160:163], a[48:51], a[28:31], v[36:39]
v_mfma_f32_16x16x32_bf16 v[160:163], a[44:47], a[24:27], v[160:163]
v_mfma_f32_16x16x32_bf16 v[160:163], a[40:43], a[20:23], v[160:163]
v_mfma_f32_16x16x32_bf16 v[160:163], a[36:39], a[16:19], v[160:163]
v_mfma_f32_16x16x32_bf16 v[168:171], a[36:39], v[236:239], v[40:43]
buffer_load_dwordx4 v2, s[12:15], s24 offen offset:0 nt lds
v_mfma_f32_16x16x32_bf16 v[168:171], a[40:43], v[240:243], v[168:171]
s_add_u32 m0, m0, 8
v_mfma_f32_16x16x32_bf16 v[168:171], a[44:47], v[244:247], v[168:171]
buffer_load_dwordx4 v2, s[12:15], s24 offen offset:1024 nt lds
v_exp_f32 v164, v164
v_exp_f32 v165, v165
v_exp_f32 v166, v166
v_exp_f32 v167, v167
v_exp_f32 v160, v160
v_exp_f32 v161, v161
v_exp_f32 v162, v162
v_exp_f32 v163, v163
v_mfma_f32_16x16x32_bf16 v[168:171], a[48:51], v[248:251], v[168:171]
s_xor_b32 s24, s98, 20480
v_cvt_pk_bf16_f32 v202, v164, v165
v_cvt_pk_bf16_f32 v203, v166, v167
v_cvt_pk_bf16_f32 v200, v160, v161
v_cvt_pk_bf16_f32 v201, v162, v163
v_mfma_f32_16x16x32_bf16 v[172:175], a[64:67], v[248:251], v[40:43]
s_add_u32 m0, s23, 126720
v_mfma_f32_16x16x32_bf16 v[172:175], a[60:63], v[244:247], v[172:175]
v_mfma_f32_16x16x32_bf16 v[172:175], a[56:59], v[240:243], v[172:175]
v_mfma_f32_16x16x32_bf16 v[172:175], a[52:55], v[236:239], v[172:175]
v_mfma_f32_16x16x32_bf16 v[140:143], a[32:35], v[176:179], v[140:143]
s_waitcnt vmcnt(8)
s_barrier
v_mfma_f32_16x16x32_bf16 v[144:147], a[32:35], v[196:199], v[144:147]
ds_read_b64_tr_b16 a[164:165], v10 offset:25344
ds_read_b64_tr_b16 a[166:167], v10 offset:25856
s_waitcnt lgkmcnt(0)
ds_read_b64_tr_b16 a[168:169], v10 offset:25352
ds_read_b64_tr_b16 a[170:171], v10 offset:25864
ds_read_b64_tr_b16 a[172:173], v10 offset:25360
ds_read_b64_tr_b16 a[174:175], v10 offset:25872
ds_read_b64_tr_b16 a[176:177], v10 offset:25368
ds_read_b64_tr_b16 a[178:179], v10 offset:25880
ds_read_b64_tr_b16 a[180:181], v10 offset:25472
ds_read_b64_tr_b16 a[182:183], v10 offset:25984
ds_read_b64_tr_b16 a[184:185], v10 offset:25480
ds_read_b64_tr_b16 a[186:187], v10 offset:25992
ds_read_b64_tr_b16 a[188:189], v10 offset:25488
ds_read_b64_tr_b16 a[190:191], v10 offset:26000
ds_read_b64_tr_b16 a[192:193], v10 offset:25496
ds_read_b64_tr_b16 a[194:195], v10 offset:26008
v_mfma_f32_16x16x32_bf16 v[148:151], a[32:35], v[216:219], v[148:151]
ds_read_b128 a[68:71], v7 offset:16896
ds_read_b128 a[72:75], v7 offset:16960
ds_read_b128 a[76:79], v7 offset:17024
v_exp_f32 v168, v168
v_exp_f32 v169, v169
v_exp_f32 v170, v170
v_exp_f32 v171, v171
v_exp_f32 v172, v172
v_mfma_f32_16x16x32_bf16 v[44:47], a[164:167], v[184:187], v[44:47]
ds_read_b128 a[80:83], v7 offset:17088
ds_read_b128 a[96:99], v7 offset:17600
v_cvt_pk_bf16_f32 v220, v168, v169
v_mfma_f32_16x16x32_bf16 v[76:79], a[164:167], v[204:207], v[76:79]
s_waitcnt lgkmcnt(15)
ds_read_b128 a[92:95], v7 offset:17536
v_exp_f32 v173, v173
v_mfma_f32_16x16x32_bf16 v[108:111], a[164:167], v[224:227], v[108:111]
ds_read_b128 a[88:91], v7 offset:17472
v_exp_f32 v174, v174
v_mfma_f32_16x16x32_bf16 v[112:115], a[168:171], v[224:227], v[112:115]
v_exp_f32 v175, v175
v_cvt_pk_bf16_f32 v221, v170, v171
v_mfma_f32_16x16x32_bf16 v[80:83], a[168:171], v[204:207], v[80:83]
s_waitcnt lgkmcnt(15)
ds_read_b128 a[84:87], v7 offset:17408
v_cvt_pk_bf16_f32 v222, v172, v173
v_cvt_pk_bf16_f32 v223, v174, v175
v_mfma_f32_16x16x32_bf16 v[48:51], a[168:171], v[184:187], v[48:51]
v_mfma_f32_16x16x32_bf16 v[52:55], a[172:175], v[184:187], v[52:55]
v_mfma_f32_16x16x32_bf16 v[84:87], a[172:175], v[204:207], v[84:87]
v_mfma_f32_16x16x32_bf16 v[116:119], a[172:175], v[224:227], v[116:119]
v_mfma_f32_16x16x32_bf16 v[120:123], a[176:179], v[224:227], v[120:123]
v_mfma_f32_16x16x32_bf16 v[88:91], a[176:179], v[204:207], v[88:91]
s_waitcnt lgkmcnt(8)
v_mfma_f32_16x16x32_bf16 v[56:59], a[176:179], v[184:187], v[56:59]
v_mfma_f32_16x16x32_bf16 v[60:63], a[180:183], v[184:187], v[60:63]
v_mfma_f32_16x16x32_bf16 v[92:95], a[180:183], v[204:207], v[92:95]
v_mfma_f32_16x16x32_bf16 v[124:127], a[180:183], v[224:227], v[124:127]
v_mfma_f32_16x16x32_bf16 v[128:131], a[184:187], v[224:227], v[128:131]
v_mfma_f32_16x16x32_bf16 v[96:99], a[184:187], v[204:207], v[96:99]
buffer_load_dwordx4 v2, s[8:11], s24 offen offset:0 nt lds
v_mfma_f32_16x16x32_bf16 v[64:67], a[184:187], v[184:187], v[64:67]
s_add_u32 m0, m0, 32
v_mfma_f32_16x16x32_bf16 v[68:71], a[188:191], v[184:187], v[68:71]
buffer_load_dwordx4 v2, s[8:11], s24 offen offset:1024 nt lds
v_mfma_f32_16x16x32_bf16 v[100:103], a[188:191], v[204:207], v[100:103]
s_xor_b32 s24, s98, 10240
v_mfma_f32_16x16x32_bf16 v[132:135], a[188:191], v[224:227], v[132:135]
s_add_u32 m0, s29, 135168
v_mfma_f32_16x16x32_bf16 v[136:139], a[192:195], v[224:227], v[136:139]
v_mfma_f32_16x16x32_bf16 v[104:107], a[192:195], v[204:207], v[104:107]
s_waitcnt lgkmcnt(4)
v_mfma_f32_16x16x32_bf16 v[72:75], a[192:195], v[184:187], v[72:75]
v_mfma_f32_16x16x32_bf16 v[152:155], a[68:71], a[0:3], v[32:35]
v_mfma_f32_16x16x32_bf16 v[152:155], a[72:75], a[4:7], v[152:155]
v_mfma_f32_16x16x32_bf16 v[152:155], a[76:79], a[8:11], v[152:155]
s_waitcnt lgkmcnt(0)
v_mfma_f32_16x16x32_bf16 v[152:155], a[80:83], a[12:15], v[152:155]
v_mfma_f32_16x16x32_bf16 v[156:159], a[96:99], a[12:15], v[32:35]
v_mfma_f32_16x16x32_bf16 v[156:159], a[92:95], a[8:11], v[156:159]
v_mfma_f32_16x16x32_bf16 v[156:159], a[88:91], a[4:7], v[156:159]
v_mfma_f32_16x16x32_bf16 v[156:159], a[84:87], a[0:3], v[156:159]
v_mfma_f32_16x16x32_bf16 v[164:167], a[84:87], a[16:19], v[36:39]
v_mfma_f32_16x16x32_bf16 v[164:167], a[88:91], a[20:23], v[164:167]
v_mfma_f32_16x16x32_bf16 v[164:167], a[92:95], a[24:27], v[164:167]
v_exp_f32 v152, v152
v_exp_f32 v153, v153
v_exp_f32 v154, v154
v_exp_f32 v155, v155
v_exp_f32 v156, v156
v_exp_f32 v157, v157
v_exp_f32 v158, v158
v_exp_f32 v159, v159
v_mfma_f32_16x16x32_bf16 v[164:167], a[96:99], a[28:31], v[164:167]
v_cvt_pk_bf16_f32 v184, v152, v153
v_cvt_pk_bf16_f32 v185, v154, v155
v_cvt_pk_bf16_f32 v186, v156, v157
v_cvt_pk_bf16_f32 v187, v158, v159
v_mfma_f32_16x16x32_bf16 v[160:163], a[80:83], a[28:31], v[36:39]
v_mfma_f32_16x16x32_bf16 v[160:163], a[76:79], a[24:27], v[160:163]
v_mfma_f32_16x16x32_bf16 v[160:163], a[72:75], a[20:23], v[160:163]
v_mfma_f32_16x16x32_bf16 v[160:163], a[68:71], a[16:19], v[160:163]
v_mfma_f32_16x16x32_bf16 v[168:171], a[68:71], v[236:239], v[40:43]
buffer_load_dwordx4 v2, s[12:15], s24 offen offset:0 nt lds
v_mfma_f32_16x16x32_bf16 v[168:171], a[72:75], v[240:243], v[168:171]
s_add_u32 m0, m0, 8
v_mfma_f32_16x16x32_bf16 v[168:171], a[76:79], v[244:247], v[168:171]
buffer_load_dwordx4 v2, s[12:15], s24 offen offset:1024 nt lds
v_exp_f32 v164, v164
v_exp_f32 v165, v165
v_exp_f32 v166, v166
v_exp_f32 v167, v167
v_exp_f32 v160, v160
v_exp_f32 v161, v161
v_exp_f32 v162, v162
v_exp_f32 v163, v163
v_mfma_f32_16x16x32_bf16 v[168:171], a[80:83], v[248:251], v[168:171]
s_xor_b32 s24, s98, 22528
v_cvt_pk_bf16_f32 v206, v164, v165
v_cvt_pk_bf16_f32 v207, v166, v167
v_cvt_pk_bf16_f32 v204, v160, v161
v_cvt_pk_bf16_f32 v205, v162, v163
v_mfma_f32_16x16x32_bf16 v[172:175], a[96:99], v[248:251], v[40:43]
s_add_u32 m0, s23, 143616
v_mfma_f32_16x16x32_bf16 v[172:175], a[92:95], v[244:247], v[172:175]
s_waitcnt vmcnt(8)
s_barrier
v_mfma_f32_16x16x32_bf16 v[172:175], a[88:91], v[240:243], v[172:175]
ds_read_b64_tr_b16 a[196:197], v10 offset:42240
ds_read_b64_tr_b16 a[198:199], v10 offset:42752
ds_read_b64_tr_b16 a[200:201], v10 offset:42248
ds_read_b64_tr_b16 a[202:203], v10 offset:42760
ds_read_b64_tr_b16 a[204:205], v10 offset:42256
ds_read_b64_tr_b16 a[206:207], v10 offset:42768
ds_read_b64_tr_b16 a[208:209], v10 offset:42264
ds_read_b64_tr_b16 a[210:211], v10 offset:42776
ds_read_b64_tr_b16 a[212:213], v10 offset:42368
ds_read_b64_tr_b16 a[214:215], v10 offset:42880
ds_read_b64_tr_b16 a[216:217], v10 offset:42376
v_mfma_f32_16x16x32_bf16 v[172:175], a[84:87], v[236:239], v[172:175]
ds_read_b64_tr_b16 a[218:219], v10 offset:42888
ds_read_b64_tr_b16 a[220:221], v10 offset:42384
v_mfma_f32_16x16x32_bf16 v[140:143], a[32:35], v[180:183], v[140:143]
ds_read_b64_tr_b16 a[222:223], v10 offset:42896
ds_read_b64_tr_b16 a[224:225], v10 offset:42392
ds_read_b64_tr_b16 a[226:227], v10 offset:42904
v_mfma_f32_16x16x32_bf16 v[144:147], a[32:35], v[200:203], v[144:147]
s_waitcnt lgkmcnt(14)
ds_read_b128 a[36:39], v7 offset:33792
v_mfma_f32_16x16x32_bf16 v[148:151], a[32:35], v[220:223], v[148:151]
ds_read_b128 a[40:43], v7 offset:33856
v_exp_f32 v168, v168
v_mfma_f32_16x16x32_bf16 v[44:47], a[196:199], v[188:191], v[44:47]
ds_read_b128 a[44:47], v7 offset:33920
v_exp_f32 v169, v169
v_mfma_f32_16x16x32_bf16 v[76:79], a[196:199], v[208:211], v[76:79]
s_waitcnt lgkmcnt(15)
ds_read_b128 a[48:51], v7 offset:33984
v_exp_f32 v170, v170
v_mfma_f32_16x16x32_bf16 v[108:111], a[196:199], v[228:231], v[108:111]
v_exp_f32 v171, v171
v_mfma_f32_16x16x32_bf16 v[112:115], a[200:203], v[228:231], v[112:115]
ds_read_b128 a[64:67], v7 offset:34496
v_exp_f32 v172, v172
v_mfma_f32_16x16x32_bf16 v[80:83], a[200:203], v[208:211], v[80:83]
s_waitcnt lgkmcnt(13)
ds_read_b128 a[60:63], v7 offset:34432
v_exp_f32 v173, v173
v_mfma_f32_16x16x32_bf16 v[48:51], a[200:203], v[188:191], v[48:51]
ds_read_b128 a[56:59], v7 offset:34368
v_cvt_pk_bf16_f32 v224, v168, v169
v_mfma_f32_16x16x32_bf16 v[52:55], a[204:207], v[188:191], v[52:55]
v_exp_f32 v174, v174
v_cvt_pk_bf16_f32 v225, v170, v171
v_mfma_f32_16x16x32_bf16 v[84:87], a[204:207], v[208:211], v[84:87]
ds_read_b128 a[52:55], v7 offset:34304
v_exp_f32 v175, v175
v_mfma_f32_16x16x32_bf16 v[116:119], a[204:207], v[228:231], v[116:119]
v_cvt_pk_bf16_f32 v226, v172, v173
v_cvt_pk_bf16_f32 v227, v174, v175
v_mfma_f32_16x16x32_bf16 v[120:123], a[208:211], v[228:231], v[120:123]
v_mfma_f32_16x16x32_bf16 v[88:91], a[208:211], v[208:211], v[88:91]
s_waitcnt lgkmcnt(8)
v_mfma_f32_16x16x32_bf16 v[56:59], a[208:211], v[188:191], v[56:59]
v_mfma_f32_16x16x32_bf16 v[60:63], a[212:215], v[188:191], v[60:63]
buffer_load_dwordx4 v2, s[8:11], s24 offen offset:0 nt lds
v_mfma_f32_16x16x32_bf16 v[92:95], a[212:215], v[208:211], v[92:95]
s_add_u32 m0, m0, 32
v_mfma_f32_16x16x32_bf16 v[124:127], a[212:215], v[228:231], v[124:127]
buffer_load_dwordx4 v2, s[8:11], s24 offen offset:1024 nt lds
v_mfma_f32_16x16x32_bf16 v[128:131], a[216:219], v[228:231], v[128:131]
s_xor_b32 s24, s98, 12288
v_mfma_f32_16x16x32_bf16 v[96:99], a[216:219], v[208:211], v[96:99]
s_add_u32 m0, s29, 152064
v_mfma_f32_16x16x32_bf16 v[64:67], a[216:219], v[188:191], v[64:67]
v_mfma_f32_16x16x32_bf16 v[68:71], a[220:223], v[188:191], v[68:71]
v_mfma_f32_16x16x32_bf16 v[100:103], a[220:223], v[208:211], v[100:103]
v_mfma_f32_16x16x32_bf16 v[132:135], a[220:223], v[228:231], v[132:135]
v_mfma_f32_16x16x32_bf16 v[136:139], a[224:227], v[228:231], v[136:139]
v_mfma_f32_16x16x32_bf16 v[104:107], a[224:227], v[208:211], v[104:107]
s_waitcnt lgkmcnt(4)
v_mfma_f32_16x16x32_bf16 v[72:75], a[224:227], v[188:191], v[72:75]
v_mfma_f32_16x16x32_bf16 v[152:155], a[36:39], a[0:3], v[32:35]
v_mfma_f32_16x16x32_bf16 v[152:155], a[40:43], a[4:7], v[152:155]
v_mfma_f32_16x16x32_bf16 v[152:155], a[44:47], a[8:11], v[152:155]
s_waitcnt lgkmcnt(0)
v_mfma_f32_16x16x32_bf16 v[152:155], a[48:51], a[12:15], v[152:155]
v_mfma_f32_16x16x32_bf16 v[156:159], a[64:67], a[12:15], v[32:35]
v_mfma_f32_16x16x32_bf16 v[156:159], a[60:63], a[8:11], v[156:159]
v_mfma_f32_16x16x32_bf16 v[156:159], a[56:59], a[4:7], v[156:159]
v_mfma_f32_16x16x32_bf16 v[156:159], a[52:55], a[0:3], v[156:159]
v_mfma_f32_16x16x32_bf16 v[164:167], a[52:55], a[16:19], v[36:39]
v_mfma_f32_16x16x32_bf16 v[164:167], a[56:59], a[20:23], v[164:167]
v_mfma_f32_16x16x32_bf16 v[164:167], a[60:63], a[24:27], v[164:167]
v_exp_f32 v152, v152
v_exp_f32 v153, v153
v_exp_f32 v154, v154
v_exp_f32 v155, v155
v_exp_f32 v156, v156
v_exp_f32 v157, v157
v_exp_f32 v158, v158
v_exp_f32 v159, v159
v_mfma_f32_16x16x32_bf16 v[164:167], a[64:67], a[28:31], v[164:167]
v_cvt_pk_bf16_f32 v188, v152, v153
v_cvt_pk_bf16_f32 v189, v154, v155
v_cvt_pk_bf16_f32 v190, v156, v157
v_cvt_pk_bf16_f32 v191, v158, v159
v_mfma_f32_16x16x32_bf16 v[160:163], a[48:51], a[28:31], v[36:39]
v_mfma_f32_16x16x32_bf16 v[160:163], a[44:47], a[24:27], v[160:163]
v_mfma_f32_16x16x32_bf16 v[160:163], a[40:43], a[20:23], v[160:163]
v_mfma_f32_16x16x32_bf16 v[160:163], a[36:39], a[16:19], v[160:163]
v_mfma_f32_16x16x32_bf16 v[168:171], a[36:39], v[236:239], v[40:43]
buffer_load_dwordx4 v2, s[12:15], s24 offen offset:0 nt lds
v_mfma_f32_16x16x32_bf16 v[168:171], a[40:43], v[240:243], v[168:171]
s_add_u32 m0, m0, 8
v_mfma_f32_16x16x32_bf16 v[168:171], a[44:47], v[244:247], v[168:171]
v_exp_f32 v164, v164
v_exp_f32 v165, v165
v_exp_f32 v166, v166
v_exp_f32 v167, v167
v_mfma_f32_16x16x32_bf16 v[168:171], a[48:51], v[248:251], v[168:171]
s_waitcnt vmcnt(7)
s_barrier
v_mfma_f32_16x16x32_bf16 v[172:175], a[64:67], v[248:251], v[40:43]
ds_read_b64_tr_b16 a[100:101], v11 offset:0
ds_read_b64_tr_b16 a[102:103], v11 offset:512
buffer_load_dwordx4 v2, s[12:15], s24 offen offset:1024 nt lds
v_mfma_f32_16x16x32_bf16 v[172:175], a[60:63], v[244:247], v[172:175]
s_xor_b32 s24, s98, 24576
ds_read_b64_tr_b16 a[104:105], v11 offset:8
ds_read_b64_tr_b16 a[106:107], v11 offset:520
ds_read_b64_tr_b16 a[108:109], v11 offset:16
v_mfma_f32_16x16x32_bf16 v[172:175], a[56:59], v[240:243], v[172:175]
s_add_u32 m0, s23, 0
ds_read_b64_tr_b16 a[110:111], v11 offset:528
ds_read_b64_tr_b16 a[112:113], v11 offset:24
v_mfma_f32_16x16x32_bf16 v[172:175], a[52:55], v[236:239], v[172:175]
ds_read_b64_tr_b16 a[114:115], v11 offset:536
ds_read_b64_tr_b16 a[116:117], v11 offset:128
ds_read_b64_tr_b16 a[118:119], v11 offset:640
v_mfma_f32_16x16x32_bf16 v[140:143], a[32:35], v[184:187], v[140:143]
ds_read_b64_tr_b16 a[120:121], v11 offset:136
ds_read_b64_tr_b16 a[122:123], v11 offset:648
v_mfma_f32_16x16x32_bf16 v[144:147], a[32:35], v[204:207], v[144:147]
s_waitcnt lgkmcnt(10)
ds_read_b64_tr_b16 a[124:125], v11 offset:144
ds_read_b64_tr_b16 a[126:127], v11 offset:656
ds_read_b64_tr_b16 a[128:129], v11 offset:152
v_mfma_f32_16x16x32_bf16 v[148:151], a[32:35], v[224:227], v[148:151]
ds_read_b128 a[68:71], v7 offset:50688
ds_read_b128 a[72:75], v7 offset:50752
ds_read_b64_tr_b16 a[130:131], v11 offset:664
v_mfma_f32_16x16x32_bf16 v[44:47], a[100:103], v[192:195], v[44:47]
ds_read_b128 a[76:79], v7 offset:50816
v_cvt_pk_bf16_f32 v210, v164, v165
v_mfma_f32_16x16x32_bf16 v[76:79], a[100:103], v[212:215], v[76:79]
s_waitcnt lgkmcnt(15)
ds_read_b128 a[80:83], v7 offset:50880
v_exp_f32 v160, v160
v_mfma_f32_16x16x32_bf16 v[108:111], a[100:103], v[232:235], v[108:111]
ds_read_b128 a[96:99], v7 offset:51392
v_cvt_pk_bf16_f32 v211, v166, v167
v_mfma_f32_16x16x32_bf16 v[112:115], a[104:107], v[232:235], v[112:115]
v_exp_f32 v161, v161
v_mfma_f32_16x16x32_bf16 v[80:83], a[104:107], v[212:215], v[80:83]
s_waitcnt lgkmcnt(13)
ds_read_b128 a[92:95], v7 offset:51328
v_exp_f32 v162, v162
v_mfma_f32_16x16x32_bf16 v[48:51], a[104:107], v[192:195], v[48:51]
ds_read_b128 a[88:91], v7 offset:51264
v_exp_f32 v163, v163
v_mfma_f32_16x16x32_bf16 v[52:55], a[108:111], v[192:195], v[52:55]
ds_read_b128 a[84:87], v7 offset:51200
v_cvt_pk_bf16_f32 v208, v160, v161
v_cvt_pk_bf16_f32 v209, v162, v163
v_mfma_f32_16x16x32_bf16 v[84:87], a[108:111], v[212:215], v[84:87]
v_exp_f32 v168, v168
v_mfma_f32_16x16x32_bf16 v[116:119], a[108:111], v[232:235], v[116:119]
v_exp_f32 v169, v169
v_mfma_f32_16x16x32_bf16 v[120:123], a[112:115], v[232:235], v[120:123]
v_exp_f32 v170, v170
v_cvt_pk_bf16_f32 v228, v168, v169
v_mfma_f32_16x16x32_bf16 v[88:91], a[112:115], v[212:215], v[88:91]
s_waitcnt lgkmcnt(6)
v_exp_f32 v171, v171
v_mfma_f32_16x16x32_bf16 v[56:59], a[112:115], v[192:195], v[56:59]
v_exp_f32 v172, v172
v_cvt_pk_bf16_f32 v229, v170, v171
v_mfma_f32_16x16x32_bf16 v[60:63], a[116:119], v[192:195], v[60:63]
buffer_load_dwordx4 v2, s[8:11], s24 offen offset:0 nt lds
v_mfma_f32_16x16x32_bf16 v[92:95], a[116:119], v[212:215], v[92:95]
s_add_u32 m0, m0, 32
v_exp_f32 v173, v173
v_mfma_f32_16x16x32_bf16 v[124:127], a[116:119], v[232:235], v[124:127]
buffer_load_dwordx4 v2, s[8:11], s24 offen offset:1024 nt lds
v_exp_f32 v174, v174
v_mfma_f32_16x16x32_bf16 v[128:131], a[120:123], v[232:235], v[128:131]
s_xor_b32 s24, s98, 14336
v_exp_f32 v175, v175
v_cvt_pk_bf16_f32 v230, v172, v173
v_mfma_f32_16x16x32_bf16 v[96:99], a[120:123], v[212:215], v[96:99]
s_add_u32 m0, s29, 8448
v_cvt_pk_bf16_f32 v231, v174, v175
v_mfma_f32_16x16x32_bf16 v[64:67], a[120:123], v[192:195], v[64:67]
v_mfma_f32_16x16x32_bf16 v[68:71], a[124:127], v[192:195], v[68:71]
v_mfma_f32_16x16x32_bf16 v[100:103], a[124:127], v[212:215], v[100:103]
v_mfma_f32_16x16x32_bf16 v[132:135], a[124:127], v[232:235], v[132:135]
v_mfma_f32_16x16x32_bf16 v[136:139], a[128:131], v[232:235], v[136:139]
v_mfma_f32_16x16x32_bf16 v[104:107], a[128:131], v[212:215], v[104:107]
s_waitcnt lgkmcnt(4)
v_mfma_f32_16x16x32_bf16 v[72:75], a[128:131], v[192:195], v[72:75]
v_mfma_f32_16x16x32_bf16 v[152:155], a[68:71], a[0:3], v[32:35]
v_mfma_f32_16x16x32_bf16 v[152:155], a[72:75], a[4:7], v[152:155]
v_mfma_f32_16x16x32_bf16 v[152:155], a[76:79], a[8:11], v[152:155]
s_waitcnt lgkmcnt(0)
v_mfma_f32_16x16x32_bf16 v[152:155], a[80:83], a[12:15], v[152:155]
v_mfma_f32_16x16x32_bf16 v[156:159], a[96:99], a[12:15], v[32:35]
v_mfma_f32_16x16x32_bf16 v[156:159], a[92:95], a[8:11], v[156:159]
v_mfma_f32_16x16x32_bf16 v[156:159], a[88:91], a[4:7], v[156:159]
v_mfma_f32_16x16x32_bf16 v[156:159], a[84:87], a[0:3], v[156:159]
v_mfma_f32_16x16x32_bf16 v[164:167], a[84:87], a[16:19], v[36:39]
v_mfma_f32_16x16x32_bf16 v[164:167], a[88:91], a[20:23], v[164:167]
v_mfma_f32_16x16x32_bf16 v[164:167], a[92:95], a[24:27], v[164:167]
v_exp_f32 v152, v152
v_exp_f32 v153, v153
v_exp_f32 v154, v154
v_exp_f32 v155, v155
v_exp_f32 v156, v156
v_exp_f32 v157, v157
v_mfma_f32_16x16x32_bf16 v[164:167], a[96:99], a[28:31], v[164:167]
v_exp_f32 v158, v158
v_cvt_pk_bf16_f32 v192, v152, v153
v_mfma_f32_16x16x32_bf16 v[160:163], a[80:83], a[28:31], v[36:39]
v_exp_f32 v159, v159
v_cvt_pk_bf16_f32 v193, v154, v155
v_mfma_f32_16x16x32_bf16 v[160:163], a[76:79], a[24:27], v[160:163]
v_cvt_pk_bf16_f32 v194, v156, v157
v_cvt_pk_bf16_f32 v195, v158, v159
v_mfma_f32_16x16x32_bf16 v[160:163], a[72:75], a[20:23], v[160:163]
v_mfma_f32_16x16x32_bf16 v[160:163], a[68:71], a[16:19], v[160:163]
v_mfma_f32_16x16x32_bf16 v[168:171], a[68:71], v[236:239], v[40:43]
buffer_load_dwordx4 v2, s[12:15], s24 offen offset:0 nt lds
v_mfma_f32_16x16x32_bf16 v[168:171], a[72:75], v[240:243], v[168:171]
s_add_u32 m0, m0, 8
v_mfma_f32_16x16x32_bf16 v[168:171], a[76:79], v[244:247], v[168:171]
v_exp_f32 v164, v164
v_exp_f32 v165, v165
v_mfma_f32_16x16x32_bf16 v[168:171], a[80:83], v[248:251], v[168:171]
s_waitcnt vmcnt(7)
s_barrier
v_mfma_f32_16x16x32_bf16 v[172:175], a[96:99], v[248:251], v[40:43]
ds_read_b64_tr_b16 a[132:133], v11 offset:16896
ds_read_b64_tr_b16 a[134:135], v11 offset:17408
buffer_load_dwordx4 v2, s[12:15], s24 offen offset:1024 nt lds
v_mfma_f32_16x16x32_bf16 v[172:175], a[92:95], v[244:247], v[172:175]
s_xor_b32 s24, s98, 26624
ds_read_b64_tr_b16 a[136:137], v11 offset:16904
ds_read_b64_tr_b16 a[138:139], v11 offset:17416
ds_read_b64_tr_b16 a[140:141], v11 offset:16912
v_mfma_f32_16x16x32_bf16 v[172:175], a[88:91], v[240:243], v[172:175]
s_add_u32 m0, s23, 16896
ds_read_b64_tr_b16 a[142:143], v11 offset:17424
ds_read_b64_tr_b16 a[144:145], v11 offset:16920
ds_read_b64_tr_b16 a[146:147], v11 offset:17432
v_mfma_f32_16x16x32_bf16 v[172:175], a[84:87], v[236:239], v[172:175]
ds_read_b64_tr_b16 a[148:149], v11 offset:17024
ds_read_b64_tr_b16 a[150:151], v11 offset:17536
v_mfma_f32_16x16x32_bf16 v[140:143], a[32:35], v[188:191], v[140:143]
ds_read_b64_tr_b16 a[152:153], v11 offset:17032
ds_read_b64_tr_b16 a[154:155], v11 offset:17544
ds_read_b64_tr_b16 a[156:157], v11 offset:17040
v_mfma_f32_16x16x32_bf16 v[144:147], a[32:35], v[208:211], v[144:147]
s_waitcnt lgkmcnt(11)
ds_read_b64_tr_b16 a[158:159], v11 offset:17552
ds_read_b64_tr_b16 a[160:161], v11 offset:17048
ds_read_b64_tr_b16 a[162:163], v11 offset:17560
v_mfma_f32_16x16x32_bf16 v[148:151], a[32:35], v[228:231], v[148:151]
ds_read_b128 a[36:39], v8 offset:8448
ds_read_b128 a[40:43], v8 offset:8512
v_mfma_f32_16x16x32_bf16 v[44:47], a[132:135], v[176:179], v[44:47]
ds_read_b128 a[44:47], v8 offset:8576
v_exp_f32 v166, v166
v_mfma_f32_16x16x32_bf16 v[76:79], a[132:135], v[196:199], v[76:79]
s_waitcnt lgkmcnt(15)
ds_read_b128 a[48:51], v8 offset:8640
v_exp_f32 v167, v167
v_mfma_f32_16x16x32_bf16 v[108:111], a[132:135], v[216:219], v[108:111]
ds_read_b128 a[64:67], v8 offset:9152
v_cvt_pk_bf16_f32 v214, v164, v165
v_mfma_f32_16x16x32_bf16 v[112:115], a[136:139], v[216:219], v[112:115]
ds_read_b128 a[60:63], v8 offset:9088
v_exp_f32 v160, v160
v_mfma_f32_16x16x32_bf16 v[80:83], a[136:139], v[196:199], v[80:83]
s_waitcnt lgkmcnt(14)
v_exp_f32 v161, v161
v_cvt_pk_bf16_f32 v215, v166, v167
v_mfma_f32_16x16x32_bf16 v[48:51], a[136:139], v[176:179], v[48:51]
ds_read_b128 a[56:59], v8 offset:9024
v_cvt_pk_bf16_f32 v212, v160, v161
v_mfma_f32_16x16x32_bf16 v[52:55], a[140:143], v[176:179], v[52:55]
ds_read_b128 a[52:55], v8 offset:8960
v_exp_f32 v162, v162
v_mfma_f32_16x16x32_bf16 v[84:87], a[140:143], v[196:199], v[84:87]
v_exp_f32 v163, v163
v_mfma_f32_16x16x32_bf16 v[116:119], a[140:143], v[216:219], v[116:119]
v_cvt_pk_bf16_f32 v213, v162, v163
v_exp_f32 v168, v168
v_mfma_f32_16x16x32_bf16 v[120:123], a[144:147], v[216:219], v[120:123]
v_exp_f32 v169, v169
v_mfma_f32_16x16x32_bf16 v[88:91], a[144:147], v[196:199], v[88:91]
s_waitcnt lgkmcnt(8)
v_exp_f32 v170, v170
v_exp_f32 v171, v171
v_mfma_f32_16x16x32_bf16 v[56:59], a[144:147], v[176:179], v[56:59]
v_exp_f32 v172, v172
v_cvt_pk_bf16_f32 v232, v168, v169
v_mfma_f32_16x16x32_bf16 v[60:63], a[148:151], v[176:179], v[60:63]
buffer_load_dwordx4 v2, s[8:11], s24 offen offset:0 nt lds
v_mfma_f32_16x16x32_bf16 v[92:95], a[148:151], v[196:199], v[92:95]
s_add_u32 m0, m0, 32
v_exp_f32 v173, v173
v_cvt_pk_bf16_f32 v233, v170, v171
v_mfma_f32_16x16x32_bf16 v[124:127], a[148:151], v[216:219], v[124:127]
buffer_load_dwordx4 v2, s[8:11], s24 offen offset:1024 nt lds
v_cvt_pk_bf16_f32 v234, v172, v173
v_mfma_f32_16x16x32_bf16 v[128:131], a[152:155], v[216:219], v[128:131]
s_xor_b32 s24, s98, 16384
v_exp_f32 v174, v174
v_mfma_f32_16x16x32_bf16 v[96:99], a[152:155], v[196:199], v[96:99]
s_add_u32 m0, s29, 25344
v_exp_f32 v175, v175
v_mfma_f32_16x16x32_bf16 v[64:67], a[152:155], v[176:179], v[64:67]
v_cvt_pk_bf16_f32 v235, v174, v175
v_mfma_f32_16x16x32_bf16 v[68:71], a[156:159], v[176:179], v[68:71]
v_mfma_f32_16x16x32_bf16 v[100:103], a[156:159], v[196:199], v[100:103]
v_mfma_f32_16x16x32_bf16 v[132:135], a[156:159], v[216:219], v[132:135]
v_mfma_f32_16x16x32_bf16 v[136:139], a[160:163], v[216:219], v[136:139]
v_mfma_f32_16x16x32_bf16 v[104:107], a[160:163], v[196:199], v[104:107]
s_waitcnt lgkmcnt(4)
v_mfma_f32_16x16x32_bf16 v[72:75], a[160:163], v[176:179], v[72:75]
v_mfma_f32_16x16x32_bf16 v[152:155], a[36:39], a[0:3], v[32:35]
v_mfma_f32_16x16x32_bf16 v[152:155], a[40:43], a[4:7], v[152:155]
v_mfma_f32_16x16x32_bf16 v[152:155], a[44:47], a[8:11], v[152:155]
s_waitcnt lgkmcnt(0)
v_mfma_f32_16x16x32_bf16 v[152:155], a[48:51], a[12:15], v[152:155]
v_mfma_f32_16x16x32_bf16 v[156:159], a[64:67], a[12:15], v[32:35]
v_mfma_f32_16x16x32_bf16 v[156:159], a[60:63], a[8:11], v[156:159]
v_mfma_f32_16x16x32_bf16 v[156:159], a[56:59], a[4:7], v[156:159]
v_mfma_f32_16x16x32_bf16 v[156:159], a[52:55], a[0:3], v[156:159]
v_mfma_f32_16x16x32_bf16 v[164:167], a[52:55], a[16:19], v[36:39]
v_mfma_f32_16x16x32_bf16 v[164:167], a[56:59], a[20:23], v[164:167]
v_mfma_f32_16x16x32_bf16 v[164:167], a[60:63], a[24:27], v[164:167]
v_exp_f32 v152, v152
v_exp_f32 v153, v153
v_exp_f32 v154, v154
v_exp_f32 v155, v155
v_exp_f32 v156, v156
v_exp_f32 v157, v157
v_exp_f32 v158, v158
v_mfma_f32_16x16x32_bf16 v[164:167], a[64:67], a[28:31], v[164:167]
v_exp_f32 v159, v159
v_cvt_pk_bf16_f32 v176, v152, v153
v_cvt_pk_bf16_f32 v177, v154, v155
v_mfma_f32_16x16x32_bf16 v[160:163], a[48:51], a[28:31], v[36:39]
v_cvt_pk_bf16_f32 v178, v156, v157
v_cvt_pk_bf16_f32 v179, v158, v159
v_mfma_f32_16x16x32_bf16 v[160:163], a[44:47], a[24:27], v[160:163]
v_mfma_f32_16x16x32_bf16 v[160:163], a[40:43], a[20:23], v[160:163]
v_mfma_f32_16x16x32_bf16 v[160:163], a[36:39], a[16:19], v[160:163]
v_mfma_f32_16x16x32_bf16 v[168:171], a[36:39], v[236:239], v[40:43]
buffer_load_dwordx4 v2, s[12:15], s24 offen offset:0 nt lds
v_mfma_f32_16x16x32_bf16 v[168:171], a[40:43], v[240:243], v[168:171]
s_add_u32 m0, m0, 8
v_mfma_f32_16x16x32_bf16 v[168:171], a[44:47], v[244:247], v[168:171]
v_exp_f32 v164, v164
v_exp_f32 v165, v165
v_exp_f32 v166, v166
v_mfma_f32_16x16x32_bf16 v[168:171], a[48:51], v[248:251], v[168:171]
s_waitcnt vmcnt(7)
s_barrier
v_mfma_f32_16x16x32_bf16 v[172:175], a[64:67], v[248:251], v[40:43]
ds_read_b64_tr_b16 a[164:165], v11 offset:33792
ds_read_b64_tr_b16 a[166:167], v11 offset:34304
ds_read_b64_tr_b16 a[168:169], v11 offset:33800
v_mfma_f32_16x16x32_bf16 v[172:175], a[60:63], v[244:247], v[172:175]
ds_read_b64_tr_b16 a[170:171], v11 offset:34312
buffer_load_dwordx4 v2, s[12:15], s24 offen offset:1024 nt lds
v_mfma_f32_16x16x32_bf16 v[172:175], a[56:59], v[240:243], v[172:175]
s_xor_b32 s24, s98, 28672
ds_read_b64_tr_b16 a[172:173], v11 offset:33808
ds_read_b64_tr_b16 a[174:175], v11 offset:34320
v_mfma_f32_16x16x32_bf16 v[172:175], a[52:55], v[236:239], v[172:175]
s_add_u32 m0, s23, 33792
ds_read_b64_tr_b16 a[176:177], v11 offset:33816
ds_read_b64_tr_b16 a[178:179], v11 offset:34328
ds_read_b64_tr_b16 a[180:181], v11 offset:33920
v_mfma_f32_16x16x32_bf16 v[140:143], a[32:35], v[192:195], v[140:143]
ds_read_b64_tr_b16 a[182:183], v11 offset:34432
ds_read_b64_tr_b16 a[184:185], v11 offset:33928
v_mfma_f32_16x16x32_bf16 v[144:147], a[32:35], v[212:215], v[144:147]
s_waitcnt lgkmcnt(9)
ds_read_b64_tr_b16 a[186:187], v11 offset:34440
ds_read_b64_tr_b16 a[188:189], v11 offset:33936
ds_read_b64_tr_b16 a[190:191], v11 offset:34448
v_mfma_f32_16x16x32_bf16 v[148:151], a[32:35], v[232:235], v[148:151]
L_touch2_o2:
s_cbranch_scc1 L_touch_ret
ds_read_b64_tr_b16 a[192:193], v11 offset:33944
ds_read_b64_tr_b16 a[194:195], v11 offset:34456
v_mfma_f32_16x16x32_bf16 v[44:47], a[164:167], v[180:183], v[44:47]
ds_read_b128 a[68:71], v8 offset:25344
ds_read_b128 a[72:75], v8 offset:25408
ds_read_b128 a[76:79], v8 offset:25472
v_mfma_f32_16x16x32_bf16 v[76:79], a[164:167], v[200:203], v[76:79]
s_waitcnt lgkmcnt(15)
ds_read_b128 a[80:83], v8 offset:25536
v_cvt_pk_bf16_f32 v198, v164, v165
v_mfma_f32_16x16x32_bf16 v[108:111], a[164:167], v[220:223], v[108:111]
v_exp_f32 v167, v167
v_mfma_f32_16x16x32_bf16 v[112:115], a[168:171], v[220:223], v[112:115]
ds_read_b128 a[96:99], v8 offset:26048
v_exp_f32 v160, v160
v_mfma_f32_16x16x32_bf16 v[80:83], a[168:171], v[200:203], v[80:83]
s_waitcnt lgkmcnt(13)
ds_read_b128 a[92:95], v8 offset:25984
v_exp_f32 v161, v161
v_mfma_f32_16x16x32_bf16 v[48:51], a[168:171], v[180:183], v[48:51]
ds_read_b128 a[88:91], v8 offset:25920
v_cvt_pk_bf16_f32 v199, v166, v167
v_mfma_f32_16x16x32_bf16 v[52:55], a[172:175], v[180:183], v[52:55]
v_exp_f32 v162, v162
v_cvt_pk_bf16_f32 v196, v160, v161
v_mfma_f32_16x16x32_bf16 v[84:87], a[172:175], v[200:203], v[84:87]
v_exp_f32 v163, v163
v_mfma_f32_16x16x32_bf16 v[116:119], a[172:175], v[220:223], v[116:119]
ds_read_b128 a[84:87], v8 offset:25856
v_exp_f32 v168, v168
v_mfma_f32_16x16x32_bf16 v[120:123], a[176:179], v[220:223], v[120:123]
v_exp_f32 v169, v169
v_mfma_f32_16x16x32_bf16 v[88:91], a[176:179], v[200:203], v[88:91]
s_waitcnt lgkmcnt(8)
v_cvt_pk_bf16_f32 v197, v162, v163
v_exp_f32 v170, v170
v_mfma_f32_16x16x32_bf16 v[56:59], a[176:179], v[180:183], v[56:59]
v_exp_f32 v171, v171
v_mfma_f32_16x16x32_bf16 v[60:63], a[180:183], v[180:183], v[60:63]
buffer_load_dwordx4 v2, s[8:11], s24 offen offset:0 nt lds
v_cvt_pk_bf16_f32 v216, v168, v169
v_mfma_f32_16x16x32_bf16 v[92:95], a[180:183], v[200:203], v[92:95]
s_add_u32 m0, m0, 32
v_exp_f32 v172, v172
v_mfma_f32_16x16x32_bf16 v[124:127], a[180:183], v[220:223], v[124:127]
buffer_load_dwordx4 v2, s[8:11], s24 offen offset:1024 nt lds
v_cvt_pk_bf16_f32 v217, v170, v171
v_mfma_f32_16x16x32_bf16 v[128:131], a[184:187], v[220:223], v[128:131]
s_xor_b32 s24, s98, 18432
v_exp_f32 v173, v173
v_mfma_f32_16x16x32_bf16 v[96:99], a[184:187], v[200:203], v[96:99]
s_add_u32 m0, s29, 42240
v_exp_f32 v174, v174
v_cvt_pk_bf16_f32 v218, v172, v173
v_mfma_f32_16x16x32_bf16 v[64:67], a[184:187], v[180:183], v[64:67]
v_exp_f32 v175, v175
v_mfma_f32_16x16x32_bf16 v[68:71], a[188:191], v[180:183], v[68:71]
v_cvt_pk_bf16_f32 v219, v174, v175
v_mfma_f32_16x16x32_bf16 v[100:103], a[188:191], v[200:203], v[100:103]
v_mfma_f32_16x16x32_bf16 v[132:135], a[188:191], v[220:223], v[132:135]
v_mfma_f32_16x16x32_bf16 v[136:139], a[192:195], v[220:223], v[136:139]
v_mfma_f32_16x16x32_bf16 v[104:107], a[192:195], v[200:203], v[104:107]
s_waitcnt lgkmcnt(4)
v_mfma_f32_16x16x32_bf16 v[72:75], a[192:195], v[180:183], v[72:75]
v_mfma_f32_16x16x32_bf16 v[152:155], a[68:71], a[0:3], v[32:35]
v_mfma_f32_16x16x32_bf16 v[152:155], a[72:75], a[4:7], v[152:155]
v_mfma_f32_16x16x32_bf16 v[152:155], a[76:79], a[8:11], v[152:155]
s_waitcnt lgkmcnt(0)
v_mfma_f32_16x16x32_bf16 v[152:155], a[80:83], a[12:15], v[152:155]
v_mfma_f32_16x16x32_bf16 v[156:159], a[96:99], a[12:15], v[32:35]
v_mfma_f32_16x16x32_bf16 v[156:159], a[92:95], a[8:11], v[156:159]
v_mfma_f32_16x16x32_bf16 v[156:159], a[88:91], a[4:7], v[156:159]
v_mfma_f32_16x16x32_bf16 v[156:159], a[84:87], a[0:3], v[156:159]
v_mfma_f32_16x16x32_bf16 v[164:167], a[84:87], a[16:19], v[36:39]
v_mfma_f32_16x16x32_bf16 v[164:167], a[88:91], a[20:23], v[164:167]
v_mfma_f32_16x16x32_bf16 v[164:167], a[92:95], a[24:27], v[164:167]
v_exp_f32 v152, v152
v_exp_f32 v153, v153
v_exp_f32 v154, v154
v_exp_f32 v155, v155
v_exp_f32 v156, v156
v_mfma_f32_16x16x32_bf16 v[164:167], a[96:99], a[28:31], v[164:167]
v_exp_f32 v157, v157
v_cvt_pk_bf16_f32 v180, v152, v153
v_mfma_f32_16x16x32_bf16 v[160:163], a[80:83], a[28:31], v[36:39]
v_exp_f32 v158, v158
v_mfma_f32_16x16x32_bf16 v[160:163], a[76:79], a[24:27], v[160:163]
v_exp_f32 v159, v159
v_cvt_pk_bf16_f32 v181, v154, v155
v_mfma_f32_16x16x32_bf16 v[160:163], a[72:75], a[20:23], v[160:163]
v_cvt_pk_bf16_f32 v182, v156, v157
v_cvt_pk_bf16_f32 v183, v158, v159
v_mfma_f32_16x16x32_bf16 v[160:163], a[68:71], a[16:19], v[160:163]
v_mfma_f32_16x16x32_bf16 v[168:171], a[68:71], v[236:239], v[40:43]
buffer_load_dwordx4 v2, s[12:15], s24 offen offset:0 nt lds
v_mfma_f32_16x16x32_bf16 v[168:171], a[72:75], v[240:243], v[168:171]
s_add_u32 m0, m0, 8
v_mfma_f32_16x16x32_bf16 v[168:171], a[76:79], v[244:247], v[168:171]
v_exp_f32 v164, v164
v_exp_f32 v165, v165
v_mfma_f32_16x16x32_bf16 v[168:171], a[80:83], v[248:251], v[168:171]
s_waitcnt vmcnt(7)
s_barrier
v_mfma_f32_16x16x32_bf16 v[172:175], a[96:99], v[248:251], v[40:43]
ds_read_b64_tr_b16 a[196:197], v9 offset:8448
ds_read_b64_tr_b16 a[198:199], v9 offset:8960
ds_read_b64_tr_b16 a[200:201], v9 offset:8456
v_mfma_f32_16x16x32_bf16 v[172:175], a[92:95], v[244:247], v[172:175]
ds_read_b64_tr_b16 a[202:203], v9 offset:8968
buffer_load_dwordx4 v2, s[12:15], s24 offen offset:1024 nt lds
v_mfma_f32_16x16x32_bf16 v[172:175], a[88:91], v[240:243], v[172:175]
s_xor_b32 s24, s98, 30720
ds_read_b64_tr_b16 a[204:205], v9 offset:8464
ds_read_b64_tr_b16 a[206:207], v9 offset:8976
v_mfma_f32_16x16x32_bf16 v[172:175], a[84:87], v[236:239], v[172:175]
s_add_u32 m0, s23, 50688
ds_read_b64_tr_b16 a[208:209], v9 offset:8472
ds_read_b64_tr_b16 a[210:211], v9 offset:8984
ds_read_b64_tr_b16 a[212:213], v9 offset:8576
v_mfma_f32_16x16x32_bf16 v[140:143], a[32:35], v[176:179], v[140:143]
ds_read_b64_tr_b16 a[214:215], v9 offset:9088
ds_read_b64_tr_b16 a[216:217], v9 offset:8584
v_mfma_f32_16x16x32_bf16 v[144:147], a[32:35], v[196:199], v[144:147]
s_waitcnt lgkmcnt(9)
ds_read_b64_tr_b16 a[218:219], v9 offset:9096
ds_read_b64_tr_b16 a[220:221], v9 offset:8592
v_mfma_f32_16x16x32_bf16 v[148:151], a[32:35], v[216:219], v[148:151]
ds_read_b64_tr_b16 a[222:223], v9 offset:9104
ds_read_b64_tr_b16 a[224:225], v9 offset:8600
ds_read_b64_tr_b16 a[226:227], v9 offset:9112
v_mfma_f32_16x16x32_bf16 v[44:47], a[196:199], v[184:187], v[44:47]
ds_read_b128 a[36:39], v6 offset:0
ds_read_b128 a[40:43], v6 offset:64
v_mfma_f32_16x16x32_bf16 v[76:79], a[196:199], v[204:207], v[76:79]
s_waitcnt lgkmcnt(14)
ds_read_b128 a[44:47], v6 offset:128
ds_read_b128 a[48:51], v6 offset:192
v_cvt_pk_bf16_f32 v202, v164, v165
v_mfma_f32_16x16x32_bf16 v[108:111], a[196:199], v[224:227], v[108:111]
v_exp_f32 v166, v166
v_mfma_f32_16x16x32_bf16 v[112:115], a[200:203], v[224:227], v[112:115]
ds_read_b128 a[64:67], v6 offset:704
v_exp_f32 v167, v167
v_mfma_f32_16x16x32_bf16 v[80:83], a[200:203], v[204:207], v[80:83]
s_waitcnt lgkmcnt(13)
ds_read_b128 a[60:63], v6 offset:640
v_cvt_pk_bf16_f32 v203, v166, v167
v_mfma_f32_16x16x32_bf16 v[48:51], a[200:203], v[184:187], v[48:51]
v_exp_f32 v160, v160
v_mfma_f32_16x16x32_bf16 v[52:55], a[204:207], v[184:187], v[52:55]
ds_read_b128 a[56:59], v6 offset:576
v_exp_f32 v161, v161
v_mfma_f32_16x16x32_bf16 v[84:87], a[204:207], v[204:207], v[84:87]
ds_read_b128 a[52:55], v6 offset:512
v_exp_f32 v162, v162
v_mfma_f32_16x16x32_bf16 v[116:119], a[204:207], v[224:227], v[116:119]
buffer_load_dwordx4 v2, s[8:11], s24 offen offset:0 nt lds
v_mfma_f32_16x16x32_bf16 v[120:123], a[208:211], v[224:227], v[120:123]
s_add_u32 m0, m0, 32
v_exp_f32 v163, v163
v_mfma_f32_16x16x32_bf16 v[88:91], a[208:211], v[204:207], v[88:91]
s_waitcnt lgkmcnt(8)
buffer_load_dwordx4 v2, s[8:11], s24 offen offset:1024 nt lds
v_cvt_pk_bf16_f32 v200, v160, v161
v_mfma_f32_16x16x32_bf16 v[56:59], a[208:211], v[184:187], v[56:59]
s_xor_b32 s24, s98, 20480
v_exp_f32 v168, v168
v_mfma_f32_16x16x32_bf16 v[60:63], a[212:215], v[184:187], v[60:63]
s_add_u32 m0, s29, 59136
v_cvt_pk_bf16_f32 v201, v162, v163
v_exp_f32 v169, v169
v_mfma_f32_16x16x32_bf16 v[92:95], a[212:215], v[204:207], v[92:95]
v_exp_f32 v170, v170
v_mfma_f32_16x16x32_bf16 v[124:127], a[212:215], v[224:227], v[124:127]
v_exp_f32 v171, v171
v_cvt_pk_bf16_f32 v220, v168, v169
v_mfma_f32_16x16x32_bf16 v[128:131], a[216:219], v[224:227], v[128:131]
v_exp_f32 v172, v172
v_mfma_f32_16x16x32_bf16 v[96:99], a[216:219], v[204:207], v[96:99]
v_exp_f32 v173, v173
v_cvt_pk_bf16_f32 v221, v170, v171
v_mfma_f32_16x16x32_bf16 v[64:67], a[216:219], v[184:187], v[64:67]
v_exp_f32 v174, v174
v_mfma_f32_16x16x32_bf16 v[68:71], a[220:223], v[184:187], v[68:71]
v_exp_f32 v175, v175
v_cvt_pk_bf16_f32 v222, v172, v173
v_mfma_f32_16x16x32_bf16 v[100:103], a[220:223], v[204:207], v[100:103]
v_cvt_pk_bf16_f32 v223, v174, v175
v_mfma_f32_16x16x32_bf16 v[132:135], a[220:223], v[224:227], v[132:135]
v_mfma_f32_16x16x32_bf16 v[136:139], a[224:227], v[224:227], v[136:139]
v_mfma_f32_16x16x32_bf16 v[104:107], a[224:227], v[204:207], v[104:107]
s_waitcnt lgkmcnt(4)
v_mfma_f32_16x16x32_bf16 v[72:75], a[224:227], v[184:187], v[72:75]
v_mfma_f32_16x16x32_bf16 v[152:155], a[36:39], a[0:3], v[32:35]
v_mfma_f32_16x16x32_bf16 v[152:155], a[40:43], a[4:7], v[152:155]
v_mfma_f32_16x16x32_bf16 v[152:155], a[44:47], a[8:11], v[152:155]
s_waitcnt lgkmcnt(0)
v_mfma_f32_16x16x32_bf16 v[152:155], a[48:51], a[12:15], v[152:155]
v_mfma_f32_16x16x32_bf16 v[156:159], a[64:67], a[12:15], v[32:35]
v_mfma_f32_16x16x32_bf16 v[156:159], a[60:63], a[8:11], v[156:159]
v_mfma_f32_16x16x32_bf16 v[156:159], a[56:59], a[4:7], v[156:159]
v_mfma_f32_16x16x32_bf16 v[156:159], a[52:55], a[0:3], v[156:159]
v_mfma_f32_16x16x32_bf16 v[164:167], a[52:55], a[16:19], v[36:39]
v_mfma_f32_16x16x32_bf16 v[164:167], a[56:59], a[20:23], v[164:167]
v_mfma_f32_16x16x32_bf16 v[164:167], a[60:63], a[24:27], v[164:167]
v_exp_f32 v152, v152
v_exp_f32 v153, v153
v_exp_f32 v154, v154
v_exp_f32 v155, v155
v_mfma_f32_16x16x32_bf16 v[164:167], a[64:67], a[28:31], v[164:167]
v_exp_f32 v156, v156
v_cvt_pk_bf16_f32 v184, v152, v153
v_mfma_f32_16x16x32_bf16 v[160:163], a[48:51], a[28:31], v[36:39]
v_exp_f32 v157, v157
v_cvt_pk_bf16_f32 v185, v154, v155
v_mfma_f32_16x16x32_bf16 v[160:163], a[44:47], a[24:27], v[160:163]
v_exp_f32 v158, v158
v_mfma_f32_16x16x32_bf16 v[160:163], a[40:43], a[20:23], v[160:163]
v_exp_f32 v159, v159
v_cvt_pk_bf16_f32 v186, v156, v157
v_mfma_f32_16x16x32_bf16 v[160:163], a[36:39], a[16:19], v[160:163]
v_cvt_pk_bf16_f32 v187, v158, v159
v_mfma_f32_16x16x32_bf16 v[168:171], a[36:39], v[236:239], v[40:43]
buffer_load_dwordx4 v2, s[12:15], s24 offen offset:0 nt lds
v_mfma_f32_16x16x32_bf16 v[168:171], a[40:43], v[240:243], v[168:171]
s_add_u32 m0, m0, 8
v_mfma_f32_16x16x32_bf16 v[168:171], a[44:47], v[244:247], v[168:171]
v_exp_f32 v164, v164
v_mfma_f32_16x16x32_bf16 v[168:171], a[48:51], v[248:251], v[168:171]
s_waitcnt vmcnt(7)
s_barrier
v_mfma_f32_16x16x32_bf16 v[172:175], a[64:67], v[248:251], v[40:43]
ds_read_b64_tr_b16 a[100:101], v9 offset:25344
ds_read_b64_tr_b16 a[102:103], v9 offset:25856
buffer_load_dwordx4 v2, s[12:15], s24 offen offset:1024 nt lds
v_mfma_f32_16x16x32_bf16 v[172:175], a[60:63], v[244:247], v[172:175]
s_xor_b32 s24, s98, 22528
ds_read_b64_tr_b16 a[104:105], v9 offset:25352
ds_read_b64_tr_b16 a[106:107], v9 offset:25864
ds_read_b64_tr_b16 a[108:109], v9 offset:25360
v_mfma_f32_16x16x32_bf16 v[172:175], a[56:59], v[240:243], v[172:175]
s_add_u32 m0, s29, 67584
ds_read_b64_tr_b16 a[110:111], v9 offset:25872
ds_read_b64_tr_b16 a[112:113], v9 offset:25368
v_mfma_f32_16x16x32_bf16 v[172:175], a[52:55], v[236:239], v[172:175]
ds_read_b64_tr_b16 a[114:115], v9 offset:25880
ds_read_b64_tr_b16 a[116:117], v9 offset:25472
v_mfma_f32_16x16x32_bf16 v[140:143], a[32:35], v[180:183], v[140:143]
ds_read_b64_tr_b16 a[118:119], v9 offset:25984
ds_read_b64_tr_b16 a[120:121], v9 offset:25480
ds_read_b64_tr_b16 a[122:123], v9 offset:25992
v_mfma_f32_16x16x32_bf16 v[144:147], a[32:35], v[200:203], v[144:147]
s_waitcnt lgkmcnt(10)
ds_read_b64_tr_b16 a[124:125], v9 offset:25488
ds_read_b64_tr_b16 a[126:127], v9 offset:26000
v_mfma_f32_16x16x32_bf16 v[148:151], a[32:35], v[220:223], v[148:151]
ds_read_b128 a[68:71], v6 offset:16896
ds_read_b64_tr_b16 a[128:129], v9 offset:25496
ds_read_b64_tr_b16 a[130:131], v9 offset:26008
v_mfma_f32_16x16x32_bf16 v[44:47], a[100:103], v[188:191], v[44:47]
ds_read_b128 a[72:75], v6 offset:16960
ds_read_b128 a[76:79], v6 offset:17024
v_mfma_f32_16x16x32_bf16 v[76:79], a[100:103], v[208:211], v[76:79]
s_waitcnt lgkmcnt(15)
v_exp_f32 v165, v165
v_mfma_f32_16x16x32_bf16 v[108:111], a[100:103], v[228:231], v[108:111]
ds_read_b128 a[80:83], v6 offset:17088
v_exp_f32 v166, v166
v_mfma_f32_16x16x32_bf16 v[112:115], a[104:107], v[228:231], v[112:115]
ds_read_b128 a[96:99], v6 offset:17600
v_cvt_pk_bf16_f32 v206, v164, v165
v_mfma_f32_16x16x32_bf16 v[80:83], a[104:107], v[208:211], v[80:83]
s_waitcnt lgkmcnt(13)
ds_read_b128 a[92:95], v6 offset:17536
v_exp_f32 v167, v167
v_mfma_f32_16x16x32_bf16 v[48:51], a[104:107], v[188:191], v[48:51]
ds_read_b128 a[88:91], v6 offset:17472
v_cvt_pk_bf16_f32 v207, v166, v167
v_mfma_f32_16x16x32_bf16 v[52:55], a[108:111], v[188:191], v[52:55]
v_exp_f32 v160, v160
v_mfma_f32_16x16x32_bf16 v[84:87], a[108:111], v[208:211], v[84:87]
ds_read_b128 a[84:87], v6 offset:17408
v_exp_f32 v161, v161
v_mfma_f32_16x16x32_bf16 v[116:119], a[108:111], v[228:231], v[116:119]
v_exp_f32 v162, v162
v_mfma_f32_16x16x32_bf16 v[120:123], a[112:115], v[228:231], v[120:123]
v_exp_f32 v163, v163
v_cvt_pk_bf16_f32 v204, v160, v161
v_mfma_f32_16x16x32_bf16 v[88:91], a[112:115], v[208:211], v[88:91]
s_waitcnt lgkmcnt(7)
v_exp_f32 v168, v168
v_mfma_f32_16x16x32_bf16 v[56:59], a[112:115], v[188:191], v[56:59]
v_exp_f32 v169, v169
v_mfma_f32_16x16x32_bf16 v[60:63], a[116:119], v[188:191], v[60:63]
v_cvt_pk_bf16_f32 v205, v162, v163
v_exp_f32 v170, v170
v_mfma_f32_16x16x32_bf16 v[92:95], a[116:119], v[208:211], v[92:95]
v_exp_f32 v171, v171
v_mfma_f32_16x16x32_bf16 v[124:127], a[116:119], v[228:231], v[124:127]
v_exp_f32 v172, v172
v_mfma_f32_16x16x32_bf16 v[128:131], a[120:123], v[228:231], v[128:131]
v_exp_f32 v173, v173
v_cvt_pk_bf16_f32 v224, v168, v169
v_mfma_f32_16x16x32_bf16 v[96:99], a[120:123], v[208:211], v[96:99]
v_exp_f32 v174, v174
v_mfma_f32_16x16x32_bf16 v[64:67], a[120:123], v[188:191], v[64:67]
v_exp_f32 v175, v175
v_cvt_pk_bf16_f32 v225, v170, v171
v_mfma_f32_16x16x32_bf16 v[68:71], a[124:127], v[188:191], v[68:71]
v_cvt_pk_bf16_f32 v226, v172, v173
v_cvt_pk_bf16_f32 v227, v174, v175
v_mfma_f32_16x16x32_bf16 v[100:103], a[124:127], v[208:211], v[100:103]
v_mfma_f32_16x16x32_bf16 v[132:135], a[124:127], v[228:231], v[132:135]
v_mfma_f32_16x16x32_bf16 v[136:139], a[128:131], v[228:231], v[136:139]
v_mfma_f32_16x16x32_bf16 v[104:107], a[128:131], v[208:211], v[104:107]
s_waitcnt lgkmcnt(4)
buffer_load_dwordx4 v2, s[12:15], s24 offen offset:0 nt lds
v_mfma_f32_16x16x32_bf16 v[72:75], a[128:131], v[188:191], v[72:75]
s_add_u32 m0, m0, 8
v_mfma_f32_16x16x32_bf16 v[152:155], a[68:71], a[0:3], v[32:35]
buffer_load_dwordx4 v2, s[12:15], s24 offen offset:1024 nt lds
v_mfma_f32_16x16x32_bf16 v[152:155], a[72:75], a[4:7], v[152:155]
s_xor_b32 s24, s101, 24576
v_mfma_f32_16x16x32_bf16 v[152:155], a[76:79], a[8:11], v[152:155]
s_waitcnt lgkmcnt(0)
v_mfma_f32_16x16x32_bf16 v[152:155], a[80:83], a[12:15], v[152:155]
s_add_u32 m0, s29, 76032
v_mfma_f32_16x16x32_bf16 v[156:159], a[96:99], a[12:15], v[32:35]
v_mfma_f32_16x16x32_bf16 v[156:159], a[92:95], a[8:11], v[156:159]
v_mfma_f32_16x16x32_bf16 v[156:159], a[88:91], a[4:7], v[156:159]
buffer_load_dwordx4 v4, s[12:15], s24 offen offset:0 nt lds
v_mfma_f32_16x16x32_bf16 v[156:159], a[84:87], a[0:3], v[156:159]
s_add_u32 m0, m0, 8
v_mfma_f32_16x16x32_bf16 v[164:167], a[84:87], a[16:19], v[36:39]
buffer_load_dwordx4 v4, s[12:15], s24 offen offset:1024 nt lds
v_mfma_f32_16x16x32_bf16 v[164:167], a[88:91], a[20:23], v[164:167]
s_xor_b32 s24, s101, 28672
v_mfma_f32_16x16x32_bf16 v[164:167], a[92:95], a[24:27], v[164:167]
s_add_u32 m0, s29, 84480
v_exp_f32 v152, v152
v_exp_f32 v153, v153
v_exp_f32 v154, v154
v_exp_f32 v155, v155
v_mfma_f32_16x16x32_bf16 v[164:167], a[96:99], a[28:31], v[164:167]
v_exp_f32 v156, v156
v_cvt_pk_bf16_f32 v188, v152, v153
v_mfma_f32_16x16x32_bf16 v[160:163], a[80:83], a[28:31], v[36:39]
v_exp_f32 v157, v157
v_mfma_f32_16x16x32_bf16 v[160:163], a[76:79], a[24:27], v[160:163]
v_exp_f32 v158, v158
v_cvt_pk_bf16_f32 v189, v154, v155
v_mfma_f32_16x16x32_bf16 v[160:163], a[72:75], a[20:23], v[160:163]
v_exp_f32 v159, v159
v_mfma_f32_16x16x32_bf16 v[160:163], a[68:71], a[16:19], v[160:163]
v_cvt_pk_bf16_f32 v190, v156, v157
v_cvt_pk_bf16_f32 v191, v158, v159
v_mfma_f32_16x16x32_bf16 v[168:171], a[68:71], v[236:239], v[40:43]
v_mfma_f32_16x16x32_bf16 v[168:171], a[72:75], v[240:243], v[168:171]
v_mfma_f32_16x16x32_bf16 v[168:171], a[76:79], v[244:247], v[168:171]
v_exp_f32 v164, v164
v_mfma_f32_16x16x32_bf16 v[168:171], a[80:83], v[248:251], v[168:171]
s_waitcnt vmcnt(8)
s_barrier
v_mfma_f32_16x16x32_bf16 v[172:175], a[96:99], v[248:251], v[40:43]
ds_read_b64_tr_b16 a[132:133], v9 offset:42240
ds_read_b64_tr_b16 a[134:135], v9 offset:42752
ds_read_b64_tr_b16 a[136:137], v9 offset:42248
ds_read_b64_tr_b16 a[138:139], v9 offset:42760
v_mfma_f32_16x16x32_bf16 v[172:175], a[92:95], v[244:247], v[172:175]
ds_read_b64_tr_b16 a[140:141], v9 offset:42256
ds_read_b64_tr_b16 a[142:143], v9 offset:42768
v_mfma_f32_16x16x32_bf16 v[172:175], a[88:91], v[240:243], v[172:175]
ds_read_b64_tr_b16 a[144:145], v9 offset:42264
ds_read_b64_tr_b16 a[146:147], v9 offset:42776
ds_read_b64_tr_b16 a[148:149], v9 offset:42368
v_mfma_f32_16x16x32_bf16 v[172:175], a[84:87], v[236:239], v[172:175]
ds_read_b64_tr_b16 a[150:151], v9 offset:42880
ds_read_b64_tr_b16 a[152:153], v9 offset:42376
v_mfma_f32_16x16x32_bf16 v[140:143], a[32:35], v[184:187], v[140:143]
ds_read_b64_tr_b16 a[154:155], v9 offset:42888
ds_read_b64_tr_b16 a[156:157], v9 offset:42384
v_mfma_f32_16x16x32_bf16 v[144:147], a[32:35], v[204:207], v[144:147]
s_waitcnt lgkmcnt(11)
ds_read_b64_tr_b16 a[158:159], v9 offset:42896
ds_read_b64_tr_b16 a[160:161], v9 offset:42392
ds_read_b64_tr_b16 a[162:163], v9 offset:42904
v_mfma_f32_16x16x32_bf16 v[148:151], a[32:35], v[224:227], v[148:151]
ds_read_b128 a[36:39], v6 offset:33792
ds_read_b128 a[40:43], v6 offset:33856
v_mfma_f32_16x16x32_bf16 v[44:47], a[132:135], v[192:195], v[44:47]
v_exp_f32 v165, v165
v_mfma_f32_16x16x32_bf16 v[76:79], a[132:135], v[212:215], v[76:79]
s_waitcnt lgkmcnt(14)
ds_read_b128 a[44:47], v6 offset:33920
ds_read_b128 a[48:51], v6 offset:33984
v_cvt_pk_bf16_f32 v210, v164, v165
v_mfma_f32_16x16x32_bf16 v[108:111], a[132:135], v[232:235], v[108:111]
v_exp_f32 v166, v166
v_mfma_f32_16x16x32_bf16 v[112:115], a[136:139], v[232:235], v[112:115]
v_exp_f32 v167, v167
v_mfma_f32_16x16x32_bf16 v[80:83], a[136:139], v[212:215], v[80:83]
s_waitcnt lgkmcnt(12)
buffer_load_dwordx4 v4, s[12:15], s24 offen offset:0 nt lds
v_mfma_f32_16x16x32_bf16 v[48:51], a[136:139], v[192:195], v[48:51]
s_add_u32 m0, m0, 8
ds_read_b128 a[64:67], v6 offset:34496
ds_read_b128 a[60:63], v6 offset:34432
v_cvt_pk_bf16_f32 v211, v166, v167
v_mfma_f32_16x16x32_bf16 v[52:55], a[140:143], v[192:195], v[52:55]
buffer_load_dwordx4 v4, s[12:15], s24 offen offset:1024 nt lds
v_mfma_f32_16x16x32_bf16 v[84:87], a[140:143], v[212:215], v[84:87]
s_xor_b32 s24, s101, 24704
ds_read_b128 a[56:59], v6 offset:34368
ds_read_b128 a[52:55], v6 offset:34304
v_mfma_f32_16x16x32_bf16 v[116:119], a[140:143], v[232:235], v[116:119]
s_add_u32 m0, s29, 92928
v_exp_f32 v160, v160
v_mfma_f32_16x16x32_bf16 v[120:123], a[144:147], v[232:235], v[120:123]
v_exp_f32 v161, v161
v_mfma_f32_16x16x32_bf16 v[88:91], a[144:147], v[212:215], v[88:91]
s_waitcnt lgkmcnt(8)
v_exp_f32 v162, v162
v_cvt_pk_bf16_f32 v208, v160, v161
v_mfma_f32_16x16x32_bf16 v[56:59], a[144:147], v[192:195], v[56:59]
v_exp_f32 v163, v163
v_mfma_f32_16x16x32_bf16 v[60:63], a[148:151], v[192:195], v[60:63]
v_cvt_pk_bf16_f32 v209, v162, v163
v_exp_f32 v168, v168
v_mfma_f32_16x16x32_bf16 v[92:95], a[148:151], v[212:215], v[92:95]
v_exp_f32 v169, v169
v_mfma_f32_16x16x32_bf16 v[124:127], a[148:151], v[232:235], v[124:127]
v_exp_f32 v170, v170
v_cvt_pk_bf16_f32 v228, v168, v169
v_mfma_f32_16x16x32_bf16 v[128:131], a[152:155], v[232:235], v[128:131]
v_exp_f32 v171, v171
v_mfma_f32_16x16x32_bf16 v[96:99], a[152:155], v[212:215], v[96:99]
v_exp_f32 v172, v172
v_mfma_f32_16x16x32_bf16 v[64:67], a[152:155], v[192:195], v[64:67]
v_exp_f32 v173, v173
v_cvt_pk_bf16_f32 v229, v170, v171
v_mfma_f32_16x16x32_bf16 v[68:71], a[156:159], v[192:195], v[68:71]
v_exp_f32 v174, v174
v_mfma_f32_16x16x32_bf16 v[100:103], a[156:159], v[212:215], v[100:103]
v_exp_f32 v175, v175
v_mfma_f32_16x16x32_bf16 v[132:135], a[156:159], v[232:235], v[132:135]
v_cvt_pk_bf16_f32 v230, v172, v173
v_cvt_pk_bf16_f32 v231, v174, v175
v_mfma_f32_16x16x32_bf16 v[136:139], a[160:163], v[232:235], v[136:139]
v_mfma_f32_16x16x32_bf16 v[104:107], a[160:163], v[212:215], v[104:107]
s_waitcnt lgkmcnt(4)
v_mfma_f32_16x16x32_bf16 v[72:75], a[160:163], v[192:195], v[72:75]
v_mfma_f32_16x16x32_bf16 v[152:155], a[36:39], a[0:3], v[32:35]
v_mfma_f32_16x16x32_bf16 v[152:155], a[40:43], a[4:7], v[152:155]
v_mfma_f32_16x16x32_bf16 v[152:155], a[44:47], a[8:11], v[152:155]
s_waitcnt lgkmcnt(0)
v_mfma_f32_16x16x32_bf16 v[152:155], a[48:51], a[12:15], v[152:155]
buffer_load_dwordx4 v4, s[12:15], s24 offen offset:0 nt lds
v_mfma_f32_16x16x32_bf16 v[156:159], a[64:67], a[12:15], v[32:35]
s_add_u32 m0, m0, 8
v_mfma_f32_16x16x32_bf16 v[156:159], a[60:63], a[8:11], v[156:159]
buffer_load_dwordx4 v4, s[12:15], s24 offen offset:1024 nt lds
v_mfma_f32_16x16x32_bf16 v[156:159], a[56:59], a[4:7], v[156:159]
s_xor_b32 s24, s101, 28800
v_mfma_f32_16x16x32_bf16 v[156:159], a[52:55], a[0:3], v[156:159]
s_add_u32 m0, s29, 101376
v_mfma_f32_16x16x32_bf16 v[164:167], a[52:55], a[16:19], v[36:39]
v_mfma_f32_16x16x32_bf16 v[164:167], a[56:59], a[20:23], v[164:167]
v_mfma_f32_16x16x32_bf16 v[164:167], a[60:63], a[24:27], v[164:167]
v_exp_f32 v152, v152
v_exp_f32 v153, v153
v_exp_f32 v154, v154
v_mfma_f32_16x16x32_bf16 v[164:167], a[64:67], a[28:31], v[164:167]
buffer_load_dwordx4 v4, s[12:15], s24 offen offset:0 nt lds
v_cvt_pk_bf16_f32 v192, v152, v153
v_mfma_f32_16x16x32_bf16 v[160:163], a[48:51], a[28:31], v[36:39]
s_add_u32 m0, m0, 8
v_exp_f32 v155, v155
v_mfma_f32_16x16x32_bf16 v[160:163], a[44:47], a[24:27], v[160:163]
buffer_load_dwordx4 v4, s[12:15], s24 offen offset:1024 nt lds
v_cvt_pk_bf16_f32 v193, v154, v155
v_mfma_f32_16x16x32_bf16 v[160:163], a[40:43], a[20:23], v[160:163]
v_exp_f32 v156, v156
v_mfma_f32_16x16x32_bf16 v[160:163], a[36:39], a[16:19], v[160:163]
v_exp_f32 v157, v157
v_mfma_f32_16x16x32_bf16 v[168:171], a[36:39], v[236:239], v[40:43]
v_exp_f32 v158, v158
v_cvt_pk_bf16_f32 v194, v156, v157
v_mfma_f32_16x16x32_bf16 v[168:171], a[40:43], v[240:243], v[168:171]
v_exp_f32 v159, v159
v_mfma_f32_16x16x32_bf16 v[168:171], a[44:47], v[244:247], v[168:171]
v_exp_f32 v164, v164
v_mfma_f32_16x16x32_bf16 v[168:171], a[48:51], v[248:251], v[168:171]
s_waitcnt vmcnt(10)
s_barrier
v_mfma_f32_16x16x32_bf16 v[172:175], a[64:67], v[248:251], v[40:43]
ds_read_b64_tr_b16 a[164:165], v10 offset:0
ds_read_b64_tr_b16 a[166:167], v10 offset:512
v_mfma_f32_16x16x32_bf16 v[172:175], a[60:63], v[244:247], v[172:175]
ds_read_b64_tr_b16 a[168:169], v10 offset:8
ds_read_b64_tr_b16 a[170:171], v10 offset:520
v_cvt_pk_bf16_f32 v195, v158, v159
v_mfma_f32_16x16x32_bf16 v[172:175], a[56:59], v[240:243], v[172:175]
v_exp_f32 v165, v165
v_mfma_f32_16x16x32_bf16 v[172:175], a[52:55], v[236:239], v[172:175]
ds_read_b64_tr_b16 a[172:173], v10 offset:16
ds_read_b64_tr_b16 a[174:175], v10 offset:528
v_mfma_f32_16x16x32_bf16 v[140:143], a[32:35], v[188:191], v[140:143]
ds_read_b64_tr_b16 a[176:177], v10 offset:24
v_cvt_pk_bf16_f32 v214, v164, v165
v_mfma_f32_16x16x32_bf16 v[144:147], a[32:35], v[208:211], v[144:147]
s_waitcnt lgkmcnt(5)
v_exp_f32 v166, v166
v_mfma_f32_16x16x32_bf16 v[148:151], a[32:35], v[228:231], v[148:151]
ds_read_b64_tr_b16 a[178:179], v10 offset:536
ds_read_b64_tr_b16 a[180:181], v10 offset:128
v_mfma_f32_16x16x32_bf16 v[44:47], a[164:167], v[176:179], v[44:47]
ds_read_b64_tr_b16 a[182:183], v10 offset:640
ds_read_b64_tr_b16 a[184:185], v10 offset:136
v_mfma_f32_16x16x32_bf16 v[76:79], a[164:167], v[196:199], v[76:79]
s_waitcnt lgkmcnt(7)
ds_read_b64_tr_b16 a[186:187], v10 offset:648
v_exp_f32 v167, v167
v_mfma_f32_16x16x32_bf16 v[108:111], a[164:167], v[216:219], v[108:111]
ds_read_b64_tr_b16 a[188:189], v10 offset:144
v_cvt_pk_bf16_f32 v215, v166, v167
v_mfma_f32_16x16x32_bf16 v[112:115], a[168:171], v[216:219], v[112:115]
v_exp_f32 v160, v160
v_mfma_f32_16x16x32_bf16 v[80:83], a[168:171], v[196:199], v[80:83]
s_waitcnt lgkmcnt(5)
ds_read_b64_tr_b16 a[190:191], v10 offset:656
ds_read_b64_tr_b16 a[192:193], v10 offset:152
v_mfma_f32_16x16x32_bf16 v[48:51], a[168:171], v[176:179], v[48:51]
v_exp_f32 v161, v161
v_mfma_f32_16x16x32_bf16 v[52:55], a[172:175], v[176:179], v[52:55]
ds_read_b128 a[68:71], v6 offset:50688
ds_read_b64_tr_b16 a[194:195], v10 offset:664
v_mfma_f32_16x16x32_bf16 v[84:87], a[172:175], v[196:199], v[84:87]
v_exp_f32 v162, v162
v_mfma_f32_16x16x32_bf16 v[116:119], a[172:175], v[216:219], v[116:119]
ds_read_b128 a[72:75], v6 offset:50752
v_cvt_pk_bf16_f32 v212, v160, v161
v_mfma_f32_16x16x32_bf16 v[120:123], a[176:179], v[216:219], v[120:123]
ds_read_b128 a[76:79], v6 offset:50816
v_exp_f32 v163, v163
v_mfma_f32_16x16x32_bf16 v[88:91], a[176:179], v[196:199], v[88:91]
s_waitcnt lgkmcnt(2)
v_exp_f32 v168, v168
v_mfma_f32_16x16x32_bf16 v[56:59], a[176:179], v[176:179], v[56:59]
ds_read_b128 a[80:83], v6 offset:50880
v_cvt_pk_bf16_f32 v213, v162, v163
v_mfma_f32_16x16x32_bf16 v[60:63], a[180:183], v[176:179], v[60:63]
v_exp_f32 v169, v169
v_mfma_f32_16x16x32_bf16 v[92:95], a[180:183], v[196:199], v[92:95]
ds_read_b128 a[96:99], v6 offset:51392
v_cvt_pk_bf16_f32 v232, v168, v169
v_mfma_f32_16x16x32_bf16 v[124:127], a[180:183], v[216:219], v[124:127]
v_exp_f32 v170, v170
v_mfma_f32_16x16x32_bf16 v[128:131], a[184:187], v[216:219], v[128:131]
v_exp_f32 v171, v171
v_mfma_f32_16x16x32_bf16 v[96:99], a[184:187], v[196:199], v[96:99]
ds_read_b128 a[92:95], v6 offset:51328
v_cvt_pk_bf16_f32 v233, v170, v171
v_mfma_f32_16x16x32_bf16 v[64:67], a[184:187], v[176:179], v[64:67]
ds_read_b128 a[88:91], v6 offset:51264
v_exp_f32 v172, v172
v_mfma_f32_16x16x32_bf16 v[68:71], a[188:191], v[176:179], v[68:71]
v_exp_f32 v173, v173
v_mfma_f32_16x16x32_bf16 v[100:103], a[188:191], v[196:199], v[100:103]
ds_read_b128 a[84:87], v6 offset:51200
v_cvt_pk_bf16_f32 v234, v172, v173
v_mfma_f32_16x16x32_bf16 v[132:135], a[188:191], v[216:219], v[132:135]
v_exp_f32 v174, v174
v_mfma_f32_16x16x32_bf16 v[136:139], a[192:195], v[216:219], v[136:139]
v_exp_f32 v175, v175
v_mfma_f32_16x16x32_bf16 v[104:107], a[192:195], v[196:199], v[104:107]
s_waitcnt lgkmcnt(4)
v_cvt_pk_bf16_f32 v235, v174, v175
v_mfma_f32_16x16x32_bf16 v[72:75], a[192:195], v[176:179], v[72:75]
v_mfma_f32_16x16x32_bf16 v[152:155], a[68:71], a[0:3], v[32:35]
v_mfma_f32_16x16x32_bf16 v[152:155], a[72:75], a[4:7], v[152:155]
v_mfma_f32_16x16x32_bf16 v[152:155], a[76:79], a[8:11], v[152:155]
s_waitcnt lgkmcnt(0)
v_mfma_f32_16x16x32_bf16 v[152:155], a[80:83], a[12:15], v[152:155]
v_mfma_f32_16x16x32_bf16 v[156:159], a[96:99], a[12:15], v[32:35]
v_mfma_f32_16x16x32_bf16 v[156:159], a[92:95], a[8:11], v[156:159]
L_touch3_o2:
s_cbranch_scc1 L_touch_ret
v_mfma_f32_16x16x32_bf16 v[156:159], a[88:91], a[4:7], v[156:159]
v_mfma_f32_16x16x32_bf16 v[156:159], a[84:87], a[0:3], v[156:159]
s_waitcnt vmcnt(6)
s_barrier
v_mfma_f32_16x16x32_bf16 v[164:167], a[84:87], a[16:19], v[36:39]
ds_read_b64_tr_b16 a[196:197], v10 offset:8448
ds_read_b64_tr_b16 a[198:199], v10 offset:8960
v_mfma_f32_16x16x32_bf16 v[164:167], a[88:91], a[20:23], v[164:167]
ds_read_b64_tr_b16 a[200:201], v10 offset:8456
ds_read_b64_tr_b16 a[202:203], v10 offset:8968
v_mfma_f32_16x16x32_bf16 v[164:167], a[92:95], a[24:27], v[164:167]
v_exp_f32 v152, v152
v_mfma_f32_16x16x32_bf16 v[164:167], a[96:99], a[28:31], v[164:167]
ds_read_b64_tr_b16 a[204:205], v10 offset:8464
ds_read_b64_tr_b16 a[206:207], v10 offset:8976
v_mfma_f32_16x16x32_bf16 v[160:163], a[80:83], a[28:31], v[36:39]
v_exp_f32 v153, v153
v_mfma_f32_16x16x32_bf16 v[160:163], a[76:79], a[24:27], v[160:163]
ds_read_b64_tr_b16 a[208:209], v10 offset:8472
ds_read_b64_tr_b16 a[210:211], v10 offset:8984
v_mfma_f32_16x16x32_bf16 v[160:163], a[72:75], a[20:23], v[160:163]
ds_read_b64_tr_b16 a[212:213], v10 offset:8576
v_cvt_pk_bf16_f32 v176, v152, v153
v_mfma_f32_16x16x32_bf16 v[160:163], a[68:71], a[16:19], v[160:163]
v_exp_f32 v154, v154
v_mfma_f32_16x16x32_bf16 v[168:171], a[68:71], v[236:239], v[40:43]
ds_read_b64_tr_b16 a[214:215], v10 offset:9088
ds_read_b64_tr_b16 a[216:217], v10 offset:8584
v_mfma_f32_16x16x32_bf16 v[168:171], a[72:75], v[240:243], v[168:171]
ds_read_b64_tr_b16 a[218:219], v10 offset:9096
ds_read_b64_tr_b16 a[220:221], v10 offset:8592
v_mfma_f32_16x16x32_bf16 v[168:171], a[76:79], v[244:247], v[168:171]
v_exp_f32 v155, v155
v_mfma_f32_16x16x32_bf16 v[168:171], a[80:83], v[248:251], v[168:171]
ds_read_b64_tr_b16 a[222:223], v10 offset:9104
ds_read_b64_tr_b16 a[224:225], v10 offset:8600
v_mfma_f32_16x16x32_bf16 v[172:175], a[96:99], v[248:251], v[40:43]
ds_read_b64_tr_b16 a[226:227], v10 offset:9112
v_cvt_pk_bf16_f32 v177, v154, v155
v_mfma_f32_16x16x32_bf16 v[172:175], a[92:95], v[244:247], v[172:175]
v_exp_f32 v156, v156
v_mfma_f32_16x16x32_bf16 v[172:175], a[88:91], v[240:243], v[172:175]
ds_read_b64_tr_b16 a[100:101], v12 offset:0
ds_read_b64_tr_b16 a[102:103], v12 offset:256
v_mfma_f32_16x16x32_bf16 v[172:175], a[84:87], v[236:239], v[172:175]
v_exp_f32 v157, v157
v_mfma_f32_16x16x32_bf16 v[140:143], a[32:35], v[192:195], v[140:143]
ds_read_b64_tr_b16 a[104:105], v12 offset:8
ds_read_b64_tr_b16 a[106:107], v12 offset:264
v_mfma_f32_16x16x32_bf16 v[144:147], a[32:35], v[212:215], v[144:147]
s_waitcnt lgkmcnt(15)
ds_read_b64_tr_b16 a[108:109], v12 offset:16
v_cvt_pk_bf16_f32 v178, v156, v157
v_mfma_f32_16x16x32_bf16 v[148:151], a[32:35], v[232:235], v[148:151]
ds_read_b64_tr_b16 a[110:111], v12 offset:272
ds_read_b64_tr_b16 a[112:113], v12 offset:24
v_mfma_f32_16x16x32_bf16 v[44:47], a[196:199], v[180:183], v[44:47]
v_exp_f32 v158, v158
v_mfma_f32_16x16x32_bf16 v[76:79], a[196:199], v[200:203], v[76:79]
ds_read_b64_tr_b16 a[114:115], v12 offset:280
ds_read_b64_tr_b16 a[116:117], v12 offset:512
v_mfma_f32_16x16x32_bf16 v[108:111], a[196:199], v[220:223], v[108:111]
v_exp_f32 v159, v159
v_mfma_f32_16x16x32_bf16 v[112:115], a[200:203], v[220:223], v[112:115]
ds_read_b64_tr_b16 a[118:119], v12 offset:768
v_cvt_pk_bf16_f32 v179, v158, v159
v_mfma_f32_16x16x32_bf16 v[80:83], a[200:203], v[200:203], v[80:83]
s_waitcnt lgkmcnt(15)
ds_read_b64_tr_b16 a[120:121], v12 offset:520
ds_read_b64_tr_b16 a[122:123], v12 offset:776
v_mfma_f32_16x16x32_bf16 v[48:51], a[200:203], v[180:183], v[48:51]
v_exp_f32 v164, v164
v_mfma_f32_16x16x32_bf16 v[52:55], a[204:207], v[180:183], v[52:55]
ds_read_b64_tr_b16 a[124:125], v12 offset:528
ds_read_b64_tr_b16 a[126:127], v12 offset:784
v_mfma_f32_16x16x32_bf16 v[84:87], a[204:207], v[200:203], v[84:87]
v_exp_f32 v165, v165
v_mfma_f32_16x16x32_bf16 v[116:119], a[204:207], v[220:223], v[116:119]
ds_read_b64_tr_b16 a[128:129], v12 offset:536
ds_read_b64_tr_b16 a[130:131], v12 offset:792
v_mfma_f32_16x16x32_bf16 v[120:123], a[208:211], v[220:223], v[120:123]
v_exp_f32 v166, v166
v_mfma_f32_16x16x32_bf16 v[88:91], a[208:211], v[200:203], v[88:91]
s_waitcnt lgkmcnt(15)
v_exp_f32 v167, v167
v_mfma_f32_16x16x32_bf16 v[56:59], a[208:211], v[180:183], v[56:59]
v_exp_f32 v160, v160
v_mfma_f32_16x16x32_bf16 v[60:63], a[212:215], v[180:183], v[60:63]
v_exp_f32 v161, v161
v_mfma_f32_16x16x32_bf16 v[92:95], a[212:215], v[200:203], v[92:95]
s_waitcnt vmcnt(4)
s_barrier
v_mfma_f32_16x16x32_bf16 v[124:127], a[212:215], v[220:223], v[124:127]
ds_read_b64_tr_b16 a[132:133], v12 offset:8448
ds_read_b64_tr_b16 a[134:135], v12 offset:8704
v_mfma_f32_16x16x32_bf16 v[128:131], a[216:219], v[220:223], v[128:131]
ds_read_b64_tr_b16 a[136:137], v12 offset:8456
ds_read_b64_tr_b16 a[138:139], v12 offset:8712
v_mfma_f32_16x16x32_bf16 v[96:99], a[216:219], v[200:203], v[96:99]
ds_read_b64_tr_b16 a[140:141], v12 offset:8464
v_cvt_pk_bf16_f32 v198, v164, v165
v_mfma_f32_16x16x32_bf16 v[64:67], a[216:219], v[180:183], v[64:67]
ds_read_b64_tr_b16 a[142:143], v12 offset:8720
v_cvt_pk_bf16_f32 v199, v166, v167
v_mfma_f32_16x16x32_bf16 v[68:71], a[220:223], v[180:183], v[68:71]
ds_read_b64_tr_b16 a[144:145], v12 offset:8472
v_cvt_pk_bf16_f32 v196, v160, v161
v_mfma_f32_16x16x32_bf16 v[100:103], a[220:223], v[200:203], v[100:103]
v_exp_f32 v162, v162
v_mfma_f32_16x16x32_bf16 v[132:135], a[220:223], v[220:223], v[132:135]
ds_read_b64_tr_b16 a[146:147], v12 offset:8728
ds_read_b64_tr_b16 a[148:149], v12 offset:8960
v_mfma_f32_16x16x32_bf16 v[136:139], a[224:227], v[220:223], v[136:139]
v_exp_f32 v163, v163
v_mfma_f32_16x16x32_bf16 v[104:107], a[224:227], v[200:203], v[104:107]
ds_read_b64_tr_b16 a[150:151], v12 offset:9216
ds_read_b64_tr_b16 a[152:153], v12 offset:8968
v_mfma_f32_16x16x32_bf16 v[72:75], a[224:227], v[180:183], v[72:75]
s_waitcnt lgkmcnt(15)
ds_read_b64_tr_b16 a[154:155], v12 offset:9224
ds_read_b64_tr_b16 a[156:157], v12 offset:8976
v_mfma_f32_16x16x32_bf16 v[140:143], a[32:35], v[176:179], v[140:143]
s_mov_b32 vcc_lo, 0xaaaaaaaa
ds_read_b64_tr_b16 a[158:159], v12 offset:9232
v_cvt_pk_bf16_f32 v197, v162, v163
v_mfma_f32_16x16x32_bf16 v[44:47], a[100:103], v[184:187], v[44:47]
s_mov_b32 vcc_hi, 0xaaaaaaaa
v_exp_f32 v168, v168
v_mfma_f32_16x16x32_bf16 v[48:51], a[104:107], v[184:187], v[48:51]
ds_read_b64_tr_b16 a[160:161], v12 offset:8984
ds_read_b64_tr_b16 a[162:163], v12 offset:9240
v_mfma_f32_16x16x32_bf16 v[52:55], a[108:111], v[184:187], v[52:55]
s_waitcnt lgkmcnt(15)
v_exp_f32 v169, v169
v_mfma_f32_16x16x32_bf16 v[56:59], a[112:115], v[184:187], v[56:59]
v_rcp_f32 v32, v140
v_mfma_f32_16x16x32_bf16 v[44:47], a[116:119], v[188:191], v[44:47]
v_cvt_pk_bf16_f32 v216, v168, v169
v_mov_b32 v33, v32
v_mfma_f32_16x16x32_bf16 v[48:51], a[120:123], v[188:191], v[48:51]
v_exp_f32 v170, v170
v_mfma_f32_16x16x32_bf16 v[52:55], a[124:127], v[188:191], v[52:55]
s_waitcnt lgkmcnt(8)
v_exp_f32 v171, v171
v_mfma_f32_16x16x32_bf16 v[56:59], a[128:131], v[188:191], v[56:59]
s_waitcnt lgkmcnt(0)
v_exp_f32 v172, v172
v_mfma_f32_16x16x32_bf16 v[44:47], a[132:135], v[192:195], v[44:47]
v_exp_f32 v173, v173
v_mfma_f32_16x16x32_bf16 v[44:47], a[148:151], v[176:179], v[44:47]
v_exp_f32 v174, v174
v_mfma_f32_16x16x32_bf16 v[48:51], a[152:155], v[176:179], v[48:51]
v_cvt_pk_bf16_f32 v217, v170, v171
v_cvt_pk_bf16_f32 v218, v172, v173
v_mfma_f32_16x16x32_bf16 v[48:51], a[136:139], v[192:195], v[48:51]
v_exp_f32 v175, v175
v_mfma_f32_16x16x32_bf16 v[52:55], a[140:143], v[192:195], v[52:55]
v_cvt_pk_bf16_f32 v219, v174, v175
v_mfma_f32_16x16x32_bf16 v[52:55], a[156:159], v[176:179], v[52:55]
v_mul_f32 v44, v44, v32
v_mul_f32 v45, v45, v32
v_mfma_f32_16x16x32_bf16 v[56:59], a[160:163], v[176:179], v[56:59]
v_mul_f32 v46, v46, v32
v_mul_f32 v47, v47, v32
v_mfma_f32_16x16x32_bf16 v[56:59], a[144:147], v[192:195], v[56:59]
v_cvt_pk_bf16_f32 v44, v44, v45
v_cvt_pk_bf16_f32 v45, v46, v47
v_mfma_f32_16x16x32_bf16 v[144:147], a[32:35], v[196:199], v[144:147]
v_mul_f32 v48, v48, v32
v_mul_f32 v49, v49, v32
v_mfma_f32_16x16x32_bf16 v[76:79], a[100:103], v[204:207], v[76:79]
v_mul_f32 v50, v50, v32
v_mul_f32 v51, v51, v32
v_mfma_f32_16x16x32_bf16 v[76:79], a[116:119], v[208:211], v[76:79]
v_cvt_pk_bf16_f32 v46, v48, v49
v_cvt_pk_bf16_f32 v47, v50, v51
v_mfma_f32_16x16x32_bf16 v[76:79], a[132:135], v[212:215], v[76:79]
v_mul_f32 v52, v52, v32
v_mul_f32 v53, v53, v32
v_mfma_f32_16x16x32_bf16 v[76:79], a[148:151], v[196:199], v[76:79]
v_rcp_f32 v36, v144
v_mfma_f32_16x16x32_bf16 v[80:83], a[152:155], v[196:199], v[80:83]
v_mov_b32 v37, v36
v_mul_f32 v54, v54, v32
v_mfma_f32_16x16x32_bf16 v[80:83], a[136:139], v[212:215], v[80:83]
v_mul_f32 v55, v55, v32
v_cvt_pk_bf16_f32 v52, v52, v53
v_mfma_f32_16x16x32_bf16 v[80:83], a[120:123], v[208:211], v[80:83]
v_cvt_pk_bf16_f32 v53, v54, v55
v_mul_f32 v56, v56, v32
v_mfma_f32_16x16x32_bf16 v[80:83], a[104:107], v[204:207], v[80:83]
v_mul_f32 v57, v57, v32
v_mul_f32 v58, v58, v32
v_mfma_f32_16x16x32_bf16 v[84:87], a[108:111], v[204:207], v[84:87]
v_mul_f32 v59, v59, v32
v_cvt_pk_bf16_f32 v54, v56, v57
v_mfma_f32_16x16x32_bf16 v[84:87], a[124:127], v[208:211], v[84:87]
v_cvt_pk_bf16_f32 v55, v58, v59
v_cndmask_b32_dpp v56, v44, v52, vcc quad_perm:[1,0,3,2] row_mask:0xf bank_mask:0xf
v_mfma_f32_16x16x32_bf16 v[84:87], a[140:143], v[212:215], v[84:87]
v_cndmask_b32_dpp v57, v45, v53, vcc quad_perm:[1,0,3,2] row_mask:0xf bank_mask:0xf
v_cndmask_b32_dpp v58, v46, v54, vcc quad_perm:[1,0,3,2] row_mask:0xf bank_mask:0xf
v_mfma_f32_16x16x32_bf16 v[84:87], a[156:159], v[196:199], v[84:87]
v_cndmask_b32_dpp v59, v47, v55, vcc quad_perm:[1,0,3,2] row_mask:0xf bank_mask:0xf
s_brev_b64 vcc, vcc
v_cndmask_b32_dpp v48, v52, v44, vcc quad_perm:[1,0,3,2] row_mask:0xf bank_mask:0xf
v_mfma_f32_16x16x32_bf16 v[88:91], a[160:163], v[196:199], v[88:91]
v_cndmask_b32_dpp v49, v53, v45, vcc quad_perm:[1,0,3,2] row_mask:0xf bank_mask:0xf
v_cndmask_b32_dpp v50, v54, v46, vcc quad_perm:[1,0,3,2] row_mask:0xf bank_mask:0xf
v_mfma_f32_16x16x32_bf16 v[88:91], a[144:147], v[212:215], v[88:91]
v_cndmask_b32_dpp v51, v55, v47, vcc quad_perm:[1,0,3,2] row_mask:0xf bank_mask:0xf
v_mul_f32 v76, v76, v36
v_mfma_f32_16x16x32_bf16 v[88:91], a[128:131], v[208:211], v[88:91]
v_mul_f32 v77, v77, v36
v_mul_f32 v78, v78, v36
v_mfma_f32_16x16x32_bf16 v[88:91], a[112:115], v[204:207], v[88:91]
v_mul_f32 v79, v79, v36
v_cvt_pk_bf16_f32 v76, v76, v77
v_mfma_f32_16x16x32_bf16 v[148:151], a[32:35], v[216:219], v[148:151]
v_cvt_pk_bf16_f32 v77, v78, v79
v_mul_f32 v80, v80, v36
v_mfma_f32_16x16x32_bf16 v[108:111], a[100:103], v[224:227], v[108:111]
s_waitcnt vmcnt(0)
s_barrier
v_mfma_f32_16x16x32_bf16 v[108:111], a[116:119], v[228:231], v[108:111]
ds_read_b64_tr_b16 a[164:165], v12 offset:16896
ds_read_b64_tr_b16 a[166:167], v12 offset:17152
ds_read_b64_tr_b16 a[168:169], v12 offset:16904
v_mul_f32 v81, v81, v36
v_mfma_f32_16x16x32_bf16 v[108:111], a[132:135], v[232:235], v[108:111]
ds_read_b64_tr_b16 a[170:171], v12 offset:17160
v_mul_f32 v82, v82, v36
v_mul_f32 v83, v83, v36
v_mfma_f32_16x16x32_bf16 v[108:111], a[148:151], v[216:219], v[108:111]
ds_read_b64_tr_b16 a[172:173], v12 offset:16912
v_rcp_f32 v40, v148
v_mfma_f32_16x16x32_bf16 v[112:115], a[152:155], v[216:219], v[112:115]
ds_read_b64_tr_b16 a[174:175], v12 offset:17168
ds_read_b64_tr_b16 a[176:177], v12 offset:16920
v_mov_b32 v41, v40
v_mfma_f32_16x16x32_bf16 v[112:115], a[136:139], v[232:235], v[112:115]
ds_read_b64_tr_b16 a[178:179], v12 offset:17176
buffer_store_dwordx4 v[56:59], v5, s[16:19], s93 offen offset:256 nt
v_mfma_f32_16x16x32_bf16 v[112:115], a[120:123], v[228:231], v[112:115]
ds_read_b64_tr_b16 a[180:181], v12 offset:17408
ds_read_b64_tr_b16 a[182:183], v12 offset:17664
v_cvt_pk_bf16_f32 v78, v80, v81
v_mfma_f32_16x16x32_bf16 v[112:115], a[104:107], v[224:227], v[112:115]
ds_read_b64_tr_b16 a[184:185], v12 offset:17416
v_cvt_pk_bf16_f32 v79, v82, v83
v_mul_f32 v84, v84, v36
v_mfma_f32_16x16x32_bf16 v[116:119], a[108:111], v[224:227], v[116:119]
ds_read_b64_tr_b16 a[186:187], v12 offset:17672
ds_read_b64_tr_b16 a[188:189], v12 offset:17424
v_mul_f32 v85, v85, v36
v_mfma_f32_16x16x32_bf16 v[116:119], a[124:127], v[228:231], v[116:119]
ds_read_b64_tr_b16 a[190:191], v12 offset:17680
v_mul_f32 v86, v86, v36
v_mul_f32 v87, v87, v36
v_mfma_f32_16x16x32_bf16 v[116:119], a[140:143], v[232:235], v[116:119]
ds_read_b64_tr_b16 a[192:193], v12 offset:17432
buffer_store_dwordx4 v[48:51], v5, s[16:19], s93 offen offset:0 nt
v_cvt_pk_bf16_f32 v84, v84, v85
v_mfma_f32_16x16x32_bf16 v[116:119], a[156:159], v[216:219], v[116:119]
ds_read_b64_tr_b16 a[194:195], v12 offset:17688
ds_read_b64_tr_b16 a[196:197], v12 offset:25344
v_cvt_pk_bf16_f32 v85, v86, v87
v_mfma_f32_16x16x32_bf16 v[120:123], a[160:163], v[216:219], v[120:123]
ds_read_b64_tr_b16 a[198:199], v12 offset:25600
v_mul_f32 v88, v88, v36
v_mul_f32 v89, v89, v36
v_mfma_f32_16x16x32_bf16 v[120:123], a[144:147], v[232:235], v[120:123]
ds_read_b64_tr_b16 a[200:201], v12 offset:25352
ds_read_b64_tr_b16 a[202:203], v12 offset:25608
v_mul_f32 v90, v90, v36
v_mfma_f32_16x16x32_bf16 v[120:123], a[128:131], v[228:231], v[120:123]
s_waitcnt lgkmcnt(12)
ds_read_b64_tr_b16 a[204:205], v12 offset:25360
v_mul_f32 v91, v91, v36
v_cvt_pk_bf16_f32 v86, v88, v89
v_mfma_f32_16x16x32_bf16 v[120:123], a[112:115], v[224:227], v[120:123]
ds_read_b64_tr_b16 a[206:207], v12 offset:25616
ds_read_b64_tr_b16 a[208:209], v12 offset:25368
v_cvt_pk_bf16_f32 v87, v90, v91
v_mfma_f32_16x16x32_bf16 v[60:63], a[164:167], v[184:187], v[60:63]
ds_read_b64_tr_b16 a[210:211], v12 offset:25624
ds_read_b64_tr_b16 a[212:213], v12 offset:25856
ds_read_b64_tr_b16 a[214:215], v12 offset:26112
v_mfma_f32_16x16x32_bf16 v[64:67], a[168:171], v[184:187], v[64:67]
ds_read_b64_tr_b16 a[216:217], v12 offset:25864
ds_read_b64_tr_b16 a[218:219], v12 offset:26120
v_cndmask_b32_dpp v80, v84, v76, vcc quad_perm:[1,0,3,2] row_mask:0xf bank_mask:0xf
v_mfma_f32_16x16x32_bf16 v[68:71], a[172:175], v[184:187], v[68:71]
s_waitcnt lgkmcnt(12)
ds_read_b64_tr_b16 a[220:221], v12 offset:25872
ds_read_b64_tr_b16 a[222:223], v12 offset:26128
v_cndmask_b32_dpp v81, v85, v77, vcc quad_perm:[1,0,3,2] row_mask:0xf bank_mask:0xf
v_mfma_f32_16x16x32_bf16 v[72:75], a[176:179], v[184:187], v[72:75]
ds_read_b64_tr_b16 a[224:225], v12 offset:25880
ds_read_b64_tr_b16 a[226:227], v12 offset:26136
v_cndmask_b32_dpp v82, v86, v78, vcc quad_perm:[1,0,3,2] row_mask:0xf bank_mask:0xf
v_mfma_f32_16x16x32_bf16 v[60:63], a[180:183], v[188:191], v[60:63]
v_cndmask_b32_dpp v83, v87, v79, vcc quad_perm:[1,0,3,2] row_mask:0xf bank_mask:0xf
s_brev_b64 vcc, vcc
v_cndmask_b32_dpp v88, v76, v84, vcc quad_perm:[1,0,3,2] row_mask:0xf bank_mask:0xf
v_cndmask_b32_dpp v89, v77, v85, vcc quad_perm:[1,0,3,2] row_mask:0xf bank_mask:0xf
v_mfma_f32_16x16x32_bf16 v[64:67], a[184:187], v[188:191], v[64:67]
buffer_store_dwordx4 v[80:83], v5, s[16:19], s99 offen offset:0 nt
v_cndmask_b32_dpp v90, v78, v86, vcc quad_perm:[1,0,3,2] row_mask:0xf bank_mask:0xf
v_cndmask_b32_dpp v91, v79, v87, vcc quad_perm:[1,0,3,2] row_mask:0xf bank_mask:0xf
v_mfma_f32_16x16x32_bf16 v[68:71], a[188:191], v[188:191], v[68:71]
s_waitcnt lgkmcnt(8)
v_mul_f32 v108, v108, v40
v_mul_f32 v109, v109, v40
v_mul_f32 v110, v110, v40
v_mfma_f32_16x16x32_bf16 v[72:75], a[192:195], v[188:191], v[72:75]
s_waitcnt lgkmcnt(0)
v_mul_f32 v111, v111, v40
v_cvt_pk_bf16_f32 v108, v108, v109
v_cvt_pk_bf16_f32 v109, v110, v111
v_mfma_f32_16x16x32_bf16 v[60:63], a[196:199], v[192:195], v[60:63]
v_mul_f32 v112, v112, v40
v_mul_f32 v113, v113, v40
v_mul_f32 v114, v114, v40
v_mfma_f32_16x16x32_bf16 v[60:63], a[212:215], v[176:179], v[60:63]
v_mul_f32 v115, v115, v40
v_cvt_pk_bf16_f32 v110, v112, v113
v_cvt_pk_bf16_f32 v111, v114, v115
v_mfma_f32_16x16x32_bf16 v[64:67], a[216:219], v[176:179], v[64:67]
buffer_store_dwordx4 v[88:91], v5, s[16:19], s99 offen offset:256 nt
v_mul_f32 v116, v116, v40
v_mfma_f32_16x16x32_bf16 v[64:67], a[200:203], v[192:195], v[64:67]
v_mul_f32 v117, v117, v40
v_mul_f32 v118, v118, v40
v_mul_f32 v119, v119, v40
v_mfma_f32_16x16x32_bf16 v[68:71], a[204:207], v[192:195], v[68:71]
v_cvt_pk_bf16_f32 v116, v116, v117
v_cvt_pk_bf16_f32 v117, v118, v119
v_mul_f32 v120, v120, v40
v_mfma_f32_16x16x32_bf16 v[68:71], a[220:223], v[176:179], v[68:71]
v_mul_f32 v121, v121, v40
v_mul_f32 v122, v122, v40
v_mul_f32 v123, v123, v40
v_mfma_f32_16x16x32_bf16 v[72:75], a[224:227], v[176:179], v[72:75]
v_cvt_pk_bf16_f32 v118, v120, v121
v_cvt_pk_bf16_f32 v119, v122, v123
v_cndmask_b32_dpp v120, v108, v116, vcc quad_perm:[1,0,3,2] row_mask:0xf bank_mask:0xf
v_mfma_f32_16x16x32_bf16 v[72:75], a[208:211], v[192:195], v[72:75]
v_cndmask_b32_dpp v121, v109, v117, vcc quad_perm:[1,0,3,2] row_mask:0xf bank_mask:0xf
v_cndmask_b32_dpp v122, v110, v118, vcc quad_perm:[1,0,3,2] row_mask:0xf bank_mask:0xf
v_cndmask_b32_dpp v123, v111, v119, vcc quad_perm:[1,0,3,2] row_mask:0xf bank_mask:0xf
s_brev_b64 vcc, vcc
v_cndmask_b32_dpp v112, v116, v108, vcc quad_perm:[1,0,3,2] row_mask:0xf bank_mask:0xf
v_mfma_f32_16x16x32_bf16 v[92:95], a[164:167], v[204:207], v[92:95]
buffer_store_dwordx4 v[120:123], v5, s[16:19], s100 offen offset:256 nt
v_cndmask_b32_dpp v113, v117, v109, vcc quad_perm:[1,0,3,2] row_mask:0xf bank_mask:0xf
v_mfma_f32_16x16x32_bf16 v[92:95], a[180:183], v[208:211], v[92:95]
v_cndmask_b32_dpp v114, v118, v110, vcc quad_perm:[1,0,3,2] row_mask:0xf bank_mask:0xf
v_cndmask_b32_dpp v115, v119, v111, vcc quad_perm:[1,0,3,2] row_mask:0xf bank_mask:0xf
v_mul_f32 v60, v60, v32
v_mfma_f32_16x16x32_bf16 v[92:95], a[196:199], v[212:215], v[92:95]
v_mul_f32 v61, v61, v32
v_mul_f32 v62, v62, v32
v_mul_f32 v63, v63, v32
v_mfma_f32_16x16x32_bf16 v[92:95], a[212:215], v[196:199], v[92:95]
v_cvt_pk_bf16_f32 v60, v60, v61
v_cvt_pk_bf16_f32 v61, v62, v63
v_mul_f32 v64, v64, v32
v_mfma_f32_16x16x32_bf16 v[96:99], a[216:219], v[196:199], v[96:99]
v_mul_f32 v65, v65, v32
v_mul_f32 v66, v66, v32
v_mul_f32 v67, v67, v32
v_mfma_f32_16x16x32_bf16 v[96:99], a[200:203], v[212:215], v[96:99]
buffer_store_dwordx4 v[112:115], v5, s[16:19], s100 offen offset:0 nt
v_cvt_pk_bf16_f32 v62, v64, v65
v_mfma_f32_16x16x32_bf16 v[96:99], a[184:187], v[208:211], v[96:99]
v_cvt_pk_bf16_f32 v63, v66, v67
v_mul_f32 v68, v68, v32
v_mul_f32 v69, v69, v32
v_mfma_f32_16x16x32_bf16 v[96:99], a[168:171], v[204:207], v[96:99]
v_mul_f32 v70, v70, v32
v_mul_f32 v71, v71, v32
v_cvt_pk_bf16_f32 v68, v68, v69
v_mfma_f32_16x16x32_bf16 v[100:103], a[172:175], v[204:207], v[100:103]
v_cvt_pk_bf16_f32 v69, v70, v71
v_mul_f32 v72, v72, v32
v_mul_f32 v73, v73, v32
v_mfma_f32_16x16x32_bf16 v[100:103], a[188:191], v[208:211], v[100:103]
v_mul_f32 v74, v74, v32
v_mul_f32 v75, v75, v32
v_cvt_pk_bf16_f32 v70, v72, v73
v_mfma_f32_16x16x32_bf16 v[100:103], a[204:207], v[212:215], v[100:103]
v_cvt_pk_bf16_f32 v71, v74, v75
v_cndmask_b32_dpp v64, v68, v60, vcc quad_perm:[1,0,3,2] row_mask:0xf bank_mask:0xf
v_cndmask_b32_dpp v65, v69, v61, vcc quad_perm:[1,0,3,2] row_mask:0xf bank_mask:0xf
v_cndmask_b32_dpp v66, v70, v62, vcc quad_perm:[1,0,3,2] row_mask:0xf bank_mask:0xf
v_mfma_f32_16x16x32_bf16 v[100:103], a[220:223], v[196:199], v[100:103]
v_cndmask_b32_dpp v67, v71, v63, vcc quad_perm:[1,0,3,2] row_mask:0xf bank_mask:0xf
s_brev_b64 vcc, vcc
v_cndmask_b32_dpp v72, v60, v68, vcc quad_perm:[1,0,3,2] row_mask:0xf bank_mask:0xf
v_cndmask_b32_dpp v73, v61, v69, vcc quad_perm:[1,0,3,2] row_mask:0xf bank_mask:0xf
v_mfma_f32_16x16x32_bf16 v[104:107], a[224:227], v[196:199], v[104:107]
buffer_store_dwordx4 v[64:67], v5, s[16:19], s93 offen offset:128 nt
v_cndmask_b32_dpp v74, v62, v70, vcc quad_perm:[1,0,3,2] row_mask:0xf bank_mask:0xf
v_mfma_f32_16x16x32_bf16 v[104:107], a[208:211], v[212:215], v[104:107]
v_cndmask_b32_dpp v75, v63, v71, vcc quad_perm:[1,0,3,2] row_mask:0xf bank_mask:0xf
v_mul_f32 v92, v92, v36
v_mul_f32 v93, v93, v36
v_mfma_f32_16x16x32_bf16 v[104:107], a[192:195], v[208:211], v[104:107]
v_mul_f32 v94, v94, v36
v_mul_f32 v95, v95, v36
v_cvt_pk_bf16_f32 v92, v92, v93
v_mfma_f32_16x16x32_bf16 v[104:107], a[176:179], v[204:207], v[104:107]
v_cvt_pk_bf16_f32 v93, v94, v95
v_mul_f32 v96, v96, v36
v_mul_f32 v97, v97, v36
v_mfma_f32_16x16x32_bf16 v[124:127], a[164:167], v[224:227], v[124:127]
v_mul_f32 v98, v98, v36
v_mul_f32 v99, v99, v36
v_cvt_pk_bf16_f32 v94, v96, v97
v_mfma_f32_16x16x32_bf16 v[124:127], a[180:183], v[228:231], v[124:127]
buffer_store_dwordx4 v[72:75], v5, s[16:19], s93 offen offset:384 nt
v_cvt_pk_bf16_f32 v95, v98, v99
v_mfma_f32_16x16x32_bf16 v[124:127], a[196:199], v[232:235], v[124:127]
v_mul_f32 v100, v100, v36
v_mul_f32 v101, v101, v36
v_mul_f32 v102, v102, v36
v_mfma_f32_16x16x32_bf16 v[124:127], a[212:215], v[216:219], v[124:127]
v_mul_f32 v103, v103, v36
v_cvt_pk_bf16_f32 v100, v100, v101
v_cvt_pk_bf16_f32 v101, v102, v103
v_mfma_f32_16x16x32_bf16 v[128:131], a[216:219], v[216:219], v[128:131]
v_mul_f32 v104, v104, v36
v_mul_f32 v105, v105, v36
v_mul_f32 v106, v106, v36
v_mfma_f32_16x16x32_bf16 v[128:131], a[200:203], v[232:235], v[128:131]
v_mul_f32 v107, v107, v36
v_cvt_pk_bf16_f32 v102, v104, v105
v_cvt_pk_bf16_f32 v103, v106, v107
v_cndmask_b32_dpp v104, v92, v100, vcc quad_perm:[1,0,3,2] row_mask:0xf bank_mask:0xf
v_mfma_f32_16x16x32_bf16 v[128:131], a[184:187], v[228:231], v[128:131]
v_cndmask_b32_dpp v105, v93, v101, vcc quad_perm:[1,0,3,2] row_mask:0xf bank_mask:0xf
v_cndmask_b32_dpp v106, v94, v102, vcc quad_perm:[1,0,3,2] row_mask:0xf bank_mask:0xf
v_cndmask_b32_dpp v107, v95, v103, vcc quad_perm:[1,0,3,2] row_mask:0xf bank_mask:0xf
s_brev_b64 vcc, vcc
v_mfma_f32_16x16x32_bf16 v[128:131], a[168:171], v[224:227], v[128:131]
buffer_store_dwordx4 v[104:107], v5, s[16:19], s99 offen offset:384 nt
v_cndmask_b32_dpp v96, v100, v92, vcc quad_perm:[1,0,3,2] row_mask:0xf bank_mask:0xf
v_mfma_f32_16x16x32_bf16 v[132:135], a[172:175], v[224:227], v[132:135]
v_cndmask_b32_dpp v97, v101, v93, vcc quad_perm:[1,0,3,2] row_mask:0xf bank_mask:0xf
v_cndmask_b32_dpp v98, v102, v94, vcc quad_perm:[1,0,3,2] row_mask:0xf bank_mask:0xf
v_cndmask_b32_dpp v99, v103, v95, vcc quad_perm:[1,0,3,2] row_mask:0xf bank_mask:0xf
v_mfma_f32_16x16x32_bf16 v[132:135], a[188:191], v[228:231], v[132:135]
v_mul_f32 v124, v124, v40
v_mul_f32 v125, v125, v40
v_mul_f32 v126, v126, v40
v_mfma_f32_16x16x32_bf16 v[132:135], a[204:207], v[232:235], v[132:135]
v_mul_f32 v127, v127, v40
v_cvt_pk_bf16_f32 v124, v124, v125
v_cvt_pk_bf16_f32 v125, v126, v127
v_mfma_f32_16x16x32_bf16 v[132:135], a[220:223], v[216:219], v[132:135]
v_mul_f32 v128, v128, v40
v_mul_f32 v129, v129, v40
v_mul_f32 v130, v130, v40
v_mfma_f32_16x16x32_bf16 v[136:139], a[224:227], v[216:219], v[136:139]
buffer_store_dwordx4 v[96:99], v5, s[16:19], s99 offen offset:128 nt
v_mul_f32 v131, v131, v40
v_mfma_f32_16x16x32_bf16 v[136:139], a[208:211], v[232:235], v[136:139]
v_cvt_pk_bf16_f32 v126, v128, v129
v_cvt_pk_bf16_f32 v127, v130, v131
v_mfma_f32_16x16x32_bf16 v[136:139], a[192:195], v[228:231], v[136:139]
v_mfma_f32_16x16x32_bf16 v[136:139], a[176:179], v[224:227], v[136:139]
v_mul_f32 v132, v132, v40
v_mul_f32 v133, v133, v40
v_mul_f32 v134, v134, v40
v_mul_f32 v135, v135, v40
v_cvt_pk_bf16_f32 v132, v132, v133
v_cvt_pk_bf16_f32 v133, v134, v135
s_nop 1
v_pk_mul_f32 v[136:137], v[136:137], v[40:41]
v_pk_mul_f32 v[138:139], v[138:139], v[40:41]
v_cvt_pk_bf16_f32 v134, v136, v137
v_cvt_pk_bf16_f32 v135, v138, v139
v_cndmask_b32_dpp v128, v132, v124, vcc quad_perm:[1,0,3,2] row_mask:0xf bank_mask:0xf
v_cndmask_b32_dpp v129, v133, v125, vcc quad_perm:[1,0,3,2] row_mask:0xf bank_mask:0xf
v_cndmask_b32_dpp v130, v134, v126, vcc quad_perm:[1,0,3,2] row_mask:0xf bank_mask:0xf
v_cndmask_b32_dpp v131, v135, v127, vcc quad_perm:[1,0,3,2] row_mask:0xf bank_mask:0xf
buffer_store_dwordx4 v[128:131], v5, s[16:19], s100 offen offset:128 nt
s_brev_b64 vcc, vcc
v_cndmask_b32_dpp v136, v124, v132, vcc quad_perm:[1,0,3,2] row_mask:0xf bank_mask:0xf
v_cndmask_b32_dpp v137, v125, v133, vcc quad_perm:[1,0,3,2] row_mask:0xf bank_mask:0xf
v_cndmask_b32_dpp v138, v126, v134, vcc quad_perm:[1,0,3,2] row_mask:0xf bank_mask:0xf
v_cndmask_b32_dpp v139, v127, v135, vcc quad_perm:[1,0,3,2] row_mask:0xf bank_mask:0xf
buffer_store_dwordx4 v[136:139], v5, s[16:19], s100 offen offset:384 nt
v_add_f32 v21, v140, v144
v_add_f32 v21, v21, v148
v_cmp_nge_f32 vcc, s22, v21
s_cbranch_vccnz L_setflag_o2
L_setflag_ret_o2:
s_barrier
ds_read_b32 v25, v15 offset:0
s_waitcnt lgkmcnt(0)
v_readfirstlane_b32 s25, v25
s_nop 0
s_cmp_gt_u32 s25, s27
s_cbranch_scc1 L_fallback
L_end_o2:
s_endpgm
L_setflag_o2:
v_mov_b32 v20, 1
s_nop 0
ds_write_b32 v15, v20 offset:0
s_waitcnt lgkmcnt(0)
s_branch L_setflag_ret_o2
L_fallback:
s_waitcnt vmcnt(0) lgkmcnt(0)
s_barrier
s_mov_b32 s27, 1
s_mov_b32 s28, 0
L_maxloop:
s_mov_b32 m0, s23
s_nop 0
buffer_load_dwordx4 v2, s[8:11], s28 offen lds
s_add_u32 m0, m0, 1056
s_add_u32 s24, s28, 1024
buffer_load_dwordx4 v2, s[8:11], s24 offen lds
s_waitcnt vmcnt(0)
s_barrier
ds_read_b128 a[36:39], v6 offset:0
ds_read_b128 a[52:55], v6 offset:512
ds_read_b128 a[40:43], v6 offset:64
ds_read_b128 a[56:59], v6 offset:576
ds_read_b128 a[44:47], v6 offset:128
ds_read_b128 a[60:63], v6 offset:640
ds_read_b128 a[48:51], v6 offset:192
ds_read_b128 a[64:67], v6 offset:704
s_waitcnt lgkmcnt(0)
s_barrier
v_mfma_f32_16x16x32_bf16 v[152:155], a[36:39], a[0:3], 0
v_mfma_f32_16x16x32_bf16 v[152:155], a[40:43], a[4:7], v[152:155]
v_mfma_f32_16x16x32_bf16 v[152:155], a[44:47], a[8:11], v[152:155]
v_mfma_f32_16x16x32_bf16 v[152:155], a[48:51], a[12:15], v[152:155]
v_mfma_f32_16x16x32_bf16 v[156:159], a[64:67], a[12:15], 0
v_mfma_f32_16x16x32_bf16 v[156:159], a[60:63], a[8:11], v[156:159]
v_mfma_f32_16x16x32_bf16 v[156:159], a[56:59], a[4:7], v[156:159]
v_mfma_f32_16x16x32_bf16 v[156:159], a[52:55], a[0:3], v[156:159]
v_mfma_f32_16x16x32_bf16 v[160:163], a[36:39], a[16:19], 0
v_mfma_f32_16x16x32_bf16 v[160:163], a[40:43], a[20:23], v[160:163]
v_mfma_f32_16x16x32_bf16 v[160:163], a[44:47], a[24:27], v[160:163]
v_mfma_f32_16x16x32_bf16 v[160:163], a[48:51], a[28:31], v[160:163]
v_mfma_f32_16x16x32_bf16 v[164:167], a[64:67], a[28:31], 0
v_mfma_f32_16x16x32_bf16 v[164:167], a[60:63], a[24:27], v[164:167]
v_mfma_f32_16x16x32_bf16 v[164:167], a[56:59], a[20:23], v[164:167]
v_mfma_f32_16x16x32_bf16 v[164:167], a[52:55], a[16:19], v[164:167]
v_mfma_f32_16x16x32_bf16 v[168:171], a[36:39], v[236:239], 0
v_mfma_f32_16x16x32_bf16 v[168:171], a[40:43], v[240:243], v[168:171]
v_mfma_f32_16x16x32_bf16 v[168:171], a[44:47], v[244:247], v[168:171]
v_mfma_f32_16x16x32_bf16 v[168:171], a[48:51], v[248:251], v[168:171]
v_mfma_f32_16x16x32_bf16 v[172:175], a[64:67], v[248:251], 0
v_mfma_f32_16x16x32_bf16 v[172:175], a[60:63], v[244:247], v[172:175]
v_mfma_f32_16x16x32_bf16 v[172:175], a[56:59], v[240:243], v[172:175]
v_mfma_f32_16x16x32_bf16 v[172:175], a[52:55], v[236:239], v[172:175]
v_max3_f32 v26, v26, v152, v153
v_max3_f32 v26, v26, v154, v155
v_max3_f32 v26, v26, v156, v157
v_max3_f32 v26, v26, v158, v159
v_max3_f32 v27, v27, v160, v161
v_max3_f32 v27, v27, v162, v163
v_max3_f32 v27, v27, v164, v165
v_max3_f32 v27, v27, v166, v167
v_max3_f32 v28, v28, v168, v169
v_max3_f32 v28, v28, v170, v171
v_max3_f32 v28, v28, v172, v173
v_max3_f32 v28, v28, v174, v175
s_or_b32 s28, s28, 0xffff87ff
s_add_u32 s28, s28, 1
s_and_b32 s28, s28, 0x7800
s_cbranch_scc1 L_maxloop
s_branch L_restart
.section .rodata,"a"
.p2align 6
.amdhsa_kernel standalone__mha_softmax__near_ridge_kernel
  .amdhsa_next_free_vgpr 480
  .amdhsa_next_free_sgpr 102
  .amdhsa_accum_offset 252
  .amdhsa_group_segment_fixed_size 0
  .amdhsa_kernarg_size 48
  .amdhsa_user_sgpr_count 2
  .amdhsa_user_sgpr_kernarg_segment_ptr 1
  .amdhsa_system_sgpr_workgroup_id_x 1
.end_amdhsa_kernel
```
